```python
import torch

def _softmax(x, axis=-1):
    return torch.softmax(x, dim=axis)
def _gelu(x):
    return torch.nn.functional.gelu(x, approximate="tanh")
def _silu(x):
    return torch.nn.functional.silu(x)
def _sigmoid(x):
    return torch.sigmoid(x)
def _layernorm(x, axis=-1, eps=1e-5):
    m = x.mean(dim=axis, keepdim=True)
    v = x.var(dim=axis, keepdim=True, unbiased=False)
    return (x - m) / torch.sqrt(v + eps)
def _scatter_add(tgt, idx, src, axis=0):
    return tgt.clone().index_add_(axis, idx, src)
def _segment_sum(src, seg, n):
    out = torch.zeros((n,) + src.shape[1:], dtype=src.dtype)
    return out.index_add_(0, seg, src)
def _pad(x, pw):
    flat = tuple(v for pair in reversed(pw) for v in pair)
    return torch.nn.functional.pad(x, flat)

kernel_name = 'parallel_sum__linear_attn_block__dense_activation_silu__prompt'

def setup_inputs():

    _w = (lambda a: (lambda t: t.to(torch.bfloat16) if t.is_floating_point() else t)(torch.as_tensor(a)))
    def _A_setup():
        B, S, D = 1, 2048, 512
        return {
            "x": _w((lambda *s: torch.randn(*s, dtype=torch.bfloat16) * 0.05)(B, S, D)),
            "wqkv": _w((lambda *s: torch.randn(*s, dtype=torch.bfloat16) * 0.1)(D, 3 * D)),
            "wo": _w((lambda *s: torch.randn(*s, dtype=torch.bfloat16) * 0.05)(D, D)),
        }
    _A_in = _A_setup()

    def _B_setup():
        B, S, D, F = 1, 2048, 512, 1792
        return {
            "x": _w((lambda *s: torch.randn(*s, dtype=torch.bfloat16) * 0.05)(B, S, D)),
            "w1": _w((lambda *s: torch.randn(*s, dtype=torch.bfloat16) * 0.8)(D, F) * (D ** -0.5)),
            "w2": _w((lambda *s: torch.randn(*s, dtype=torch.bfloat16) * 0.1)(F, D) * (F ** -0.5)),
        }
    _B_in = _B_setup()

    return {
        "A_x": _A_in["x"],
        "A_wqkv": _A_in["wqkv"],
        "A_wo": _A_in["wo"],
        "B_x": _B_in["x"],
        "B_w1": _B_in["w1"],
        "B_w2": _B_in["w2"],
    }

def reference(A_x, A_wqkv, A_wo, B_x, B_w1, B_w2):
    def _A_ref(x, wqkv, wo):
        B, S, D = x.shape
        H = 32; Dh = D // H
        qkv = (lambda x, *d: x.permute(*d))((x @ wqkv).reshape(B, S, 3, H, Dh), 2, 0, 3, 1, 4)
        q, k, v = qkv[0], qkv[1], qkv[2]
        phi = lambda t: torch.where(t > 0, t + 1, torch.exp(t)) + 1e-6
        pq, pk = phi(q), phi(k)
        kv = torch.einsum("bhsd,bhse->bhde", pk, v)
        z = torch.einsum("bhsd->bhd", pk)
        num = torch.einsum("bhqd,bhde->bhqe", pq, kv)
        den = torch.einsum("bhqd,bhd->bhq", pq, z)[..., None] + 1e-6
        o = num / den
        return (lambda x, *d: x.permute(*d))(o, 0, 2, 1, 3).reshape(B, S, D) @ wo

    def _B_ref(x, w1, w2):
        h = torch.einsum("bsd,df->bsf", x, w1)
        h = _silu(h)
        out = torch.einsum("bsf,fd->bsd", h, w2)
        return out

    x = A_x
    xn = _layernorm(x, axis=-1)
    return x + _A_ref(xn, A_wqkv, A_wo) + _B_ref(xn, B_w1, B_w2)
```

```asm
; @launch grid=(256,1,1) block=(256,1,1) lds=163840
.amdgcn_target "amdgcn-amd-amdhsa--gfx950"
.text
.p2align 12
.globl parallel_sum__linear_attn_block__dense_activation_silu__prompt_kernel
.p2align 8
.type parallel_sum__linear_attn_block__dense_activation_silu__prompt_kernel,@function
parallel_sum__linear_attn_block__dense_activation_silu__prompt_kernel:
    s_cmp_lt_u32 s2, 256
    s_cbranch_scc1 L_go
    s_endpgm
L_go:
    s_load_dwordx16 s[64:79], s[0:1], 0
    s_load_dwordx2 s[80:81], s[0:1], 64
    v_lshrrev_b32 v26, 6, v0
    v_and_b32 v1, 63, v0
    v_readfirstlane_b32 s3, v26
    s_lshr_b32 s40, s2, 3
    s_cmp_lg_u32 s3, 3
    s_cbranch_scc1 L_nct
    s_getpc_b64 s[48:49]
L_pc:
    s_mul_i32 s50, s40, 1792
    v_lshl_add_u32 v26, v1, 7, s50
    v_min_u32 v26, L_codeend-L_pc-4, v26
    v_mov_b32 v27, s49
    v_add_co_u32 v26, vcc, s48, v26
    s_mov_b64 exec, 0x3fff
    s_nop 0
    v_addc_co_u32 v27, vcc, 0, v27, vcc
    global_load_dword v31, v[26:27], off
    s_mov_b64 exec, -1
L_nct:
    s_and_b32 s35, s2, 1
    s_bfe_u32 s41, s2, 0x20001
    s_and_b32 s48, s40, 3
    s_lshl2_add_u32 s32, s41, s48
    s_lshr_b32 s54, s40, 2
    s_lshr_b32 s34, s54, 2
    s_and_b32 s48, s54, 3
    s_lshl2_add_u32 s33, s35, s48
    s_xor_b32 s36, s54, 1
    s_mul_i32 s37, s3, 40960
    s_lshl2_add_u32 s48, s32, s3
    s_lshl_b32 s63, s48, 15
    s_mul_i32 s56, s48, 147456
    s_add_u32 s56, s56, 1048576
    s_lshl_b32 s39, s34, 9
    s_add_u32 s39, s39, 3072
    s_lshl_b32 s48, s54, 7
    s_add_u32 s63, s63, s48
    v_lshrrev_b32 v26, 3, v1
    v_and_b32 v27, 7, v1
    v_lshrrev_b32 v29, 4, v1
    v_xor_b32 v28, v27, v29
    v_lshlrev_b32 v28, 4, v28
    v_lshl_add_u32 v10, v26, 10, v28
    v_xor_b32 v28, 64, v10
    v_add_u32 v11, 7168, v28
    v_add_u32 v12, 14336, v10
    v_add_u32 v13, 21504, v28
    s_mov_b32 s6, 0x200000
    s_mov_b32 s7, 0x20000
    s_waitcnt lgkmcnt(0)
    s_mov_b32 s4, s64
    s_and_b32 s5, s65, 0xffff
    s_add_u32 m0, s37, 8192
    s_xor_b32 s48, s63, 0
    buffer_load_dwordx4 v10, s[4:7], s48 offen offset:0 lds
    buffer_load_dwordx4 v11, s[4:7], s48 offen offset:1024 lds
    buffer_load_dwordx4 v12, s[4:7], s48 offen offset:2048 lds
    buffer_load_dwordx4 v13, s[4:7], s48 offen offset:3072 lds
    s_lshl_b32 s48, s41, 5
    s_add_u32 s48, s48, s40
    s_movk_i32 s44, 2048
    s_movk_i32 s45, 512
    s_movk_i32 s46, 16
    s_movk_i32 s47, 16
    s_lshl_b32 s49, s35, 7
    s_add_u32 s49, s49, s48
    s_lshl_b32 s51, s49, 11
    s_mul_i32 s49, s49, 7168
    s_cmp_eq_u32 s3, 2
    s_cselect_b32 s47, 56, s47
    s_cselect_b32 s51, s49, s51
    s_lshl3_add_u32 s49, s48, s35
    s_mul_i32 s49, s49, 1792
    s_cmp_eq_u32 s3, 1
    s_cselect_b32 s44, 3584, s44
    s_cselect_b32 s46, 14, s46
    s_cselect_b32 s47, 64, s47
    s_cselect_b32 s51, s49, s51
    s_mul_i32 s49, s48, 24
    s_add_u32 s49, s49, s35
    s_lshl_b32 s49, s49, 9
    s_cmp_eq_u32 s3, 0
    s_cselect_b32 s44, 3072, s44
    s_cselect_b32 s45, 1024, s45
    s_cselect_b32 s46, 12, s46
    s_cselect_b32 s47, 64, s47
    s_cselect_b32 s51, s49, s51
    v_mul_u32_u24 v28, s44, v29
    v_bfe_u32 v26, v1, 2, 2
    v_mul_u32_u24 v26, s45, v26
    v_add3_u32 v28, v28, v26, s51
    v_and_b32 v26, 3, v1
    v_lshl_add_u32 v28, v26, 7, v28
    v_and_b32 v26, 15, v1
    v_cmp_gt_u32 vcc, s46, v26
    v_mov_b32 v29, 1073741824
    s_nop 0
    v_cndmask_b32 v28, v29, v28, vcc
    v_cmp_gt_u32 vcc, s47, v1
    s_nop 0
    s_mov_b32 s87, 0x20000
    v_cndmask_b32 v23, v29, v28, vcc
    s_cmp_eq_u32 s3, 2
    s_cselect_b64 s[84:85], s[74:75], s[68:69]
    s_cmp_eq_u32 s3, 1
    s_cselect_b64 s[84:85], s[72:73], s[84:85]
    s_cmp_eq_u32 s3, 0
    s_cselect_b64 s[84:85], s[66:67], s[84:85]
    s_and_b32 s85, s85, 0xffff
    s_mov_b32 s86, 1835008
    s_cmp_eq_u32 s3, 3
    s_cselect_b32 s86, 524288, s86
    s_cmp_eq_u32 s3, 0
    s_cselect_b32 s86, 1572864, s86
    s_cmp_gt_u32 s3, 1
    s_cselect_b32 s62, 1073741824, 0
    v_or_b32 v31, s62, v23
    buffer_load_dword v31, v31, s[84:87], 0 offen
    s_load_dword s38, s[80:81], 0
    s_cmp_eq_u32 s34, 0
    s_cselect_b64 s[8:9], s[66:67], s[72:73]
    s_and_b32 s9, s9, 0xffff
    s_lshl_b32 s10, s39, 9
    s_mov_b32 s11, 0x20000
    s_mov_b32 s12, s74
    s_and_b32 s13, s75, 0xffff
    s_mov_b32 s14, 1835008
    s_mov_b32 s15, 0x20000
    s_mov_b32 s16, s68
    s_and_b32 s17, s69, 0xffff
    s_mov_b32 s18, 524288
    s_mov_b32 s19, 0x20000
    s_mov_b32 s20, s80
    s_and_b32 s21, s81, 0xffff
    s_mov_b32 s22, 16777216
    s_mov_b32 s23, 0x20000
    s_mov_b32 s24, s76
    s_and_b32 s25, s77, 0xffff
    s_mov_b32 s26, 2097152
    s_mov_b32 s27, 0x20000
    v_and_b32 v26, 31, v1
    v_lshlrev_b32 v27, 7, v26
    v_add_u32 v27, s37, v27
    v_add_u32 v27, 8192, v27
    v_bfe_u32 v26, v1, 1, 3
    v_lshrrev_b32 v28, 5, v1
    v_xor_b32 v26, v26, v28
    v_xor_b32 v28, 0, v26
    v_lshl_add_u32 v14, v28, 4, v27
    v_xor_b32 v28, 2, v26
    v_lshl_add_u32 v15, v28, 4, v27
    v_xor_b32 v28, 4, v26
    v_lshl_add_u32 v16, v28, 4, v27
    v_xor_b32 v28, 6, v26
    v_lshl_add_u32 v17, v28, 4, v27
    v_cmp_gt_u32 vcc, 32, v1
    v_lshlrev_b32 v28, 2, v1
    s_mov_b32 s52, 0x3f803f80
    s_mov_b32 s53, 0xffff0000
    v_cndmask_b32 v20, v29, v28, vcc
    v_and_b32 v26, 15, v1
    v_mul_u32_u24 v26, 3072, v26
    v_lshrrev_b32 v28, 4, v1
    v_lshl_add_u32 v26, v28, 10, v26
    s_mul_i32 s48, s40, 49152
    s_add_u32 s48, s48, 384
    s_or_b32 s49, s35, s3
    s_cselect_b32 s48, 1073741824, s48
    v_cmp_gt_u32 vcc, 48, v1
    v_add_u32 v26, s48, v26
    s_mul_i32 s49, s35, 3
    v_cndmask_b32 v30, v29, v26, vcc
    v_add_u32 v26, s49, v28
    v_and_b32 v27, 15, v1
    v_mul_u32_u24 v27, 3584, v27
    v_lshl_add_u32 v26, v26, 9, v27
    s_mul_i32 s48, s40, 57344
    s_add_u32 s48, s48, 384
    s_lshl4_add_u32 s49, s35, 48
    s_cmp_eq_u32 s3, 1
    s_cselect_b32 s49, s49, 0
    v_cmp_gt_u32 vcc, s49, v1
    v_add_u32 v26, s48, v26
    s_nop 0
    v_cndmask_b32 v30, v30, v26, vcc
    s_lshl_b32 s48, s39, 4
    s_lshl_b32 s49, s3, 3
    s_lshl_b32 s50, s54, 2
    s_xor_b32 s49, s49, s50
    s_xor_b32 s50, s49, 4
    s_mul_i32 s40, s48, s49
    s_mul_i32 s44, s48, s50
    s_add_u32 s41, s40, s48
    s_add_u32 s42, s41, s48
    s_add_u32 s43, s42, s48
    s_add_u32 s45, s44, s48
    s_add_u32 s46, s45, s48
    s_add_u32 s47, s46, s48
    s_bitcmp0_b32 s33, 0
    s_cselect_b32 s49, 0, 64
    s_mul_i32 s50, s33, 448
    s_add_u32 s50, s50, s49
    s_and_b32 s49, s33, 6
    s_lshr_b32 s49, 0, s49
    s_and_b32 s49, s49, 3
    s_cmp_eq_u32 s49, 2
    s_cselect_b32 s55, -2, 1
    s_lshl_b32 s49, s49, 7
    s_add_u32 s50, s50, s49
    s_lshl_b32 s51, s33, 7
    s_add_u32 s51, s51, 1024
    s_cmp_eq_u32 s34, 0
    s_cselect_b32 s50, s51, s50
    s_cselect_b32 s55, 8, s55
    s_lshl_b32 s55, s55, 7
    v_lshrrev_b32 v26, 2, v1
    v_mul_u32_u24 v26, s39, v26
    v_and_b32 v27, 3, v1
    v_lshl_add_u32 v26, v27, 4, v26
    v_add_u32 v4, s50, v26
    v_add_u32 v5, 64, v4
    v_lshlrev_b32 v2, 4, v1
    v_lshrrev_b32 v26, 5, v1
    v_lshlrev_b32 v26, 9, v26
    v_bfe_u32 v28, v1, 2, 2
    v_lshl_add_u32 v26, v28, 6, v26
    v_bfe_u32 v28, v1, 4, 1
    v_lshl_add_u32 v26, v28, 5, v26
    v_lshl_add_u32 v6, v27, 3, v26
    v_add_u32 v7, 40960, v6
    v_add_u32 v8, 81920, v6
    v_add_u32 v9, 122880, v6
    v_mov_b32 v18, 0
    s_mov_b64 s[0:1], s[78:79]
    v_lshrrev_b32 v27, 3, v1
    v_and_b32 v28, 7, v1
    v_bfe_u32 v29, v1, 4, 1
    v_lshlrev_b32 v29, 2, v29
    v_xor_b32 v28, v28, v29
    v_lshlrev_b32 v28, 4, v28
    v_lshl_add_u32 v0, v27, 10, v28
    s_add_u32 s49, s33, s3
    s_and_b32 s49, s49, 3
    s_lshl2_add_u32 s49, s35, s49
    s_lshl_b32 s50, s36, 7
    s_lshl_b32 s61, s49, 16
    s_add_u32 s61, s61, s50
    s_mul_i32 s60, s49, 229376
    s_add_u32 s60, s60, s50
    s_and_b32 s49, s49, 1
    s_xor_b32 s50, s49, 1
    s_mul_i32 s50, s50, 196608
    s_add_u32 s59, s60, s50
    s_lshl_b32 s49, s49, 15
    s_add_u32 s60, s60, s49
    s_lshl3_add_u32 s49, s32, s33
    s_lshl2_add_u32 s49, s49, s3
    s_lshl_b32 s58, s49, 7
    s_andn2_b32 s49, s58, 1536
    v_lshrrev_b32 v27, 4, v1
    v_max_u32 v27, s34, v27
    v_add_u32 v27, s33, v27
    v_and_b32 v27, 3, v27
    v_lshl_add_u32 v3, v27, 9, s49
    v_lshrrev_b32 v27, 4, v1
    v_lshl_add_u32 v27, v27, 9, s49
    v_add_u32 v27, 393216, v27
    v_bfe_i32 v28, v1, 3, 1
    v_bfi_b32 v26, v28, v27, v3
    v_lshrrev_b32 v27, 5, v1
    v_lshlrev_b32 v29, 4, v27
    v_lshlrev_b32 v27, 9, v27
    v_bfe_u32 v28, v1, 4, 1
    v_lshl_add_u32 v27, v28, 5, v27
    v_bfe_u32 v28, v1, 2, 2
    v_lshl_add_u32 v27, v28, 7, v27
    v_bfe_u32 v28, v1, 3, 1
    v_xor_b32 v28, s35, v28
    v_lshl_add_u32 v27, v28, 6, v27
    v_and_b32 v28, 3, v1
    v_lshl_add_u32 v21, v28, 3, v27
    v_lshlrev_b32 v29, 4, v28
    v_lshrrev_b32 v28, 2, v1
    v_lshl_add_u32 v29, v28, 10, v29
    s_lshl2_add_u32 s49, s32, s3
    s_lshl_b32 s49, s49, 15
    s_lshl1_add_u32 s50, s36, s35
    s_lshl_b32 s50, s50, 6
    s_add_u32 s49, s49, s50
    v_add_u32 v19, s49, v29
    s_add_u32 s49, s33, 0
    s_and_b32 s49, s49, 3
    s_lshl2_add_u32 s49, s35, s49
    s_mul_i32 s49, s49, 18432
    s_add_u32 s28, s56, s49
    s_add_u32 s49, s33, 1
    s_and_b32 s49, s49, 3
    s_lshl2_add_u32 s49, s35, s49
    s_mul_i32 s49, s49, 18432
    s_add_u32 s29, s56, s49
    s_add_u32 s49, s33, 2
    s_and_b32 s49, s49, 3
    s_lshl2_add_u32 s49, s35, s49
    s_mul_i32 s49, s49, 18432
    s_add_u32 s30, s56, s49
    s_add_u32 s49, s33, 3
    s_and_b32 s49, s49, 3
    s_lshl2_add_u32 s49, s35, s49
    s_mul_i32 s49, s49, 18432
    s_add_u32 s31, s56, s49
    v_mov_b32 v28, s52
    v_mov_b32 v29, s52
    s_lshl_b32 s49, s35, 6
    v_xor_b32 v24, s49, v14
    v_xor_b32 v25, s49, v15
    s_add_u32 m0, s37, 12288
    s_xor_b32 s48, s63, 128
    buffer_load_dwordx4 v10, s[4:7], s48 offen offset:0 lds
    buffer_load_dwordx4 v11, s[4:7], s48 offen offset:1024 lds
    buffer_load_dwordx4 v12, s[4:7], s48 offen offset:2048 lds
    buffer_load_dwordx4 v13, s[4:7], s48 offen offset:3072 lds
    s_add_u32 m0, s37, 16384
    s_xor_b32 s48, s63, 256
    buffer_load_dwordx4 v10, s[4:7], s48 offen offset:0 lds
    buffer_load_dwordx4 v11, s[4:7], s48 offen offset:1024 lds
    buffer_load_dwordx4 v12, s[4:7], s48 offen offset:2048 lds
    buffer_load_dwordx4 v13, s[4:7], s48 offen offset:3072 lds
    s_waitcnt vmcnt(9)
    ds_read_b128 v[128:131], v14 offset:0
    ds_read_b128 v[132:135], v15 offset:0
    ds_read_b128 v[136:139], v16 offset:0
    ds_read_b128 v[140:143], v17 offset:0
    s_add_u32 m0, s37, 20480
    s_xor_b32 s48, s63, 384
    buffer_load_dwordx4 v10, s[4:7], s48 offen offset:0 lds
    buffer_load_dwordx4 v11, s[4:7], s48 offen offset:1024 lds
    buffer_load_dwordx4 v12, s[4:7], s48 offen offset:2048 lds
    buffer_load_dwordx4 v13, s[4:7], s48 offen offset:3072 lds
    s_waitcnt lgkmcnt(0)
    s_or_b32 s48, s2, s3
    s_cbranch_scc1 L_ntag
    s_andn2_b32 s38, s38, 7
    s_mul_i32 s38, s38, 1664525
    s_add_u32 s38, s38, 3816266473
    v_mov_b32 v22, s38
    s_mov_b32 exec_hi, 0
    global_store_dword v20, v22, s[0:1] sc1
    s_mov_b64 exec, -1
    buffer_store_dword v22, v20, s[20:23], 0 offen sc1
L_ntag:
    s_waitcnt vmcnt(8)
    ds_read_b128 v[144:147], v14 offset:4096
    ds_read_b128 v[148:151], v15 offset:4096
    ds_read_b128 v[152:155], v16 offset:4096
    ds_read_b128 v[156:159], v17 offset:4096
    ds_read_b128 a[248:251], v24 offset:4096
    ds_read_b128 a[252:255], v25 offset:4096
    s_add_u32 m0, s37, 24576
    s_xor_b32 s48, s63, 512
    buffer_load_dwordx4 v10, s[4:7], s48 offen offset:0 lds
    v_mfma_f32_4x4x4_16b_bf16 v[64:67], v[28:29], v[128:129], 0
    s_nop 0
    v_mfma_f32_4x4x4_16b_bf16 v[68:71], v[128:129], v[128:129], 0
    s_nop 0
    v_mfma_f32_4x4x4_16b_bf16 v[64:67], v[28:29], v[130:131], v[64:67]
    s_nop 0
    v_mfma_f32_4x4x4_16b_bf16 v[68:71], v[130:131], v[130:131], v[68:71]
    s_nop 0
    buffer_load_dwordx4 v11, s[4:7], s48 offen offset:1024 lds
    v_mfma_f32_4x4x4_16b_bf16 v[64:67], v[28:29], v[132:133], v[64:67]
    v_lshlrev_b32 v32, 16, v128
    v_mfma_f32_4x4x4_16b_bf16 v[68:71], v[132:133], v[132:133], v[68:71]
    v_and_b32 v128, s53, v128
    v_mfma_f32_4x4x4_16b_bf16 v[64:67], v[28:29], v[134:135], v[64:67]
    v_lshlrev_b32 v33, 16, v129
    v_mfma_f32_4x4x4_16b_bf16 v[68:71], v[134:135], v[134:135], v[68:71]
    v_and_b32 v129, s53, v129
    v_lshlrev_b32 v34, 16, v130
    v_and_b32 v130, s53, v130
    buffer_load_dwordx4 v12, s[4:7], s48 offen offset:2048 lds
    v_mfma_f32_4x4x4_16b_bf16 v[64:67], v[28:29], v[136:137], v[64:67]
    v_lshlrev_b32 v35, 16, v131
    v_mfma_f32_4x4x4_16b_bf16 v[68:71], v[136:137], v[136:137], v[68:71]
    v_and_b32 v131, s53, v131
    v_mfma_f32_4x4x4_16b_bf16 v[64:67], v[28:29], v[138:139], v[64:67]
    v_lshlrev_b32 v36, 16, v132
    v_mfma_f32_4x4x4_16b_bf16 v[68:71], v[138:139], v[138:139], v[68:71]
    v_and_b32 v132, s53, v132
    v_lshlrev_b32 v37, 16, v133
    v_and_b32 v133, s53, v133
    buffer_load_dwordx4 v13, s[4:7], s48 offen offset:3072 lds
    v_mfma_f32_4x4x4_16b_bf16 v[64:67], v[28:29], v[140:141], v[64:67]
    v_lshlrev_b32 v38, 16, v134
    v_mfma_f32_4x4x4_16b_bf16 v[68:71], v[140:141], v[140:141], v[68:71]
    v_and_b32 v134, s53, v134
    v_mfma_f32_4x4x4_16b_bf16 v[64:67], v[28:29], v[142:143], v[64:67]
    v_lshlrev_b32 v39, 16, v135
    v_mfma_f32_4x4x4_16b_bf16 v[68:71], v[142:143], v[142:143], v[68:71]
    v_and_b32 v135, s53, v135
    v_lshlrev_b32 v40, 16, v136
    v_and_b32 v136, s53, v136
    buffer_load_dword v30, v30, s[84:87], 0 offen
    s_waitcnt vmcnt(9)
    ds_read_b128 v[160:163], v14 offset:8192
    ds_read_b128 v[164:167], v15 offset:8192
    ds_read_b128 v[168:171], v16 offset:8192
    ds_read_b128 v[172:175], v17 offset:8192
    s_waitcnt lgkmcnt(4)
    s_add_u32 m0, s37, 28672
    s_xor_b32 s48, s63, 640
    buffer_load_dwordx4 v10, s[4:7], s48 offen offset:0 lds
    v_mfma_f32_4x4x4_16b_bf16 v[64:67], v[28:29], v[144:145], v[64:67]
    v_lshlrev_b32 v41, 16, v137
    v_mfma_f32_4x4x4_16b_bf16 v[68:71], v[144:145], v[144:145], v[68:71]
    v_and_b32 v137, s53, v137
    v_mfma_f32_4x4x4_16b_bf16 v[64:67], v[28:29], v[146:147], v[64:67]
    v_lshlrev_b32 v42, 16, v138
    v_mfma_f32_4x4x4_16b_bf16 v[68:71], v[146:147], v[146:147], v[68:71]
    v_and_b32 v138, s53, v138
    v_lshlrev_b32 v43, 16, v139
    v_and_b32 v139, s53, v139
    buffer_load_dwordx4 v11, s[4:7], s48 offen offset:1024 lds
    v_mfma_f32_4x4x4_16b_bf16 v[64:67], v[28:29], v[148:149], v[64:67]
    v_lshlrev_b32 v44, 16, v144
    v_mfma_f32_4x4x4_16b_bf16 v[68:71], v[148:149], v[148:149], v[68:71]
    v_and_b32 v144, s53, v144
    v_mfma_f32_4x4x4_16b_bf16 v[64:67], v[28:29], v[150:151], v[64:67]
    v_lshlrev_b32 v45, 16, v145
    v_mfma_f32_4x4x4_16b_bf16 v[68:71], v[150:151], v[150:151], v[68:71]
    v_and_b32 v145, s53, v145
    v_lshlrev_b32 v46, 16, v146
    v_and_b32 v146, s53, v146
    buffer_load_dwordx4 v12, s[4:7], s48 offen offset:2048 lds
    v_mfma_f32_4x4x4_16b_bf16 v[64:67], v[28:29], v[152:153], v[64:67]
    v_lshlrev_b32 v47, 16, v147
    v_mfma_f32_4x4x4_16b_bf16 v[68:71], v[152:153], v[152:153], v[68:71]
    v_and_b32 v147, s53, v147
    v_mfma_f32_4x4x4_16b_bf16 v[64:67], v[28:29], v[154:155], v[64:67]
    v_lshlrev_b32 v48, 16, v148
    v_mfma_f32_4x4x4_16b_bf16 v[68:71], v[154:155], v[154:155], v[68:71]
    v_and_b32 v148, s53, v148
    v_lshlrev_b32 v49, 16, v149
    v_and_b32 v149, s53, v149
    buffer_load_dwordx4 v13, s[4:7], s48 offen offset:3072 lds
    v_mfma_f32_4x4x4_16b_bf16 v[64:67], v[28:29], v[156:157], v[64:67]
    v_lshlrev_b32 v50, 16, v150
    v_mfma_f32_4x4x4_16b_bf16 v[68:71], v[156:157], v[156:157], v[68:71]
    v_and_b32 v150, s53, v150
    v_mfma_f32_4x4x4_16b_bf16 v[64:67], v[28:29], v[158:159], v[64:67]
    v_lshlrev_b32 v51, 16, v151
    v_mfma_f32_4x4x4_16b_bf16 v[68:71], v[158:159], v[158:159], v[68:71]
    v_and_b32 v151, s53, v151
    v_lshlrev_b32 v52, 16, v152
    v_and_b32 v152, s53, v152
    s_waitcnt vmcnt(9)
    ds_read_b128 v[176:179], v14 offset:12288
    ds_read_b128 v[180:183], v15 offset:12288
    ds_read_b128 v[184:187], v16 offset:12288
    ds_read_b128 v[188:191], v17 offset:12288
    s_waitcnt lgkmcnt(4)
    s_add_u32 m0, s37, 32768
    s_xor_b32 s48, s63, 768
    buffer_load_dwordx4 v10, s[4:7], s48 offen offset:0 lds
    v_mfma_f32_4x4x4_16b_bf16 v[64:67], v[28:29], v[160:161], v[64:67]
    v_lshlrev_b32 v53, 16, v153
    v_mfma_f32_4x4x4_16b_bf16 v[68:71], v[160:161], v[160:161], v[68:71]
    v_and_b32 v153, s53, v153
    v_mfma_f32_4x4x4_16b_bf16 v[64:67], v[28:29], v[162:163], v[64:67]
    v_lshlrev_b32 v54, 16, v154
    v_mfma_f32_4x4x4_16b_bf16 v[68:71], v[162:163], v[162:163], v[68:71]
    v_and_b32 v154, s53, v154
    v_lshlrev_b32 v55, 16, v155
    v_and_b32 v155, s53, v155
    buffer_load_dwordx4 v11, s[4:7], s48 offen offset:1024 lds
    v_mfma_f32_4x4x4_16b_bf16 v[64:67], v[28:29], v[164:165], v[64:67]
    v_lshlrev_b32 v56, 16, v160
    v_mfma_f32_4x4x4_16b_bf16 v[68:71], v[164:165], v[164:165], v[68:71]
    v_and_b32 v160, s53, v160
    v_mfma_f32_4x4x4_16b_bf16 v[64:67], v[28:29], v[166:167], v[64:67]
    v_lshlrev_b32 v57, 16, v161
    v_mfma_f32_4x4x4_16b_bf16 v[68:71], v[166:167], v[166:167], v[68:71]
    v_and_b32 v161, s53, v161
    v_lshlrev_b32 v58, 16, v162
    v_and_b32 v162, s53, v162
    buffer_load_dwordx4 v12, s[4:7], s48 offen offset:2048 lds
    v_mfma_f32_4x4x4_16b_bf16 v[64:67], v[28:29], v[168:169], v[64:67]
    v_lshlrev_b32 v59, 16, v163
    v_mfma_f32_4x4x4_16b_bf16 v[68:71], v[168:169], v[168:169], v[68:71]
    v_and_b32 v163, s53, v163
    v_mfma_f32_4x4x4_16b_bf16 v[64:67], v[28:29], v[170:171], v[64:67]
    v_lshlrev_b32 v60, 16, v164
    v_mfma_f32_4x4x4_16b_bf16 v[68:71], v[170:171], v[170:171], v[68:71]
    v_and_b32 v164, s53, v164
    v_lshlrev_b32 v61, 16, v165
    v_and_b32 v165, s53, v165
    buffer_load_dwordx4 v13, s[4:7], s48 offen offset:3072 lds
    v_mfma_f32_4x4x4_16b_bf16 v[64:67], v[28:29], v[172:173], v[64:67]
    v_lshlrev_b32 v62, 16, v166
    v_mfma_f32_4x4x4_16b_bf16 v[68:71], v[172:173], v[172:173], v[68:71]
    v_and_b32 v166, s53, v166
    v_mfma_f32_4x4x4_16b_bf16 v[64:67], v[28:29], v[174:175], v[64:67]
    v_lshlrev_b32 v63, 16, v167
    v_mfma_f32_4x4x4_16b_bf16 v[68:71], v[174:175], v[174:175], v[68:71]
    v_and_b32 v167, s53, v167
    v_lshlrev_b32 v72, 16, v168
    v_and_b32 v168, s53, v168
    s_waitcnt vmcnt(9)
    ds_read_b128 v[192:195], v14 offset:16384
    ds_read_b128 v[196:199], v15 offset:16384
    ds_read_b128 v[200:203], v16 offset:16384
    ds_read_b128 v[204:207], v17 offset:16384
    s_waitcnt lgkmcnt(4)
    s_add_u32 m0, s37, 36864
    s_xor_b32 s48, s63, 896
    buffer_load_dwordx4 v10, s[4:7], s48 offen offset:0 lds
    v_mfma_f32_4x4x4_16b_bf16 v[64:67], v[28:29], v[176:177], v[64:67]
    v_lshlrev_b32 v73, 16, v169
    v_mfma_f32_4x4x4_16b_bf16 v[68:71], v[176:177], v[176:177], v[68:71]
    v_and_b32 v169, s53, v169
    v_mfma_f32_4x4x4_16b_bf16 v[64:67], v[28:29], v[178:179], v[64:67]
    v_lshlrev_b32 v74, 16, v170
    v_mfma_f32_4x4x4_16b_bf16 v[68:71], v[178:179], v[178:179], v[68:71]
    v_and_b32 v170, s53, v170
    v_lshlrev_b32 v75, 16, v171
    v_and_b32 v171, s53, v171
    buffer_load_dwordx4 v11, s[4:7], s48 offen offset:1024 lds
    v_mfma_f32_4x4x4_16b_bf16 v[64:67], v[28:29], v[180:181], v[64:67]
    v_lshlrev_b32 v76, 16, v176
    v_mfma_f32_4x4x4_16b_bf16 v[68:71], v[180:181], v[180:181], v[68:71]
    v_and_b32 v176, s53, v176
    v_mfma_f32_4x4x4_16b_bf16 v[64:67], v[28:29], v[182:183], v[64:67]
    v_lshlrev_b32 v77, 16, v177
    v_mfma_f32_4x4x4_16b_bf16 v[68:71], v[182:183], v[182:183], v[68:71]
    v_and_b32 v177, s53, v177
    v_lshlrev_b32 v78, 16, v178
    v_and_b32 v178, s53, v178
    buffer_load_dwordx4 v12, s[4:7], s48 offen offset:2048 lds
    v_mfma_f32_4x4x4_16b_bf16 v[64:67], v[28:29], v[184:185], v[64:67]
    v_lshlrev_b32 v79, 16, v179
    v_mfma_f32_4x4x4_16b_bf16 v[68:71], v[184:185], v[184:185], v[68:71]
    v_and_b32 v179, s53, v179
    v_mfma_f32_4x4x4_16b_bf16 v[64:67], v[28:29], v[186:187], v[64:67]
    v_lshlrev_b32 v80, 16, v180
    v_mfma_f32_4x4x4_16b_bf16 v[68:71], v[186:187], v[186:187], v[68:71]
    v_and_b32 v180, s53, v180
    v_lshlrev_b32 v81, 16, v181
    v_and_b32 v181, s53, v181
    buffer_load_dwordx4 v13, s[4:7], s48 offen offset:3072 lds
    v_mfma_f32_4x4x4_16b_bf16 v[64:67], v[28:29], v[188:189], v[64:67]
    v_lshlrev_b32 v82, 16, v182
    v_mfma_f32_4x4x4_16b_bf16 v[68:71], v[188:189], v[188:189], v[68:71]
    v_and_b32 v182, s53, v182
    v_mfma_f32_4x4x4_16b_bf16 v[64:67], v[28:29], v[190:191], v[64:67]
    v_lshlrev_b32 v83, 16, v183
    v_mfma_f32_4x4x4_16b_bf16 v[68:71], v[190:191], v[190:191], v[68:71]
    v_and_b32 v183, s53, v183
    v_lshlrev_b32 v84, 16, v184
    v_and_b32 v184, s53, v184
    s_waitcnt vmcnt(8)
    ds_read_b128 v[208:211], v14 offset:20480
    ds_read_b128 v[212:215], v15 offset:20480
    ds_read_b128 v[216:219], v16 offset:20480
    ds_read_b128 v[220:223], v17 offset:20480
    s_waitcnt lgkmcnt(4)
    s_add_u32 m0, s37, 0
    s_nop 0
    buffer_load_dwordx4 v4, s[8:11], s40 offen lds
    v_mfma_f32_4x4x4_16b_bf16 v[64:67], v[28:29], v[192:193], v[64:67]
    v_lshlrev_b32 v85, 16, v185
    v_mfma_f32_4x4x4_16b_bf16 v[68:71], v[192:193], v[192:193], v[68:71]
    v_and_b32 v185, s53, v185
    v_mfma_f32_4x4x4_16b_bf16 v[64:67], v[28:29], v[194:195], v[64:67]
    v_lshlrev_b32 v86, 16, v186
    v_mfma_f32_4x4x4_16b_bf16 v[68:71], v[194:195], v[194:195], v[68:71]
    v_and_b32 v186, s53, v186
    v_lshlrev_b32 v87, 16, v187
    v_and_b32 v187, s53, v187
    s_add_u32 m0, s37, 8192
    s_nop 0
    buffer_load_dwordx4 v5, s[8:11], s40 offen lds
    v_mfma_f32_4x4x4_16b_bf16 v[64:67], v[28:29], v[196:197], v[64:67]
    v_lshlrev_b32 v88, 16, v192
    v_mfma_f32_4x4x4_16b_bf16 v[68:71], v[196:197], v[196:197], v[68:71]
    v_and_b32 v192, s53, v192
    v_mfma_f32_4x4x4_16b_bf16 v[64:67], v[28:29], v[198:199], v[64:67]
    v_lshlrev_b32 v89, 16, v193
    v_mfma_f32_4x4x4_16b_bf16 v[68:71], v[198:199], v[198:199], v[68:71]
    v_and_b32 v193, s53, v193
    v_lshlrev_b32 v90, 16, v194
    v_and_b32 v194, s53, v194
    s_add_u32 m0, s37, 1024
    s_nop 0
    buffer_load_dwordx4 v4, s[8:11], s41 offen lds
    v_mfma_f32_4x4x4_16b_bf16 v[64:67], v[28:29], v[200:201], v[64:67]
    v_lshlrev_b32 v91, 16, v195
    v_mfma_f32_4x4x4_16b_bf16 v[68:71], v[200:201], v[200:201], v[68:71]
    v_and_b32 v195, s53, v195
    v_mfma_f32_4x4x4_16b_bf16 v[64:67], v[28:29], v[202:203], v[64:67]
    v_lshlrev_b32 v92, 16, v196
    v_mfma_f32_4x4x4_16b_bf16 v[68:71], v[202:203], v[202:203], v[68:71]
    v_and_b32 v196, s53, v196
    v_lshlrev_b32 v93, 16, v197
    v_and_b32 v197, s53, v197
    s_add_u32 m0, s37, 9216
    s_nop 0
    buffer_load_dwordx4 v5, s[8:11], s41 offen lds
    v_mfma_f32_4x4x4_16b_bf16 v[64:67], v[28:29], v[204:205], v[64:67]
    v_lshlrev_b32 v94, 16, v198
    v_mfma_f32_4x4x4_16b_bf16 v[68:71], v[204:205], v[204:205], v[68:71]
    v_and_b32 v198, s53, v198
    v_mfma_f32_4x4x4_16b_bf16 v[64:67], v[28:29], v[206:207], v[64:67]
    v_lshlrev_b32 v95, 16, v199
    v_mfma_f32_4x4x4_16b_bf16 v[68:71], v[206:207], v[206:207], v[68:71]
    v_and_b32 v199, s53, v199
    v_lshlrev_b32 v96, 16, v200
    v_and_b32 v200, s53, v200
    s_waitcnt vmcnt(8)
    ds_read_b128 v[224:227], v14 offset:24576
    ds_read_b128 v[228:231], v15 offset:24576
    ds_read_b128 v[232:235], v16 offset:24576
    ds_read_b128 v[236:239], v17 offset:24576
    s_waitcnt lgkmcnt(4)
    s_add_u32 m0, s37, 2048
    s_nop 0
    buffer_load_dwordx4 v4, s[8:11], s42 offen lds
    v_mfma_f32_4x4x4_16b_bf16 v[64:67], v[28:29], v[208:209], v[64:67]
    v_lshlrev_b32 v97, 16, v201
    v_mfma_f32_4x4x4_16b_bf16 v[68:71], v[208:209], v[208:209], v[68:71]
    v_and_b32 v201, s53, v201
    v_mfma_f32_4x4x4_16b_bf16 v[64:67], v[28:29], v[210:211], v[64:67]
    v_lshlrev_b32 v98, 16, v202
    v_mfma_f32_4x4x4_16b_bf16 v[68:71], v[210:211], v[210:211], v[68:71]
    v_and_b32 v202, s53, v202
    v_lshlrev_b32 v99, 16, v203
    v_and_b32 v203, s53, v203
    s_add_u32 m0, s37, 10240
    s_nop 0
    buffer_load_dwordx4 v5, s[8:11], s42 offen lds
    v_mfma_f32_4x4x4_16b_bf16 v[64:67], v[28:29], v[212:213], v[64:67]
    v_lshlrev_b32 v100, 16, v208
    v_mfma_f32_4x4x4_16b_bf16 v[68:71], v[212:213], v[212:213], v[68:71]
    v_and_b32 v208, s53, v208
    v_mfma_f32_4x4x4_16b_bf16 v[64:67], v[28:29], v[214:215], v[64:67]
    v_lshlrev_b32 v101, 16, v209
    v_mfma_f32_4x4x4_16b_bf16 v[68:71], v[214:215], v[214:215], v[68:71]
    v_and_b32 v209, s53, v209
    v_lshlrev_b32 v102, 16, v210
    v_and_b32 v210, s53, v210
    s_add_u32 m0, s37, 3072
    s_nop 0
    buffer_load_dwordx4 v4, s[8:11], s43 offen lds
    v_mfma_f32_4x4x4_16b_bf16 v[64:67], v[28:29], v[216:217], v[64:67]
    v_lshlrev_b32 v103, 16, v211
    v_mfma_f32_4x4x4_16b_bf16 v[68:71], v[216:217], v[216:217], v[68:71]
    v_and_b32 v211, s53, v211
    v_mfma_f32_4x4x4_16b_bf16 v[64:67], v[28:29], v[218:219], v[64:67]
    v_lshlrev_b32 v104, 16, v212
    v_mfma_f32_4x4x4_16b_bf16 v[68:71], v[218:219], v[218:219], v[68:71]
    v_and_b32 v212, s53, v212
    v_lshlrev_b32 v105, 16, v213
    v_and_b32 v213, s53, v213
    s_add_u32 m0, s37, 11264
    s_nop 0
    buffer_load_dwordx4 v5, s[8:11], s43 offen lds
    v_mfma_f32_4x4x4_16b_bf16 v[64:67], v[28:29], v[220:221], v[64:67]
    v_lshlrev_b32 v106, 16, v214
    v_mfma_f32_4x4x4_16b_bf16 v[68:71], v[220:221], v[220:221], v[68:71]
    v_and_b32 v214, s53, v214
    v_mfma_f32_4x4x4_16b_bf16 v[64:67], v[28:29], v[222:223], v[64:67]
    v_lshlrev_b32 v107, 16, v215
    v_mfma_f32_4x4x4_16b_bf16 v[68:71], v[222:223], v[222:223], v[68:71]
    v_and_b32 v215, s53, v215
    v_lshlrev_b32 v108, 16, v216
    v_and_b32 v216, s53, v216
    s_waitcnt vmcnt(8)
    ds_read_b128 v[240:243], v14 offset:28672
    ds_read_b128 v[244:247], v15 offset:28672
    ds_read_b128 v[248:251], v16 offset:28672
    ds_read_b128 v[252:255], v17 offset:28672
    s_waitcnt lgkmcnt(4)
    s_add_u32 m0, s37, 4096
    s_nop 0
    buffer_load_dwordx4 v4, s[8:11], s44 offen lds
    v_mfma_f32_4x4x4_16b_bf16 v[64:67], v[28:29], v[224:225], v[64:67]
    v_lshlrev_b32 v109, 16, v217
    v_mfma_f32_4x4x4_16b_bf16 v[68:71], v[224:225], v[224:225], v[68:71]
    v_and_b32 v217, s53, v217
    v_mfma_f32_4x4x4_16b_bf16 v[64:67], v[28:29], v[226:227], v[64:67]
    v_lshlrev_b32 v110, 16, v218
    v_mfma_f32_4x4x4_16b_bf16 v[68:71], v[226:227], v[226:227], v[68:71]
    v_and_b32 v218, s53, v218
    v_lshlrev_b32 v111, 16, v219
    v_and_b32 v219, s53, v219
    s_add_u32 m0, s37, 12288
    s_nop 0
    buffer_load_dwordx4 v5, s[8:11], s44 offen lds
    v_mfma_f32_4x4x4_16b_bf16 v[64:67], v[28:29], v[228:229], v[64:67]
    v_lshlrev_b32 v112, 16, v224
    v_mfma_f32_4x4x4_16b_bf16 v[68:71], v[228:229], v[228:229], v[68:71]
    v_and_b32 v224, s53, v224
    v_mfma_f32_4x4x4_16b_bf16 v[64:67], v[28:29], v[230:231], v[64:67]
    v_lshlrev_b32 v113, 16, v225
    v_mfma_f32_4x4x4_16b_bf16 v[68:71], v[230:231], v[230:231], v[68:71]
    v_and_b32 v225, s53, v225
    v_lshlrev_b32 v114, 16, v226
    v_and_b32 v226, s53, v226
    s_add_u32 m0, s37, 5120
    s_nop 0
    buffer_load_dwordx4 v4, s[8:11], s45 offen lds
    v_mfma_f32_4x4x4_16b_bf16 v[64:67], v[28:29], v[232:233], v[64:67]
    v_lshlrev_b32 v115, 16, v227
    v_mfma_f32_4x4x4_16b_bf16 v[68:71], v[232:233], v[232:233], v[68:71]
    v_and_b32 v227, s53, v227
    v_mfma_f32_4x4x4_16b_bf16 v[64:67], v[28:29], v[234:235], v[64:67]
    v_lshlrev_b32 v116, 16, v228
    v_mfma_f32_4x4x4_16b_bf16 v[68:71], v[234:235], v[234:235], v[68:71]
    v_and_b32 v228, s53, v228
    v_lshlrev_b32 v117, 16, v229
    v_and_b32 v229, s53, v229
    s_add_u32 m0, s37, 13312
    s_nop 0
    buffer_load_dwordx4 v5, s[8:11], s45 offen lds
    v_mfma_f32_4x4x4_16b_bf16 v[64:67], v[28:29], v[236:237], v[64:67]
    v_lshlrev_b32 v118, 16, v230
    v_mfma_f32_4x4x4_16b_bf16 v[68:71], v[236:237], v[236:237], v[68:71]
    v_and_b32 v230, s53, v230
    v_mfma_f32_4x4x4_16b_bf16 v[64:67], v[28:29], v[238:239], v[64:67]
    v_lshlrev_b32 v119, 16, v231
    v_mfma_f32_4x4x4_16b_bf16 v[68:71], v[238:239], v[238:239], v[68:71]
    v_and_b32 v231, s53, v231
    v_lshlrev_b32 v120, 16, v232
    v_and_b32 v232, s53, v232
    s_waitcnt lgkmcnt(0)
    v_mfma_f32_4x4x4_16b_bf16 v[64:67], v[28:29], v[240:241], v[64:67]
    v_lshlrev_b32 v121, 16, v233
    v_mfma_f32_4x4x4_16b_bf16 v[68:71], v[240:241], v[240:241], v[68:71]
    v_and_b32 v233, s53, v233
    v_mfma_f32_4x4x4_16b_bf16 v[64:67], v[28:29], v[242:243], v[64:67]
    v_lshlrev_b32 v122, 16, v234
    v_mfma_f32_4x4x4_16b_bf16 v[68:71], v[242:243], v[242:243], v[68:71]
    v_and_b32 v234, s53, v234
    v_lshlrev_b32 v123, 16, v235
    v_and_b32 v235, s53, v235
    v_mfma_f32_4x4x4_16b_bf16 v[64:67], v[28:29], v[244:245], v[64:67]
    s_nop 0
    v_mfma_f32_4x4x4_16b_bf16 v[68:71], v[244:245], v[244:245], v[68:71]
    s_nop 0
    v_mfma_f32_4x4x4_16b_bf16 v[64:67], v[28:29], v[246:247], v[64:67]
    s_nop 0
    v_mfma_f32_4x4x4_16b_bf16 v[68:71], v[246:247], v[246:247], v[68:71]
    s_nop 0
    v_mfma_f32_4x4x4_16b_bf16 v[64:67], v[28:29], v[248:249], v[64:67]
    s_nop 0
    v_mfma_f32_4x4x4_16b_bf16 v[68:71], v[248:249], v[248:249], v[68:71]
    s_nop 0
    v_mfma_f32_4x4x4_16b_bf16 v[64:67], v[28:29], v[250:251], v[64:67]
    s_nop 0
    v_mfma_f32_4x4x4_16b_bf16 v[68:71], v[250:251], v[250:251], v[68:71]
    s_nop 0
    v_mfma_f32_4x4x4_16b_bf16 v[64:67], v[28:29], v[252:253], v[64:67]
    s_nop 0
    v_mfma_f32_4x4x4_16b_bf16 v[68:71], v[252:253], v[252:253], v[68:71]
    s_nop 0
    v_mfma_f32_4x4x4_16b_bf16 v[64:67], v[28:29], v[254:255], v[64:67]
    s_nop 0
    v_mfma_f32_4x4x4_16b_bf16 v[68:71], v[254:255], v[254:255], v[68:71]
    s_nop 0
    s_nop 2
    s_mov_b32 vcc_lo, 0xaaaaaaaa
    s_mov_b32 vcc_hi, 0xaaaaaaaa
    s_mov_b32 s50, 0xcccccccc
    s_mov_b32 s51, 0xcccccccc
    v_cndmask_b32 v68, v68, v69, vcc
    v_cndmask_b32 v70, v70, v71, vcc
    v_cndmask_b32 v68, v68, v70, s[50:51]
    v_mov_b32 v65, v64
    v_mov_b32 v69, v68
    s_nop 0
    v_permlane32_swap_b32 v64, v65
    v_permlane32_swap_b32 v68, v69
    v_add_f32 v64, v64, v65
    v_add_f32 v68, v68, v69
    v_mul_f32 v64, 0x3b000000, v64
    v_mul_f32 v68, 0x3b000000, v68
    v_fma_f32 v68, -v64, v64, v68
    v_max_f32 v68, 0, v68
    v_add_f32 v68, 0x3727c5ac, v68
    v_rsq_f32 v68, v68
    s_nop 0
    v_mul_f32 v24, 0x3fb8aa3b, v68
    v_mul_f32_e64 v25, -v64, v24
.p2align 3
    s_add_u32 m0, s37, 6144
    v_lshlrev_b32 v124, 16, v140
    v_and_b32 v140, s53, v140
    v_lshlrev_b32 v125, 16, v141
    v_and_b32 v141, s53, v141
    v_lshlrev_b32 v126, 16, v142
    v_and_b32 v142, s53, v142
    v_lshlrev_b32 v127, 16, v143
    v_and_b32 v143, s53, v143
    v_pk_fma_f32 v[124:125], v[124:125], v[24:25], v[24:25] op_sel:[0,0,1] op_sel_hi:[1,0,1]
    v_pk_fma_f32 v[140:141], v[140:141], v[24:25], v[24:25] op_sel:[0,0,1] op_sel_hi:[1,0,1]
    v_pk_fma_f32 v[126:127], v[126:127], v[24:25], v[24:25] op_sel:[0,0,1] op_sel_hi:[1,0,1]
    v_pk_fma_f32 v[142:143], v[142:143], v[24:25], v[24:25] op_sel:[0,0,1] op_sel_hi:[1,0,1]
    buffer_load_dwordx4 v4, s[8:11], s46 offen lds
    v_cvt_pk_bf16_f32 v140, v124, v140
    v_cvt_pk_bf16_f32 v141, v125, v141
    v_cvt_pk_bf16_f32 v142, v126, v142
    v_cvt_pk_bf16_f32 v143, v127, v143
    s_add_u32 m0, s37, 14336
    v_lshlrev_b32 v124, 16, v156
    v_and_b32 v156, s53, v156
    v_lshlrev_b32 v125, 16, v157
    v_and_b32 v157, s53, v157
    v_lshlrev_b32 v126, 16, v158
    v_and_b32 v158, s53, v158
    v_lshlrev_b32 v127, 16, v159
    v_and_b32 v159, s53, v159
    v_pk_fma_f32 v[124:125], v[124:125], v[24:25], v[24:25] op_sel:[0,0,1] op_sel_hi:[1,0,1]
    v_pk_fma_f32 v[156:157], v[156:157], v[24:25], v[24:25] op_sel:[0,0,1] op_sel_hi:[1,0,1]
    v_pk_fma_f32 v[126:127], v[126:127], v[24:25], v[24:25] op_sel:[0,0,1] op_sel_hi:[1,0,1]
    v_pk_fma_f32 v[158:159], v[158:159], v[24:25], v[24:25] op_sel:[0,0,1] op_sel_hi:[1,0,1]
    buffer_load_dwordx4 v5, s[8:11], s46 offen lds
    v_cvt_pk_bf16_f32 v156, v124, v156
    v_cvt_pk_bf16_f32 v157, v125, v157
    v_cvt_pk_bf16_f32 v158, v126, v158
    v_cvt_pk_bf16_f32 v159, v127, v159
    s_add_u32 m0, s37, 7168
    v_lshlrev_b32 v124, 16, v172
    v_and_b32 v172, s53, v172
    v_lshlrev_b32 v125, 16, v173
    v_and_b32 v173, s53, v173
    v_lshlrev_b32 v126, 16, v174
    v_and_b32 v174, s53, v174
    v_lshlrev_b32 v127, 16, v175
    v_and_b32 v175, s53, v175
    v_pk_fma_f32 v[124:125], v[124:125], v[24:25], v[24:25] op_sel:[0,0,1] op_sel_hi:[1,0,1]
    v_pk_fma_f32 v[172:173], v[172:173], v[24:25], v[24:25] op_sel:[0,0,1] op_sel_hi:[1,0,1]
    v_pk_fma_f32 v[126:127], v[126:127], v[24:25], v[24:25] op_sel:[0,0,1] op_sel_hi:[1,0,1]
    v_pk_fma_f32 v[174:175], v[174:175], v[24:25], v[24:25] op_sel:[0,0,1] op_sel_hi:[1,0,1]
    buffer_load_dwordx4 v4, s[8:11], s47 offen lds
    v_cvt_pk_bf16_f32 v172, v124, v172
    v_cvt_pk_bf16_f32 v173, v125, v173
    v_cvt_pk_bf16_f32 v174, v126, v174
    v_cvt_pk_bf16_f32 v175, v127, v175
    s_add_u32 m0, s37, 15360
    v_lshlrev_b32 v124, 16, v188
    v_and_b32 v188, s53, v188
    v_lshlrev_b32 v125, 16, v189
    v_and_b32 v189, s53, v189
    v_lshlrev_b32 v126, 16, v190
    v_and_b32 v190, s53, v190
    v_lshlrev_b32 v127, 16, v191
    v_and_b32 v191, s53, v191
    v_pk_fma_f32 v[124:125], v[124:125], v[24:25], v[24:25] op_sel:[0,0,1] op_sel_hi:[1,0,1]
    v_pk_fma_f32 v[188:189], v[188:189], v[24:25], v[24:25] op_sel:[0,0,1] op_sel_hi:[1,0,1]
    v_pk_fma_f32 v[126:127], v[126:127], v[24:25], v[24:25] op_sel:[0,0,1] op_sel_hi:[1,0,1]
    v_pk_fma_f32 v[190:191], v[190:191], v[24:25], v[24:25] op_sel:[0,0,1] op_sel_hi:[1,0,1]
    buffer_load_dwordx4 v5, s[8:11], s47 offen lds
    v_cvt_pk_bf16_f32 v188, v124, v188
    v_cvt_pk_bf16_f32 v189, v125, v189
    v_cvt_pk_bf16_f32 v190, v126, v190
    v_cvt_pk_bf16_f32 v191, v127, v191
    v_add_u32 v4, s55, v4
    v_add_u32 v5, s55, v5
    s_cmp_lt_u32 s3, 2
    s_cselect_b32 s62, 1073741824, 0
    v_or_b32 v23, s62, v23
    buffer_load_dword v23, v23, s[84:87], 0 offen
    v_lshlrev_b32 v124, 16, v204
    v_and_b32 v204, s53, v204
    v_lshlrev_b32 v125, 16, v205
    v_and_b32 v205, s53, v205
    v_lshlrev_b32 v126, 16, v206
    v_and_b32 v206, s53, v206
    v_lshlrev_b32 v127, 16, v207
    v_and_b32 v207, s53, v207
    v_pk_fma_f32 v[124:125], v[124:125], v[24:25], v[24:25] op_sel:[0,0,1] op_sel_hi:[1,0,1]
    v_pk_fma_f32 v[204:205], v[204:205], v[24:25], v[24:25] op_sel:[0,0,1] op_sel_hi:[1,0,1]
    v_pk_fma_f32 v[126:127], v[126:127], v[24:25], v[24:25] op_sel:[0,0,1] op_sel_hi:[1,0,1]
    v_pk_fma_f32 v[206:207], v[206:207], v[24:25], v[24:25] op_sel:[0,0,1] op_sel_hi:[1,0,1]
    v_cvt_pk_bf16_f32 v204, v124, v204
    v_cvt_pk_bf16_f32 v205, v125, v205
    v_cvt_pk_bf16_f32 v206, v126, v206
    v_cvt_pk_bf16_f32 v207, v127, v207
    v_lshlrev_b32 v124, 16, v220
    v_and_b32 v220, s53, v220
    v_lshlrev_b32 v125, 16, v221
    v_and_b32 v221, s53, v221
    v_lshlrev_b32 v126, 16, v222
    v_and_b32 v222, s53, v222
    v_lshlrev_b32 v127, 16, v223
    v_and_b32 v223, s53, v223
    v_pk_fma_f32 v[124:125], v[124:125], v[24:25], v[24:25] op_sel:[0,0,1] op_sel_hi:[1,0,1]
    v_pk_fma_f32 v[220:221], v[220:221], v[24:25], v[24:25] op_sel:[0,0,1] op_sel_hi:[1,0,1]
    v_pk_fma_f32 v[126:127], v[126:127], v[24:25], v[24:25] op_sel:[0,0,1] op_sel_hi:[1,0,1]
    v_pk_fma_f32 v[222:223], v[222:223], v[24:25], v[24:25] op_sel:[0,0,1] op_sel_hi:[1,0,1]
    v_cvt_pk_bf16_f32 v220, v124, v220
    v_cvt_pk_bf16_f32 v221, v125, v221
    v_cvt_pk_bf16_f32 v222, v126, v222
    v_cvt_pk_bf16_f32 v223, v127, v223
    v_lshlrev_b32 v124, 16, v236
    v_and_b32 v236, s53, v236
    v_lshlrev_b32 v125, 16, v237
    v_and_b32 v237, s53, v237
    v_lshlrev_b32 v126, 16, v238
    v_and_b32 v238, s53, v238
    v_lshlrev_b32 v127, 16, v239
    v_and_b32 v239, s53, v239
    v_pk_fma_f32 v[124:125], v[124:125], v[24:25], v[24:25] op_sel:[0,0,1] op_sel_hi:[1,0,1]
    v_pk_fma_f32 v[236:237], v[236:237], v[24:25], v[24:25] op_sel:[0,0,1] op_sel_hi:[1,0,1]
    v_pk_fma_f32 v[126:127], v[126:127], v[24:25], v[24:25] op_sel:[0,0,1] op_sel_hi:[1,0,1]
    v_pk_fma_f32 v[238:239], v[238:239], v[24:25], v[24:25] op_sel:[0,0,1] op_sel_hi:[1,0,1]
    v_cvt_pk_bf16_f32 v236, v124, v236
    v_cvt_pk_bf16_f32 v237, v125, v237
    v_cvt_pk_bf16_f32 v238, v126, v238
    v_cvt_pk_bf16_f32 v239, v127, v239
    s_add_u32 m0, s37, 16384
    v_lshlrev_b32 v124, 16, v240
    v_and_b32 v240, s53, v240
    v_lshlrev_b32 v125, 16, v241
    v_and_b32 v241, s53, v241
    v_lshlrev_b32 v126, 16, v242
    v_and_b32 v242, s53, v242
    v_lshlrev_b32 v127, 16, v243
    v_and_b32 v243, s53, v243
    v_pk_fma_f32 v[124:125], v[124:125], v[24:25], v[24:25] op_sel:[0,0,1] op_sel_hi:[1,0,1]
    v_pk_fma_f32 v[240:241], v[240:241], v[24:25], v[24:25] op_sel:[0,0,1] op_sel_hi:[1,0,1]
    v_pk_fma_f32 v[126:127], v[126:127], v[24:25], v[24:25] op_sel:[0,0,1] op_sel_hi:[1,0,1]
    v_pk_fma_f32 v[242:243], v[242:243], v[24:25], v[24:25] op_sel:[0,0,1] op_sel_hi:[1,0,1]
    buffer_load_dwordx4 v4, s[8:11], s40 offen lds
    v_cvt_pk_bf16_f32 v240, v124, v240
    v_cvt_pk_bf16_f32 v241, v125, v241
    v_cvt_pk_bf16_f32 v242, v126, v242
    v_cvt_pk_bf16_f32 v243, v127, v243
    v_lshlrev_b32 v124, 16, v244
    v_and_b32 v244, s53, v244
    v_lshlrev_b32 v125, 16, v245
    v_and_b32 v245, s53, v245
    v_lshlrev_b32 v126, 16, v246
    v_and_b32 v246, s53, v246
    v_lshlrev_b32 v127, 16, v247
    v_and_b32 v247, s53, v247
    v_pk_fma_f32 v[124:125], v[124:125], v[24:25], v[24:25] op_sel:[0,0,1] op_sel_hi:[1,0,1]
    v_pk_fma_f32 v[244:245], v[244:245], v[24:25], v[24:25] op_sel:[0,0,1] op_sel_hi:[1,0,1]
    v_pk_fma_f32 v[126:127], v[126:127], v[24:25], v[24:25] op_sel:[0,0,1] op_sel_hi:[1,0,1]
    v_pk_fma_f32 v[246:247], v[246:247], v[24:25], v[24:25] op_sel:[0,0,1] op_sel_hi:[1,0,1]
    v_cvt_pk_bf16_f32 v244, v124, v244
    v_cvt_pk_bf16_f32 v245, v125, v245
    v_cvt_pk_bf16_f32 v246, v126, v246
    v_cvt_pk_bf16_f32 v247, v127, v247
    s_add_u32 m0, s37, 24576
    v_lshlrev_b32 v124, 16, v248
    v_and_b32 v248, s53, v248
    v_lshlrev_b32 v125, 16, v249
    v_and_b32 v249, s53, v249
    v_lshlrev_b32 v126, 16, v250
    v_and_b32 v250, s53, v250
    v_lshlrev_b32 v127, 16, v251
    v_and_b32 v251, s53, v251
    v_pk_fma_f32 v[124:125], v[124:125], v[24:25], v[24:25] op_sel:[0,0,1] op_sel_hi:[1,0,1]
    v_pk_fma_f32 v[248:249], v[248:249], v[24:25], v[24:25] op_sel:[0,0,1] op_sel_hi:[1,0,1]
    v_pk_fma_f32 v[126:127], v[126:127], v[24:25], v[24:25] op_sel:[0,0,1] op_sel_hi:[1,0,1]
    v_pk_fma_f32 v[250:251], v[250:251], v[24:25], v[24:25] op_sel:[0,0,1] op_sel_hi:[1,0,1]
    buffer_load_dwordx4 v5, s[8:11], s40 offen lds
    v_cvt_pk_bf16_f32 v248, v124, v248
    v_cvt_pk_bf16_f32 v249, v125, v249
    v_cvt_pk_bf16_f32 v250, v126, v250
    v_cvt_pk_bf16_f32 v251, v127, v251
    v_pk_fma_f32 v[32:33], v[32:33], v[24:25], v[24:25] op_sel:[0,0,1] op_sel_hi:[1,0,1]
    v_pk_fma_f32 v[128:129], v[128:129], v[24:25], v[24:25] op_sel:[0,0,1] op_sel_hi:[1,0,1]
    v_pk_fma_f32 v[34:35], v[34:35], v[24:25], v[24:25] op_sel:[0,0,1] op_sel_hi:[1,0,1]
    v_pk_fma_f32 v[130:131], v[130:131], v[24:25], v[24:25] op_sel:[0,0,1] op_sel_hi:[1,0,1]
    v_cvt_pk_bf16_f32 v128, v32, v128
    v_cvt_pk_bf16_f32 v129, v33, v129
    v_cvt_pk_bf16_f32 v130, v34, v130
    v_cvt_pk_bf16_f32 v131, v35, v131
    s_add_u32 m0, s37, 17408
    v_pk_fma_f32 v[36:37], v[36:37], v[24:25], v[24:25] op_sel:[0,0,1] op_sel_hi:[1,0,1]
    v_pk_fma_f32 v[132:133], v[132:133], v[24:25], v[24:25] op_sel:[0,0,1] op_sel_hi:[1,0,1]
    v_pk_fma_f32 v[38:39], v[38:39], v[24:25], v[24:25] op_sel:[0,0,1] op_sel_hi:[1,0,1]
    v_pk_fma_f32 v[134:135], v[134:135], v[24:25], v[24:25] op_sel:[0,0,1] op_sel_hi:[1,0,1]
    buffer_load_dwordx4 v4, s[8:11], s41 offen lds
    v_cvt_pk_bf16_f32 v132, v36, v132
    v_cvt_pk_bf16_f32 v133, v37, v133
    v_cvt_pk_bf16_f32 v134, v38, v134
    v_cvt_pk_bf16_f32 v135, v39, v135
    v_pk_fma_f32 v[40:41], v[40:41], v[24:25], v[24:25] op_sel:[0,0,1] op_sel_hi:[1,0,1]
    v_pk_fma_f32 v[136:137], v[136:137], v[24:25], v[24:25] op_sel:[0,0,1] op_sel_hi:[1,0,1]
    v_pk_fma_f32 v[42:43], v[42:43], v[24:25], v[24:25] op_sel:[0,0,1] op_sel_hi:[1,0,1]
    v_pk_fma_f32 v[138:139], v[138:139], v[24:25], v[24:25] op_sel:[0,0,1] op_sel_hi:[1,0,1]
    v_cvt_pk_bf16_f32 v136, v40, v136
    v_cvt_pk_bf16_f32 v137, v41, v137
    v_cvt_pk_bf16_f32 v138, v42, v138
    v_cvt_pk_bf16_f32 v139, v43, v139
    s_add_u32 m0, s37, 25600
    v_pk_fma_f32 v[44:45], v[44:45], v[24:25], v[24:25] op_sel:[0,0,1] op_sel_hi:[1,0,1]
    v_pk_fma_f32 v[144:145], v[144:145], v[24:25], v[24:25] op_sel:[0,0,1] op_sel_hi:[1,0,1]
    v_pk_fma_f32 v[46:47], v[46:47], v[24:25], v[24:25] op_sel:[0,0,1] op_sel_hi:[1,0,1]
    v_pk_fma_f32 v[146:147], v[146:147], v[24:25], v[24:25] op_sel:[0,0,1] op_sel_hi:[1,0,1]
    buffer_load_dwordx4 v5, s[8:11], s41 offen lds
    v_cvt_pk_bf16_f32 v144, v44, v144
    v_cvt_pk_bf16_f32 v145, v45, v145
    v_cvt_pk_bf16_f32 v146, v46, v146
    v_cvt_pk_bf16_f32 v147, v47, v147
    v_pk_fma_f32 v[48:49], v[48:49], v[24:25], v[24:25] op_sel:[0,0,1] op_sel_hi:[1,0,1]
    v_pk_fma_f32 v[148:149], v[148:149], v[24:25], v[24:25] op_sel:[0,0,1] op_sel_hi:[1,0,1]
    v_pk_fma_f32 v[50:51], v[50:51], v[24:25], v[24:25] op_sel:[0,0,1] op_sel_hi:[1,0,1]
    v_pk_fma_f32 v[150:151], v[150:151], v[24:25], v[24:25] op_sel:[0,0,1] op_sel_hi:[1,0,1]
    v_cvt_pk_bf16_f32 v148, v48, v148
    v_cvt_pk_bf16_f32 v149, v49, v149
    v_cvt_pk_bf16_f32 v150, v50, v150
    v_cvt_pk_bf16_f32 v151, v51, v151
    s_add_u32 m0, s37, 18432
    v_pk_fma_f32 v[52:53], v[52:53], v[24:25], v[24:25] op_sel:[0,0,1] op_sel_hi:[1,0,1]
    v_pk_fma_f32 v[152:153], v[152:153], v[24:25], v[24:25] op_sel:[0,0,1] op_sel_hi:[1,0,1]
    v_pk_fma_f32 v[54:55], v[54:55], v[24:25], v[24:25] op_sel:[0,0,1] op_sel_hi:[1,0,1]
    v_pk_fma_f32 v[154:155], v[154:155], v[24:25], v[24:25] op_sel:[0,0,1] op_sel_hi:[1,0,1]
    buffer_load_dwordx4 v4, s[8:11], s42 offen lds
    v_cvt_pk_bf16_f32 v152, v52, v152
    v_cvt_pk_bf16_f32 v153, v53, v153
    v_cvt_pk_bf16_f32 v154, v54, v154
    v_cvt_pk_bf16_f32 v155, v55, v155
    v_pk_fma_f32 v[56:57], v[56:57], v[24:25], v[24:25] op_sel:[0,0,1] op_sel_hi:[1,0,1]
    v_pk_fma_f32 v[160:161], v[160:161], v[24:25], v[24:25] op_sel:[0,0,1] op_sel_hi:[1,0,1]
    v_pk_fma_f32 v[58:59], v[58:59], v[24:25], v[24:25] op_sel:[0,0,1] op_sel_hi:[1,0,1]
    v_pk_fma_f32 v[162:163], v[162:163], v[24:25], v[24:25] op_sel:[0,0,1] op_sel_hi:[1,0,1]
    v_cvt_pk_bf16_f32 v160, v56, v160
    v_cvt_pk_bf16_f32 v161, v57, v161
    v_cvt_pk_bf16_f32 v162, v58, v162
    v_cvt_pk_bf16_f32 v163, v59, v163
    s_add_u32 m0, s37, 26624
    v_pk_fma_f32 v[60:61], v[60:61], v[24:25], v[24:25] op_sel:[0,0,1] op_sel_hi:[1,0,1]
    v_pk_fma_f32 v[164:165], v[164:165], v[24:25], v[24:25] op_sel:[0,0,1] op_sel_hi:[1,0,1]
    v_pk_fma_f32 v[62:63], v[62:63], v[24:25], v[24:25] op_sel:[0,0,1] op_sel_hi:[1,0,1]
    v_pk_fma_f32 v[166:167], v[166:167], v[24:25], v[24:25] op_sel:[0,0,1] op_sel_hi:[1,0,1]
    buffer_load_dwordx4 v5, s[8:11], s42 offen lds
    v_cvt_pk_bf16_f32 v164, v60, v164
    v_cvt_pk_bf16_f32 v165, v61, v165
    v_cvt_pk_bf16_f32 v166, v62, v166
    v_cvt_pk_bf16_f32 v167, v63, v167
    global_load_dword v30, v18, s[0:1] sc1
    s_waitcnt vmcnt(8)
    s_barrier
    ds_read_b64_tr_b16 a[0:1], v6 offset:0
    ds_read_b64_tr_b16 a[2:3], v6 offset:256
    ds_read_b64_tr_b16 a[4:5], v6 offset:8192
    ds_read_b64_tr_b16 a[6:7], v6 offset:8448
    ds_read_b64_tr_b16 a[8:9], v6 offset:1024
    ds_read_b64_tr_b16 a[10:11], v6 offset:1280
    ds_read_b64_tr_b16 a[12:13], v6 offset:9216
    ds_read_b64_tr_b16 a[14:15], v6 offset:9472
    ds_read_b64_tr_b16 a[16:17], v6 offset:2048
    ds_read_b64_tr_b16 a[18:19], v6 offset:2304
    ds_read_b64_tr_b16 a[20:21], v6 offset:10240
    ds_read_b64_tr_b16 a[22:23], v6 offset:10496
    ds_read_b64_tr_b16 a[24:25], v6 offset:4096
    ds_read_b64_tr_b16 a[26:27], v6 offset:4352
    s_add_u32 s49, s33, s3
    s_and_b32 s49, s49, 2
    s_lshl2_add_u32 s49, s35, s49
    s_lshr_b32 s50, 85, s49
    s_and_b32 s50, s50, 3
    s_lshl_b32 s50, s50, 16
    s_add_u32 s52, s60, s50
    s_lshr_b32 s50, 170, s49
    s_and_b32 s50, s50, 3
    s_lshl_b32 s50, s50, 16
    s_add_u32 s63, s60, s50
    s_lshr_b32 s50, 0, s49
    s_and_b32 s50, s50, 3
    s_lshl_b32 s50, s50, 16
    s_add_u32 s60, s60, s50
    v_mov_b32 v10, v0
    v_add_u32 v11, 7168, v0
    v_add_u32 v12, 14336, v0
    v_add_u32 v13, 21504, v0
    v_add_u32 v14, 4096, v2
    v_add_u32 v15, 8192, v2
    v_add_u32 v16, 12288, v2
    v_add_u32 v17, 16384, v2
    s_cmp_eq_u32 s34, 0
    s_cbranch_scc1 L_attn
    s_waitcnt lgkmcnt(6)
    s_add_u32 m0, s37, 19456
    v_mfma_f32_32x32x16_bf16 v[32:47], a[0:3], v[128:131], 0
    buffer_load_dwordx4 v4, s[8:11], s43 offen lds
    ds_read_b64_tr_b16 a[28:29], v6 offset:12288
    ds_read_b64_tr_b16 a[30:31], v6 offset:12544
    v_mov_b32 v68, -1
    v_mov_b32 v69, -1
    v_mov_b32 v70, -1
    v_mov_b32 v71, -1
    v_mfma_f32_32x32x16_bf16 v[48:63], a[4:7], v[128:131], 0
    ds_read_b64_tr_b16 a[0:1], v6 offset:5120
    ds_read_b64_tr_b16 a[2:3], v6 offset:5376
    s_and_b32 s49, s33, 6
    s_lshr_b32 s49, 85, s49
    s_and_b32 s49, s49, 3
    s_cmp_eq_u32 s49, 2
    s_cselect_b32 s54, -2, 1
    s_lshl_b32 s54, s54, 7
    s_bitcmp0_b32 s33, 0
    s_cselect_b32 s55, 6, -1
    s_lshl_b32 s49, s49, 1
    s_sub_u32 s55, s55, s49
    s_lshl_b32 s55, s55, 6
    s_add_u32 m0, s37, 27648
    v_mfma_f32_32x32x16_bf16 v[32:47], a[8:11], v[132:135], v[32:47]
    buffer_load_dwordx4 v5, s[8:11], s43 offen lds
    ds_read_b64_tr_b16 a[4:5], v6 offset:13312
    ds_read_b64_tr_b16 a[6:7], v6 offset:13568
    v_fma_f32 v72, v72, v24, v25
    v_fma_f32 v168, v168, v24, v25
    v_fma_f32 v73, v73, v24, v25
    v_mfma_f32_32x32x16_bf16 v[48:63], a[12:15], v[132:135], v[48:63]
    buffer_store_dwordx4 v[68:71], v15, s[20:23], s28 offen offset:0 sc1
    ds_read_b64_tr_b16 a[8:9], v6 offset:6144
    ds_read_b64_tr_b16 a[10:11], v6 offset:6400
    s_waitcnt lgkmcnt(6)
    v_mfma_f32_32x32x16_bf16 v[32:47], a[16:19], v[136:139], v[32:47]
    ds_read_b64_tr_b16 a[12:13], v6 offset:14336
    ds_read_b64_tr_b16 a[14:15], v6 offset:14592
    v_fma_f32 v169, v169, v24, v25
    v_fma_f32 v74, v74, v24, v25
    v_fma_f32 v170, v170, v24, v25
    v_fma_f32 v75, v75, v24, v25
    v_fma_f32 v171, v171, v24, v25
    v_mfma_f32_32x32x16_bf16 v[48:63], a[20:23], v[136:139], v[48:63]
    ds_read_b64_tr_b16 a[16:17], v7 offset:0
    ds_read_b64_tr_b16 a[18:19], v7 offset:256
    v_cvt_pk_bf16_f32 v168, v72, v168
    v_cvt_pk_bf16_f32 v169, v73, v169
    v_cvt_pk_bf16_f32 v170, v74, v170
    v_cvt_pk_bf16_f32 v171, v75, v171
    v_fma_f32 v76, v76, v24, v25
    v_mfma_f32_32x32x16_bf16 v[32:47], a[24:27], v[144:147], v[32:47]
    ds_read_b64_tr_b16 a[20:21], v7 offset:8192
    ds_read_b64_tr_b16 a[22:23], v7 offset:8448
    v_fma_f32 v176, v176, v24, v25
    v_fma_f32 v77, v77, v24, v25
    v_fma_f32 v177, v177, v24, v25
    v_fma_f32 v78, v78, v24, v25
    s_add_u32 m0, s37, 20480
    v_mfma_f32_32x32x16_bf16 v[48:63], a[28:31], v[144:147], v[48:63]
    buffer_load_dwordx4 v4, s[8:11], s44 offen lds
    ds_read_b64_tr_b16 a[24:25], v7 offset:1024
    ds_read_b64_tr_b16 a[26:27], v7 offset:1280
    s_waitcnt lgkmcnt(6)
    v_fma_f32 v178, v178, v24, v25
    v_fma_f32 v79, v79, v24, v25
    v_mfma_f32_32x32x16_bf16 v[32:47], a[0:3], v[148:151], v[32:47]
    ds_read_b64_tr_b16 a[28:29], v7 offset:9216
    ds_read_b64_tr_b16 a[30:31], v7 offset:9472
    v_fma_f32 v179, v179, v24, v25
    v_cvt_pk_bf16_f32 v176, v76, v176
    v_cvt_pk_bf16_f32 v177, v77, v177
    v_cvt_pk_bf16_f32 v178, v78, v178
    s_add_u32 m0, s37, 28672
    v_mfma_f32_32x32x16_bf16 v[48:63], a[4:7], v[148:151], v[48:63]
    buffer_load_dwordx4 v5, s[8:11], s44 offen lds
    ds_read_b64_tr_b16 a[0:1], v6 offset:3072
    ds_read_b64_tr_b16 a[2:3], v6 offset:3328
    v_cvt_pk_bf16_f32 v179, v79, v179
    v_fma_f32 v80, v80, v24, v25
    v_fma_f32 v180, v180, v24, v25
    v_mfma_f32_32x32x16_bf16 v[32:47], a[8:11], v[152:155], v[32:47]
    ds_read_b64_tr_b16 a[4:5], v6 offset:11264
    ds_read_b64_tr_b16 a[6:7], v6 offset:11520
    v_fma_f32 v81, v81, v24, v25
    v_fma_f32 v181, v181, v24, v25
    v_fma_f32 v82, v82, v24, v25
    v_fma_f32 v182, v182, v24, v25
    s_add_u32 m0, s37, 21504
    v_mfma_f32_32x32x16_bf16 v[48:63], a[12:15], v[152:155], v[48:63]
    buffer_load_dwordx4 v4, s[8:11], s45 offen lds
    ds_read_b64_tr_b16 a[8:9], v6 offset:7168
    ds_read_b64_tr_b16 a[10:11], v6 offset:7424
    s_waitcnt lgkmcnt(6)
    v_fma_f32 v83, v83, v24, v25
    v_fma_f32 v183, v183, v24, v25
    v_mfma_f32_32x32x16_bf16 v[32:47], a[16:19], v[160:163], v[32:47]
    ds_read_b64_tr_b16 a[12:13], v6 offset:15360
    ds_read_b64_tr_b16 a[14:15], v6 offset:15616
    v_cvt_pk_bf16_f32 v180, v80, v180
    v_cvt_pk_bf16_f32 v181, v81, v181
    v_cvt_pk_bf16_f32 v182, v82, v182
    v_cvt_pk_bf16_f32 v183, v83, v183
    v_fma_f32 v84, v84, v24, v25
    v_mfma_f32_32x32x16_bf16 v[48:63], a[20:23], v[160:163], v[48:63]
    buffer_store_dwordx4 v[68:71], v15, s[20:23], s28 offen offset:1024 sc1
    ds_read_b64_tr_b16 a[16:17], v7 offset:3072
    ds_read_b64_tr_b16 a[18:19], v7 offset:3328
    v_mfma_f32_32x32x16_bf16 v[32:47], a[24:27], v[164:167], v[32:47]
    ds_read_b64_tr_b16 a[20:21], v7 offset:11264
    ds_read_b64_tr_b16 a[22:23], v7 offset:11520
    v_fma_f32 v184, v184, v24, v25
    v_fma_f32 v85, v85, v24, v25
    v_fma_f32 v185, v185, v24, v25
    v_fma_f32 v86, v86, v24, v25
    v_fma_f32 v186, v186, v24, v25
    v_mfma_f32_32x32x16_bf16 v[48:63], a[28:31], v[164:167], v[48:63]
    ds_read_b64_tr_b16 a[24:25], v7 offset:7168
    ds_read_b64_tr_b16 a[26:27], v7 offset:7424
    s_waitcnt lgkmcnt(6)
    v_fma_f32 v87, v87, v24, v25
    v_fma_f32 v187, v187, v24, v25
    v_cvt_pk_bf16_f32 v184, v84, v184
    s_add_u32 m0, s37, 29696
    v_mfma_f32_32x32x16_bf16 v[32:47], a[0:3], v[140:143], v[32:47]
    buffer_load_dwordx4 v5, s[8:11], s45 offen lds
    ds_read_b64_tr_b16 a[28:29], v7 offset:15360
    ds_read_b64_tr_b16 a[30:31], v7 offset:15616
    v_cvt_pk_bf16_f32 v185, v85, v185
    v_cvt_pk_bf16_f32 v186, v86, v186
    v_cvt_pk_bf16_f32 v187, v87, v187
    v_mfma_f32_32x32x16_bf16 v[48:63], a[4:7], v[140:143], v[48:63]
    ds_read_b64_tr_b16 a[0:1], v8 offset:3072
    ds_read_b64_tr_b16 a[2:3], v8 offset:3328
    v_fma_f32 v88, v88, v24, v25
    v_fma_f32 v192, v192, v24, v25
    v_fma_f32 v89, v89, v24, v25
    v_fma_f32 v193, v193, v24, v25
    s_add_u32 m0, s37, 22528
    v_mfma_f32_32x32x16_bf16 v[32:47], a[8:11], v[156:159], v[32:47]
    buffer_load_dwordx4 v4, s[8:11], s46 offen lds
    ds_read_b64_tr_b16 a[4:5], v8 offset:11264
    ds_read_b64_tr_b16 a[6:7], v8 offset:11520
    v_fma_f32 v90, v90, v24, v25
    v_fma_f32 v194, v194, v24, v25
    v_fma_f32 v91, v91, v24, v25
    v_mfma_f32_32x32x16_bf16 v[48:63], a[12:15], v[156:159], v[48:63]
    ds_read_b64_tr_b16 a[8:9], v8 offset:7168
    ds_read_b64_tr_b16 a[10:11], v8 offset:7424
    s_waitcnt lgkmcnt(6)
    v_fma_f32 v195, v195, v24, v25
    v_cvt_pk_bf16_f32 v192, v88, v192
    v_cvt_pk_bf16_f32 v193, v89, v193
    s_add_u32 m0, s37, 30720
    v_mfma_f32_32x32x16_bf16 v[32:47], a[16:19], v[172:175], v[32:47]
    buffer_load_dwordx4 v5, s[8:11], s46 offen lds
    ds_read_b64_tr_b16 a[12:13], v8 offset:15360
    ds_read_b64_tr_b16 a[14:15], v8 offset:15616
    v_cvt_pk_bf16_f32 v194, v90, v194
    v_cvt_pk_bf16_f32 v195, v91, v195
    v_fma_f32 v92, v92, v24, v25
    v_mfma_f32_32x32x16_bf16 v[48:63], a[20:23], v[172:175], v[48:63]
    ds_read_b64_tr_b16 a[16:17], v9 offset:3072
    ds_read_b64_tr_b16 a[18:19], v9 offset:3328
    v_fma_f32 v196, v196, v24, v25
    v_fma_f32 v93, v93, v24, v25
    v_fma_f32 v197, v197, v24, v25
    v_fma_f32 v94, v94, v24, v25
    s_add_u32 m0, s37, 23552
    v_mfma_f32_32x32x16_bf16 v[32:47], a[24:27], v[188:191], v[32:47]
    buffer_load_dwordx4 v4, s[8:11], s47 offen lds
    ds_read_b64_tr_b16 a[20:21], v9 offset:11264
    ds_read_b64_tr_b16 a[22:23], v9 offset:11520
    v_fma_f32 v198, v198, v24, v25
    v_fma_f32 v95, v95, v24, v25
    v_fma_f32 v199, v199, v24, v25
    v_mfma_f32_32x32x16_bf16 v[48:63], a[28:31], v[188:191], v[48:63]
    buffer_store_dwordx4 v[68:71], v15, s[20:23], s28 offen offset:2048 sc1
    ds_read_b64_tr_b16 a[24:25], v9 offset:4096
    ds_read_b64_tr_b16 a[26:27], v9 offset:4352
    s_waitcnt lgkmcnt(6)
    v_mfma_f32_32x32x16_bf16 v[32:47], a[0:3], v[204:207], v[32:47]
    ds_read_b64_tr_b16 a[28:29], v9 offset:12288
    ds_read_b64_tr_b16 a[30:31], v9 offset:12544
    v_cvt_pk_bf16_f32 v196, v92, v196
    v_cvt_pk_bf16_f32 v197, v93, v197
    v_cvt_pk_bf16_f32 v198, v94, v198
    v_cvt_pk_bf16_f32 v199, v95, v199
    v_fma_f32 v96, v96, v24, v25
    v_mfma_f32_32x32x16_bf16 v[48:63], a[4:7], v[204:207], v[48:63]
    ds_read_b64_tr_b16 a[0:1], v9 offset:5120
    ds_read_b64_tr_b16 a[2:3], v9 offset:5376
    v_fma_f32 v200, v200, v24, v25
    v_fma_f32 v97, v97, v24, v25
    v_fma_f32 v201, v201, v24, v25
    v_fma_f32 v98, v98, v24, v25
    v_mfma_f32_32x32x16_bf16 v[32:47], a[8:11], v[220:223], v[32:47]
    ds_read_b64_tr_b16 a[4:5], v9 offset:13312
    ds_read_b64_tr_b16 a[6:7], v9 offset:13568
    v_fma_f32 v202, v202, v24, v25
    v_fma_f32 v99, v99, v24, v25
    v_fma_f32 v203, v203, v24, v25
    s_add_u32 m0, s37, 31744
    v_mfma_f32_32x32x16_bf16 v[48:63], a[12:15], v[220:223], v[48:63]
    buffer_load_dwordx4 v5, s[8:11], s47 offen lds
    ds_read_b64_tr_b16 a[8:9], v9 offset:6144
    ds_read_b64_tr_b16 a[10:11], v9 offset:6400
    s_waitcnt lgkmcnt(6)
    v_add_u32 v4, s55, v4
    v_add_u32 v5, s54, v5
    v_cvt_pk_bf16_f32 v200, v96, v200
    v_mfma_f32_32x32x16_bf16 v[32:47], a[16:19], v[236:239], v[32:47]
    ds_read_b64_tr_b16 a[12:13], v9 offset:14336
    ds_read_b64_tr_b16 a[14:15], v9 offset:14592
    v_cvt_pk_bf16_f32 v201, v97, v201
    v_cvt_pk_bf16_f32 v202, v98, v202
    v_cvt_pk_bf16_f32 v203, v99, v203
    s_add_u32 m0, s37, 32768
    v_mfma_f32_32x32x16_bf16 v[48:63], a[20:23], v[236:239], v[48:63]
    buffer_load_dwordx4 v4, s[8:11], s40 offen lds
    ds_read_b64_tr_b16 a[16:17], v7 offset:2048
    ds_read_b64_tr_b16 a[18:19], v7 offset:2304
    v_fma_f32 v100, v100, v24, v25
    v_fma_f32 v208, v208, v24, v25
    v_mfma_f32_32x32x16_bf16 v[32:47], a[24:27], v[240:243], v[32:47]
    ds_read_b64_tr_b16 a[20:21], v7 offset:10240
    ds_read_b64_tr_b16 a[22:23], v7 offset:10496
    v_fma_f32 v101, v101, v24, v25
    v_fma_f32 v209, v209, v24, v25
    v_fma_f32 v102, v102, v24, v25
    v_fma_f32 v210, v210, v24, v25
    v_mfma_f32_32x32x16_bf16 v[48:63], a[28:31], v[240:243], v[48:63]
    ds_read_b64_tr_b16 a[24:25], v7 offset:4096
    ds_read_b64_tr_b16 a[26:27], v7 offset:4352
    s_waitcnt lgkmcnt(6)
    v_fma_f32 v103, v103, v24, v25
    v_fma_f32 v211, v211, v24, v25
    v_cvt_pk_bf16_f32 v208, v100, v208
    v_mfma_f32_32x32x16_bf16 v[32:47], a[0:3], v[244:247], v[32:47]
    ds_read_b64_tr_b16 a[28:29], v7 offset:12288
    ds_read_b64_tr_b16 a[30:31], v7 offset:12544
    v_cvt_pk_bf16_f32 v209, v101, v209
    v_cvt_pk_bf16_f32 v210, v102, v210
    v_cvt_pk_bf16_f32 v211, v103, v211
    v_fma_f32 v104, v104, v24, v25
    v_mfma_f32_32x32x16_bf16 v[48:63], a[4:7], v[244:247], v[48:63]
    buffer_store_dwordx4 v[68:71], v15, s[20:23], s28 offen offset:3072 sc1
    ds_read_b64_tr_b16 a[0:1], v7 offset:5120
    ds_read_b64_tr_b16 a[2:3], v7 offset:5376
    v_mfma_f32_32x32x16_bf16 v[32:47], a[8:11], v[248:251], v[32:47]
    ds_read_b64_tr_b16 a[4:5], v7 offset:13312
    ds_read_b64_tr_b16 a[6:7], v7 offset:13568
    v_fma_f32 v212, v212, v24, v25
    v_fma_f32 v105, v105, v24, v25
    v_fma_f32 v213, v213, v24, v25
    v_fma_f32 v106, v106, v24, v25
    v_mfma_f32_32x32x16_bf16 v[48:63], a[12:15], v[248:251], v[48:63]
    ds_read_b64_tr_b16 a[8:9], v7 offset:6144
    ds_read_b64_tr_b16 a[10:11], v7 offset:6400
    s_waitcnt lgkmcnt(6)
    v_fma_f32 v214, v214, v24, v25
    v_fma_f32 v107, v107, v24, v25
    s_add_u32 m0, s37, 33792
    v_mfma_f32_32x32x16_bf16 v[32:47], a[16:19], v[168:171], v[32:47]
    buffer_load_dwordx4 v4, s[8:11], s41 offen lds
    ds_read_b64_tr_b16 a[12:13], v7 offset:14336
    ds_read_b64_tr_b16 a[14:15], v7 offset:14592
    v_fma_f32 v215, v215, v24, v25
    v_cvt_pk_bf16_f32 v212, v104, v212
    v_mfma_f32_32x32x16_bf16 v[48:63], a[20:23], v[168:171], v[48:63]
    ds_read_b64_tr_b16 a[16:17], v8 offset:0
    ds_read_b64_tr_b16 a[18:19], v8 offset:256
    v_cvt_pk_bf16_f32 v213, v105, v213
    v_cvt_pk_bf16_f32 v214, v106, v214
    v_cvt_pk_bf16_f32 v215, v107, v215
    v_fma_f32 v108, v108, v24, v25
    v_mfma_f32_32x32x16_bf16 v[32:47], a[24:27], v[176:179], v[32:47]
    ds_read_b64_tr_b16 a[20:21], v8 offset:8192
    ds_read_b64_tr_b16 a[22:23], v8 offset:8448
    v_fma_f32 v216, v216, v24, v25
    v_fma_f32 v109, v109, v24, v25
    v_fma_f32 v217, v217, v24, v25
    v_fma_f32 v110, v110, v24, v25
    v_mfma_f32_32x32x16_bf16 v[48:63], a[28:31], v[176:179], v[48:63]
    ds_read_b64_tr_b16 a[24:25], v8 offset:1024
    ds_read_b64_tr_b16 a[26:27], v8 offset:1280
    s_waitcnt lgkmcnt(6)
    v_fma_f32 v218, v218, v24, v25
    v_fma_f32 v111, v111, v24, v25
    v_fma_f32 v219, v219, v24, v25
    v_mfma_f32_32x32x16_bf16 v[32:47], a[0:3], v[180:183], v[32:47]
    ds_read_b64_tr_b16 a[28:29], v8 offset:9216
    ds_read_b64_tr_b16 a[30:31], v8 offset:9472
    v_cvt_pk_bf16_f32 v216, v108, v216
    v_cvt_pk_bf16_f32 v217, v109, v217
    v_cvt_pk_bf16_f32 v218, v110, v218
    s_add_u32 m0, s37, 34816
    v_mfma_f32_32x32x16_bf16 v[48:63], a[4:7], v[180:183], v[48:63]
    buffer_load_dwordx4 v4, s[8:11], s42 offen lds
    ds_read_b64_tr_b16 a[0:1], v8 offset:2048
    ds_read_b64_tr_b16 a[2:3], v8 offset:2304
    v_cvt_pk_bf16_f32 v219, v111, v219
    v_fma_f32 v112, v112, v24, v25
    v_mfma_f32_32x32x16_bf16 v[32:47], a[8:11], v[184:187], v[32:47]
    ds_read_b64_tr_b16 a[4:5], v8 offset:10240
    ds_read_b64_tr_b16 a[6:7], v8 offset:10496
    v_fma_f32 v224, v224, v24, v25
    v_fma_f32 v113, v113, v24, v25
    v_fma_f32 v225, v225, v24, v25
    v_fma_f32 v114, v114, v24, v25
    v_mfma_f32_32x32x16_bf16 v[48:63], a[12:15], v[184:187], v[48:63]
    buffer_store_dwordx4 v[68:71], v16, s[20:23], s28 offen offset:0 sc1
    ds_read_b64_tr_b16 a[8:9], v8 offset:4096
    ds_read_b64_tr_b16 a[10:11], v8 offset:4352
    s_waitcnt lgkmcnt(6)
    v_mfma_f32_32x32x16_bf16 v[32:47], a[16:19], v[192:195], v[32:47]
    ds_read_b64_tr_b16 a[12:13], v8 offset:12288
    ds_read_b64_tr_b16 a[14:15], v8 offset:12544
    v_fma_f32 v226, v226, v24, v25
    v_fma_f32 v115, v115, v24, v25
    v_fma_f32 v227, v227, v24, v25
    v_cvt_pk_bf16_f32 v224, v112, v224
    v_mfma_f32_32x32x16_bf16 v[48:63], a[20:23], v[192:195], v[48:63]
    ds_read_b64_tr_b16 a[16:17], v8 offset:5120
    ds_read_b64_tr_b16 a[18:19], v8 offset:5376
    v_cvt_pk_bf16_f32 v225, v113, v225
    v_cvt_pk_bf16_f32 v226, v114, v226
    v_cvt_pk_bf16_f32 v227, v115, v227
    v_fma_f32 v116, v116, v24, v25
    v_mfma_f32_32x32x16_bf16 v[32:47], a[24:27], v[196:199], v[32:47]
    ds_read_b64_tr_b16 a[20:21], v8 offset:13312
    ds_read_b64_tr_b16 a[22:23], v8 offset:13568
    v_fma_f32 v228, v228, v24, v25
    v_fma_f32 v117, v117, v24, v25
    v_fma_f32 v229, v229, v24, v25
    v_fma_f32 v118, v118, v24, v25
    v_mfma_f32_32x32x16_bf16 v[48:63], a[28:31], v[196:199], v[48:63]
    ds_read_b64_tr_b16 a[24:25], v8 offset:6144
    ds_read_b64_tr_b16 a[26:27], v8 offset:6400
    s_waitcnt lgkmcnt(6)
    v_fma_f32 v230, v230, v24, v25
    v_fma_f32 v119, v119, v24, v25
    s_add_u32 m0, s37, 35840
    v_mfma_f32_32x32x16_bf16 v[32:47], a[0:3], v[200:203], v[32:47]
    buffer_load_dwordx4 v4, s[8:11], s43 offen lds
    ds_read_b64_tr_b16 a[28:29], v8 offset:14336
    ds_read_b64_tr_b16 a[30:31], v8 offset:14592
    v_fma_f32 v231, v231, v24, v25
    v_cvt_pk_bf16_f32 v228, v116, v228
    v_mfma_f32_32x32x16_bf16 v[48:63], a[4:7], v[200:203], v[48:63]
    ds_read_b64_tr_b16 a[0:1], v9 offset:0
    ds_read_b64_tr_b16 a[2:3], v9 offset:256
    v_cvt_pk_bf16_f32 v229, v117, v229
    v_cvt_pk_bf16_f32 v230, v118, v230
    v_cvt_pk_bf16_f32 v231, v119, v231
    v_fma_f32 v120, v120, v24, v25
    v_mfma_f32_32x32x16_bf16 v[32:47], a[8:11], v[208:211], v[32:47]
    ds_read_b64_tr_b16 a[4:5], v9 offset:8192
    ds_read_b64_tr_b16 a[6:7], v9 offset:8448
    v_fma_f32 v232, v232, v24, v25
    v_fma_f32 v121, v121, v24, v25
    v_fma_f32 v233, v233, v24, v25
    v_fma_f32 v122, v122, v24, v25
    v_mfma_f32_32x32x16_bf16 v[48:63], a[12:15], v[208:211], v[48:63]
    ds_read_b64_tr_b16 a[8:9], v9 offset:1024
    ds_read_b64_tr_b16 a[10:11], v9 offset:1280
    s_waitcnt lgkmcnt(6)
    v_fma_f32 v234, v234, v24, v25
    v_fma_f32 v123, v123, v24, v25
    s_add_u32 m0, s37, 36864
    v_mfma_f32_32x32x16_bf16 v[32:47], a[16:19], v[212:215], v[32:47]
    buffer_load_dwordx4 v4, s[8:11], s44 offen lds
    ds_read_b64_tr_b16 a[12:13], v9 offset:9216
    ds_read_b64_tr_b16 a[14:15], v9 offset:9472
    v_fma_f32 v235, v235, v24, v25
    v_cvt_pk_bf16_f32 v232, v120, v232
    v_mfma_f32_32x32x16_bf16 v[48:63], a[20:23], v[212:215], v[48:63]
    buffer_store_dwordx4 v[68:71], v16, s[20:23], s28 offen offset:1024 sc1
    ds_read_b64_tr_b16 a[16:17], v9 offset:2048
    ds_read_b64_tr_b16 a[18:19], v9 offset:2304
    v_mfma_f32_32x32x16_bf16 v[32:47], a[24:27], v[216:219], v[32:47]
    ds_read_b64_tr_b16 a[20:21], v9 offset:10240
    ds_read_b64_tr_b16 a[22:23], v9 offset:10496
    v_cvt_pk_bf16_f32 v233, v121, v233
    v_cvt_pk_bf16_f32 v234, v122, v234
    v_cvt_pk_bf16_f32 v235, v123, v235
    v_lshlrev_b32 v124, 16, v252
    v_mfma_f32_32x32x16_bf16 v[48:63], a[28:31], v[216:219], v[48:63]
    ds_read_b64_tr_b16 a[24:25], v9 offset:7168
    ds_read_b64_tr_b16 a[26:27], v9 offset:7424
    s_waitcnt lgkmcnt(6)
    v_and_b32 v252, s53, v252
    v_lshlrev_b32 v125, 16, v253
    v_and_b32 v253, s53, v253
    v_mfma_f32_32x32x16_bf16 v[32:47], a[0:3], v[224:227], v[32:47]
    ds_read_b64_tr_b16 a[28:29], v9 offset:15360
    ds_read_b64_tr_b16 a[30:31], v9 offset:15616
    v_lshlrev_b32 v126, 16, v254
    v_and_b32 v254, s53, v254
    v_lshlrev_b32 v127, 16, v255
    v_and_b32 v255, s53, v255
    v_mfma_f32_32x32x16_bf16 v[48:63], a[4:7], v[224:227], v[48:63]
    v_fma_f32 v124, v124, v24, v25
    v_fma_f32 v252, v252, v24, v25
    v_fma_f32 v125, v125, v24, v25
    v_fma_f32 v253, v253, v24, v25
    v_fma_f32 v126, v126, v24, v25
    v_fma_f32 v254, v254, v24, v25
    v_mfma_f32_32x32x16_bf16 v[32:47], a[8:11], v[228:231], v[32:47]
    v_fma_f32 v127, v127, v24, v25
    v_fma_f32 v255, v255, v24, v25
    v_cvt_pk_bf16_f32 v252, v124, v252
    v_cvt_pk_bf16_f32 v253, v125, v253
    v_cvt_pk_bf16_f32 v254, v126, v254
    s_add_u32 m0, s37, 37888
    v_mfma_f32_32x32x16_bf16 v[48:63], a[12:15], v[228:231], v[48:63]
    buffer_load_dwordx4 v4, s[8:11], s45 offen lds
    s_waitcnt lgkmcnt(0)
    v_cvt_pk_bf16_f32 v255, v127, v255
    s_waitcnt vmcnt(9)
    s_barrier
    v_mfma_f32_32x32x16_bf16 v[32:47], a[16:19], v[232:235], v[32:47]
    ds_read_b64_tr_b16 a[0:1], v6 offset:16384
    ds_read_b64_tr_b16 a[2:3], v6 offset:16640
    ds_read_b64_tr_b16 a[4:5], v6 offset:17408
    ds_read_b64_tr_b16 a[6:7], v6 offset:17664
    ds_read_b64_tr_b16 a[8:9], v6 offset:18432
    ds_read_b64_tr_b16 a[10:11], v6 offset:18688
    ds_read_b64_tr_b16 a[12:13], v6 offset:19456
    ds_read_b64_tr_b16 a[14:15], v6 offset:19712
    v_mfma_f32_32x32x16_bf16 v[48:63], a[20:23], v[232:235], v[48:63]
    ds_read_b64_tr_b16 a[16:17], v6 offset:20480
    ds_read_b64_tr_b16 a[18:19], v6 offset:20736
    v_mfma_f32_32x32x16_bf16 v[32:47], a[24:27], v[252:255], v[32:47]
    ds_read_b64_tr_b16 a[20:21], v6 offset:21504
    ds_read_b64_tr_b16 a[22:23], v6 offset:21760
    v_cmp_eq_u32 vcc, 0, v30
    s_cbranch_vccnz L_spin0
L_ok0:
    v_readfirstlane_b32 s38, v30
    v_mov_b32 v22, v30
    s_add_u32 m0, s37, 38912
    v_mfma_f32_32x32x16_bf16 v[48:63], a[28:31], v[252:255], v[48:63]
    buffer_load_dwordx4 v4, s[8:11], s46 offen lds
    ds_read_b64_tr_b16 a[24:25], v6 offset:22528
    ds_read_b64_tr_b16 a[26:27], v6 offset:22784
    s_waitcnt lgkmcnt(6)
    v_mfma_f32_32x32x16_bf16 v[112:127], a[0:3], v[128:131], 0
    ds_read_b64_tr_b16 a[28:29], v6 offset:23552
    ds_read_b64_tr_b16 a[30:31], v6 offset:23808
    v_mfma_f32_32x32x16_bf16 v[112:127], a[4:7], v[132:135], v[112:127]
    ds_read_b64_tr_b16 a[0:1], v7 offset:16384
    ds_read_b64_tr_b16 a[2:3], v7 offset:16640
    v_mfma_f32_32x32x16_bf16 v[112:127], a[8:11], v[136:139], v[112:127]
    ds_read_b64_tr_b16 a[4:5], v7 offset:17408
    ds_read_b64_tr_b16 a[6:7], v7 offset:17664
    v_exp_f32_e64 v64, -v32
    v_exp_f32_e64 v65, -v33
    v_add_f32 v64, 1.0, v64
    s_add_u32 m0, s37, 39936
    v_mfma_f32_32x32x16_bf16 v[112:127], a[12:15], v[140:143], v[112:127]
    buffer_load_dwordx4 v4, s[8:11], s47 offen lds
    ds_read_b64_tr_b16 a[8:9], v7 offset:18432
    ds_read_b64_tr_b16 a[10:11], v7 offset:18688
    s_waitcnt lgkmcnt(6)
    v_subrev_u32 v4, 64, v5
    v_exp_f32_e64 v66, -v34
    v_add_f32 v65, 1.0, v65
    v_mfma_f32_32x32x16_bf16 v[112:127], a[16:19], v[144:147], v[112:127]
    ds_read_b64_tr_b16 a[12:13], v7 offset:19456
    ds_read_b64_tr_b16 a[14:15], v7 offset:19712
    v_rcp_f32 v64, v64
    v_exp_f32_e64 v67, -v35
    v_add_f32 v66, 1.0, v66
    v_mfma_f32_32x32x16_bf16 v[112:127], a[20:23], v[148:151], v[112:127]
    ds_read_b64_tr_b16 a[16:17], v7 offset:20480
    ds_read_b64_tr_b16 a[18:19], v7 offset:20736
    v_rcp_f32 v65, v65
    v_mul_f32 v32, v32, v64
    v_exp_f32_e64 v68, -v36
    v_mfma_f32_32x32x16_bf16 v[112:127], a[24:27], v[152:155], v[112:127]
    ds_read_b64_tr_b16 a[20:21], v7 offset:21504
    ds_read_b64_tr_b16 a[22:23], v7 offset:21760
    v_add_f32 v67, 1.0, v67
    v_rcp_f32 v66, v66
    v_mul_f32 v33, v33, v65
    s_add_u32 m0, s37, 0
    v_mfma_f32_32x32x16_bf16 v[112:127], a[28:31], v[156:159], v[112:127]
    buffer_load_dwordx4 v4, s[8:11], s40 offen lds
    ds_read_b64_tr_b16 a[24:25], v7 offset:22528
    ds_read_b64_tr_b16 a[26:27], v7 offset:22784
    s_waitcnt lgkmcnt(6)
    v_exp_f32_e64 v64, -v37
    v_mfma_f32_32x32x16_bf16 v[112:127], a[0:3], v[160:163], v[112:127]
    ds_read_b64_tr_b16 a[28:29], v7 offset:23552
    ds_read_b64_tr_b16 a[30:31], v7 offset:23808
    v_add_f32 v68, 1.0, v68
    v_rcp_f32 v67, v67
    v_mul_f32 v34, v34, v66
    s_add_u32 m0, s37, 8192
    v_mfma_f32_32x32x16_bf16 v[112:127], a[4:7], v[164:167], v[112:127]
    buffer_load_dwordx4 v5, s[8:11], s40 offen lds
    ds_read_b64_tr_b16 a[0:1], v8 offset:16384
    ds_read_b64_tr_b16 a[2:3], v8 offset:16640
    v_cvt_pk_bf16_f32 v72, v32, v33
    v_exp_f32_e64 v65, -v38
    v_mfma_f32_32x32x16_bf16 v[112:127], a[8:11], v[168:171], v[112:127]
    ds_read_b64_tr_b16 a[4:5], v8 offset:17408
    ds_read_b64_tr_b16 a[6:7], v8 offset:17664
    v_add_f32 v64, 1.0, v64
    v_rcp_f32 v68, v68
    v_mul_f32 v35, v35, v67
    s_add_u32 m0, s37, 1024
    v_mfma_f32_32x32x16_bf16 v[112:127], a[12:15], v[172:175], v[112:127]
    buffer_load_dwordx4 v4, s[8:11], s41 offen lds
    ds_read_b64_tr_b16 a[8:9], v8 offset:18432
    ds_read_b64_tr_b16 a[10:11], v8 offset:18688
    s_waitcnt lgkmcnt(6)
    v_exp_f32_e64 v66, -v39
    v_mfma_f32_32x32x16_bf16 v[112:127], a[16:19], v[176:179], v[112:127]
    ds_read_b64_tr_b16 a[12:13], v8 offset:19456
    ds_read_b64_tr_b16 a[14:15], v8 offset:19712
    v_add_f32 v65, 1.0, v65
    v_rcp_f32 v64, v64
    v_mul_f32 v36, v36, v68
    s_add_u32 m0, s37, 9216
    v_mfma_f32_32x32x16_bf16 v[112:127], a[20:23], v[180:183], v[112:127]
    buffer_load_dwordx4 v5, s[8:11], s41 offen lds
    ds_read_b64_tr_b16 a[16:17], v8 offset:20480
    ds_read_b64_tr_b16 a[18:19], v8 offset:20736
    v_cvt_pk_bf16_f32 v73, v34, v35
    v_exp_f32_e64 v67, -v40
    v_mfma_f32_32x32x16_bf16 v[112:127], a[24:27], v[184:187], v[112:127]
    ds_read_b64_tr_b16 a[20:21], v8 offset:21504
    ds_read_b64_tr_b16 a[22:23], v8 offset:21760
    v_add_f32 v66, 1.0, v66
    v_rcp_f32 v65, v65
    v_mul_f32 v37, v37, v64
    s_add_u32 m0, s37, 2048
    v_mfma_f32_32x32x16_bf16 v[112:127], a[28:31], v[188:191], v[112:127]
    buffer_load_dwordx4 v4, s[8:11], s42 offen lds
    ds_read_b64_tr_b16 a[24:25], v8 offset:22528
    ds_read_b64_tr_b16 a[26:27], v8 offset:22784
    s_waitcnt lgkmcnt(6)
    v_exp_f32_e64 v68, -v41
    v_add_f32 v67, 1.0, v67
    v_mfma_f32_32x32x16_bf16 v[112:127], a[0:3], v[192:195], v[112:127]
    ds_read_b64_tr_b16 a[28:29], v8 offset:23552
    ds_read_b64_tr_b16 a[30:31], v8 offset:23808
    v_rcp_f32 v66, v66
    v_mul_f32 v38, v38, v65
    v_cvt_pk_bf16_f32 v74, v36, v37
    s_add_u32 m0, s37, 10240
    v_mfma_f32_32x32x16_bf16 v[112:127], a[4:7], v[196:199], v[112:127]
    buffer_load_dwordx4 v5, s[8:11], s42 offen lds
    ds_read_b64_tr_b16 a[0:1], v9 offset:16384
    ds_read_b64_tr_b16 a[2:3], v9 offset:16640
    v_exp_f32_e64 v64, -v42
    v_add_f32 v68, 1.0, v68
    v_mfma_f32_32x32x16_bf16 v[112:127], a[8:11], v[200:203], v[112:127]
    ds_read_b64_tr_b16 a[4:5], v9 offset:17408
    ds_read_b64_tr_b16 a[6:7], v9 offset:17664
    v_rcp_f32 v67, v67
    v_mul_f32 v39, v39, v66
    v_exp_f32_e64 v65, -v43
    v_mfma_f32_32x32x16_bf16 v[112:127], a[12:15], v[204:207], v[112:127]
    ds_read_b64_tr_b16 a[8:9], v9 offset:18432
    ds_read_b64_tr_b16 a[10:11], v9 offset:18688
    s_waitcnt lgkmcnt(6)
    v_add_f32 v64, 1.0, v64
    v_rcp_f32 v68, v68
    v_mul_f32 v40, v40, v67
    v_mfma_f32_32x32x16_bf16 v[112:127], a[16:19], v[208:211], v[112:127]
    ds_read_b64_tr_b16 a[12:13], v9 offset:19456
    ds_read_b64_tr_b16 a[14:15], v9 offset:19712
    v_cvt_pk_bf16_f32 v75, v38, v39
    v_exp_f32_e64 v66, -v44
    v_add_f32 v65, 1.0, v65
    v_rcp_f32 v64, v64
    v_mfma_f32_32x32x16_bf16 v[112:127], a[20:23], v[212:215], v[112:127]
    buffer_store_dwordx4 v[72:75], v2, s[20:23], s28 offen offset:0 sc1
    ds_read_b64_tr_b16 a[16:17], v9 offset:20480
    ds_read_b64_tr_b16 a[18:19], v9 offset:20736
    v_mfma_f32_32x32x16_bf16 v[112:127], a[24:27], v[216:219], v[112:127]
    ds_read_b64_tr_b16 a[20:21], v9 offset:21504
    ds_read_b64_tr_b16 a[22:23], v9 offset:21760
    v_mul_f32 v41, v41, v68
    v_exp_f32_e64 v67, -v45
    v_add_f32 v66, 1.0, v66
    v_mfma_f32_32x32x16_bf16 v[112:127], a[28:31], v[220:223], v[112:127]
    ds_read_b64_tr_b16 a[24:25], v9 offset:22528
    ds_read_b64_tr_b16 a[26:27], v9 offset:22784
    s_waitcnt lgkmcnt(6)
    v_rcp_f32 v65, v65
    v_mul_f32 v42, v42, v64
    s_add_u32 m0, s37, 3072
    v_mfma_f32_32x32x16_bf16 v[112:127], a[0:3], v[224:227], v[112:127]
    buffer_load_dwordx4 v4, s[8:11], s43 offen lds
    ds_read_b64_tr_b16 a[28:29], v9 offset:23552
    ds_read_b64_tr_b16 a[30:31], v9 offset:23808
    v_cvt_pk_bf16_f32 v76, v40, v41
    v_exp_f32_e64 v68, -v46
    v_mfma_f32_32x32x16_bf16 v[112:127], a[4:7], v[228:231], v[112:127]
    ds_read_b64_tr_b16 a[0:1], v6 offset:24576
    ds_read_b64_tr_b16 a[2:3], v6 offset:24832
    v_add_f32 v67, 1.0, v67
    v_rcp_f32 v66, v66
    v_mul_f32 v43, v43, v65
    s_add_u32 m0, s37, 11264
    v_mfma_f32_32x32x16_bf16 v[112:127], a[8:11], v[232:235], v[112:127]
    buffer_load_dwordx4 v5, s[8:11], s43 offen lds
    ds_read_b64_tr_b16 a[4:5], v6 offset:25600
    ds_read_b64_tr_b16 a[6:7], v6 offset:25856
    v_exp_f32_e64 v64, -v47
    v_add_f32 v68, 1.0, v68
    v_mfma_f32_32x32x16_bf16 v[112:127], a[12:15], v[236:239], v[112:127]
    ds_read_b64_tr_b16 a[8:9], v6 offset:26624
    ds_read_b64_tr_b16 a[10:11], v6 offset:26880
    s_waitcnt lgkmcnt(6)
    s_barrier
    s_add_u32 m0, s37, 4096
    v_mfma_f32_32x32x16_bf16 v[112:127], a[16:19], v[240:243], v[112:127]
    buffer_load_dwordx4 v4, s[8:11], s44 offen lds
    ds_read_b64_tr_b16 a[12:13], v6 offset:27648
    ds_read_b64_tr_b16 a[14:15], v6 offset:27904
    v_rcp_f32 v67, v67
    v_mul_f32 v44, v44, v66
    v_mfma_f32_32x32x16_bf16 v[112:127], a[20:23], v[244:247], v[112:127]
    ds_read_b64_tr_b16 a[16:17], v6 offset:28672
    ds_read_b64_tr_b16 a[18:19], v6 offset:28928
    v_cvt_pk_bf16_f32 v77, v42, v43
    v_add_f32 v64, 1.0, v64
    v_rcp_f32 v68, v68
    s_add_u32 m0, s37, 12288
    v_mfma_f32_32x32x16_bf16 v[112:127], a[24:27], v[248:251], v[112:127]
    buffer_load_dwordx4 v5, s[8:11], s44 offen lds
    ds_read_b64_tr_b16 a[20:21], v6 offset:29696
    ds_read_b64_tr_b16 a[22:23], v6 offset:29952
    v_mul_f32 v45, v45, v67
    v_rcp_f32 v64, v64
    v_mfma_f32_32x32x16_bf16 v[112:127], a[28:31], v[252:255], v[112:127]
    ds_read_b64_tr_b16 a[24:25], v6 offset:30720
    ds_read_b64_tr_b16 a[26:27], v6 offset:30976
    s_waitcnt lgkmcnt(6)
    v_mul_f32 v46, v46, v68
    v_cvt_pk_bf16_f32 v78, v44, v45
    v_mul_f32 v47, v47, v64
    v_cvt_pk_bf16_f32 v79, v46, v47
    v_mfma_f32_32x32x16_bf16 v[32:47], a[0:3], v[128:131], 0
    buffer_store_dwordx4 v[76:79], v2, s[20:23], s28 offen offset:1024 sc1
    ds_read_b64_tr_b16 a[28:29], v6 offset:31744
    ds_read_b64_tr_b16 a[30:31], v6 offset:32000
    v_mfma_f32_32x32x16_bf16 v[32:47], a[4:7], v[132:135], v[32:47]
    ds_read_b64_tr_b16 a[0:1], v7 offset:24576
    ds_read_b64_tr_b16 a[2:3], v7 offset:24832
    v_exp_f32_e64 v64, -v48
    v_exp_f32_e64 v65, -v49
    v_add_f32 v64, 1.0, v64
    v_mfma_f32_32x32x16_bf16 v[32:47], a[8:11], v[136:139], v[32:47]
    ds_read_b64_tr_b16 a[4:5], v7 offset:25600
    ds_read_b64_tr_b16 a[6:7], v7 offset:25856
    v_exp_f32_e64 v66, -v50
    v_add_f32 v65, 1.0, v65
    v_rcp_f32 v64, v64
    v_mfma_f32_32x32x16_bf16 v[32:47], a[12:15], v[140:143], v[32:47]
    ds_read_b64_tr_b16 a[8:9], v7 offset:26624
    ds_read_b64_tr_b16 a[10:11], v7 offset:26880
    s_waitcnt lgkmcnt(6)
    v_exp_f32_e64 v67, -v51
    v_add_f32 v66, 1.0, v66
    s_add_u32 m0, s37, 5120
    v_mfma_f32_32x32x16_bf16 v[32:47], a[16:19], v[144:147], v[32:47]
    buffer_load_dwordx4 v4, s[8:11], s45 offen lds
    ds_read_b64_tr_b16 a[12:13], v7 offset:27648
    ds_read_b64_tr_b16 a[14:15], v7 offset:27904
    v_rcp_f32 v65, v65
    v_mul_f32 v48, v48, v64
    v_mfma_f32_32x32x16_bf16 v[32:47], a[20:23], v[148:151], v[32:47]
    ds_read_b64_tr_b16 a[16:17], v7 offset:28672
    ds_read_b64_tr_b16 a[18:19], v7 offset:28928
    v_exp_f32_e64 v68, -v52
    v_add_f32 v67, 1.0, v67
    s_add_u32 m0, s37, 13312
    v_mfma_f32_32x32x16_bf16 v[32:47], a[24:27], v[152:155], v[32:47]
    buffer_load_dwordx4 v5, s[8:11], s45 offen lds
    ds_read_b64_tr_b16 a[20:21], v7 offset:29696
    ds_read_b64_tr_b16 a[22:23], v7 offset:29952
    v_rcp_f32 v66, v66
    v_mul_f32 v49, v49, v65
    v_mfma_f32_32x32x16_bf16 v[32:47], a[28:31], v[156:159], v[32:47]
    ds_read_b64_tr_b16 a[24:25], v7 offset:30720
    ds_read_b64_tr_b16 a[26:27], v7 offset:30976
    s_waitcnt lgkmcnt(6)
    v_exp_f32_e64 v64, -v53
    v_add_f32 v68, 1.0, v68
    s_add_u32 m0, s37, 6144
    v_mfma_f32_32x32x16_bf16 v[32:47], a[0:3], v[160:163], v[32:47]
    buffer_load_dwordx4 v4, s[8:11], s46 offen lds
    ds_read_b64_tr_b16 a[28:29], v7 offset:31744
    ds_read_b64_tr_b16 a[30:31], v7 offset:32000
    v_rcp_f32 v67, v67
    v_mul_f32 v50, v50, v66
    v_mfma_f32_32x32x16_bf16 v[32:47], a[4:7], v[164:167], v[32:47]
    ds_read_b64_tr_b16 a[0:1], v8 offset:24576
    ds_read_b64_tr_b16 a[2:3], v8 offset:24832
    v_cvt_pk_bf16_f32 v80, v48, v49
    v_exp_f32_e64 v65, -v54
    v_add_f32 v64, 1.0, v64
    s_add_u32 m0, s37, 14336
    v_mfma_f32_32x32x16_bf16 v[32:47], a[8:11], v[168:171], v[32:47]
    buffer_load_dwordx4 v5, s[8:11], s46 offen lds
    ds_read_b64_tr_b16 a[4:5], v8 offset:25600
    ds_read_b64_tr_b16 a[6:7], v8 offset:25856
    v_rcp_f32 v68, v68
    v_mul_f32 v51, v51, v67
    v_mfma_f32_32x32x16_bf16 v[32:47], a[12:15], v[172:175], v[32:47]
    ds_read_b64_tr_b16 a[8:9], v8 offset:26624
    ds_read_b64_tr_b16 a[10:11], v8 offset:26880
    s_waitcnt lgkmcnt(6)
    v_exp_f32_e64 v66, -v55
    v_add_f32 v65, 1.0, v65
    s_add_u32 m0, s37, 7168
    v_mfma_f32_32x32x16_bf16 v[32:47], a[16:19], v[176:179], v[32:47]
    buffer_load_dwordx4 v4, s[8:11], s47 offen lds
    ds_read_b64_tr_b16 a[12:13], v8 offset:27648
    ds_read_b64_tr_b16 a[14:15], v8 offset:27904
    v_rcp_f32 v64, v64
    v_mul_f32 v52, v52, v68
    v_mfma_f32_32x32x16_bf16 v[32:47], a[20:23], v[180:183], v[32:47]
    ds_read_b64_tr_b16 a[16:17], v8 offset:28672
    ds_read_b64_tr_b16 a[18:19], v8 offset:28928
    v_cvt_pk_bf16_f32 v81, v50, v51
    v_exp_f32_e64 v67, -v56
    v_add_f32 v66, 1.0, v66
    s_add_u32 m0, s37, 15360
    v_mfma_f32_32x32x16_bf16 v[32:47], a[24:27], v[184:187], v[32:47]
    buffer_load_dwordx4 v5, s[8:11], s47 offen lds
    ds_read_b64_tr_b16 a[20:21], v8 offset:29696
    ds_read_b64_tr_b16 a[22:23], v8 offset:29952
    v_rcp_f32 v65, v65
    v_mul_f32 v53, v53, v64
    v_mfma_f32_32x32x16_bf16 v[32:47], a[28:31], v[188:191], v[32:47]
    ds_read_b64_tr_b16 a[24:25], v8 offset:30720
    ds_read_b64_tr_b16 a[26:27], v8 offset:30976
    s_waitcnt lgkmcnt(6)
    v_exp_f32_e64 v68, -v57
    s_add_u32 m0, s37, 16384
    s_add_u32 s48, s60, 0
    v_mfma_f32_32x32x16_bf16 v[32:47], a[0:3], v[192:195], v[32:47]
    buffer_load_dwordx4 v10, s[12:15], s48 offen offset:0 lds
    ds_read_b64_tr_b16 a[28:29], v8 offset:31744
    ds_read_b64_tr_b16 a[30:31], v8 offset:32000
    v_add_f32 v67, 1.0, v67
    v_rcp_f32 v66, v66
    v_mfma_f32_32x32x16_bf16 v[32:47], a[4:7], v[196:199], v[32:47]
    ds_read_b64_tr_b16 a[0:1], v9 offset:24576
    ds_read_b64_tr_b16 a[2:3], v9 offset:24832
    v_mul_f32 v54, v54, v65
    v_cvt_pk_bf16_f32 v82, v52, v53
    v_exp_f32_e64 v64, -v58
    v_add_f32 v68, 1.0, v68
    v_mfma_f32_32x32x16_bf16 v[32:47], a[8:11], v[200:203], v[32:47]
    ds_read_b64_tr_b16 a[4:5], v9 offset:25600
    ds_read_b64_tr_b16 a[6:7], v9 offset:25856
    v_rcp_f32 v67, v67
    v_mul_f32 v55, v55, v66
    v_exp_f32_e64 v65, -v59
    v_mfma_f32_32x32x16_bf16 v[32:47], a[12:15], v[204:207], v[32:47]
    s_waitcnt vmcnt(7)
    s_add_u32 s62, s58, 65536
    buffer_store_dword v22, v20, s[20:23], s62 offen sc1
    ds_read_b64_tr_b16 a[8:9], v9 offset:26624
    ds_read_b64_tr_b16 a[10:11], v9 offset:26880
    s_waitcnt lgkmcnt(6)
    v_mfma_f32_32x32x16_bf16 v[32:47], a[16:19], v[208:211], v[32:47]
    ds_read_b64_tr_b16 a[12:13], v9 offset:27648
    ds_read_b64_tr_b16 a[14:15], v9 offset:27904
    v_add_f32 v64, 1.0, v64
    v_rcp_f32 v68, v68
    v_mul_f32 v56, v56, v67
    v_cvt_pk_bf16_f32 v83, v54, v55
    v_mfma_f32_32x32x16_bf16 v[32:47], a[20:23], v[212:215], v[32:47]
    buffer_store_dwordx4 v[80:83], v2, s[20:23], s28 offen offset:2048 sc1
    ds_read_b64_tr_b16 a[16:17], v9 offset:28672
    ds_read_b64_tr_b16 a[18:19], v9 offset:28928
    v_mfma_f32_32x32x16_bf16 v[32:47], a[24:27], v[216:219], v[32:47]
    ds_read_b64_tr_b16 a[20:21], v9 offset:29696
    ds_read_b64_tr_b16 a[22:23], v9 offset:29952
    v_exp_f32_e64 v66, -v60
    v_add_f32 v65, 1.0, v65
    v_rcp_f32 v64, v64
    v_mul_f32 v57, v57, v68
    v_mfma_f32_32x32x16_bf16 v[32:47], a[28:31], v[220:223], v[32:47]
    buffer_load_dwordx4 v11, s[12:15], s48 offen offset:1024 lds
    ds_read_b64_tr_b16 a[24:25], v9 offset:30720
    ds_read_b64_tr_b16 a[26:27], v9 offset:30976
    s_waitcnt lgkmcnt(6)
    v_exp_f32_e64 v67, -v61
    v_mfma_f32_32x32x16_bf16 v[32:47], a[0:3], v[224:227], v[32:47]
    ds_read_b64_tr_b16 a[28:29], v9 offset:31744
    ds_read_b64_tr_b16 a[30:31], v9 offset:32000
    v_add_f32 v66, 1.0, v66
    v_rcp_f32 v65, v65
    v_mul_f32 v58, v58, v64
    v_cvt_pk_bf16_f32 v84, v56, v57
    v_mfma_f32_32x32x16_bf16 v[32:47], a[4:7], v[228:231], v[32:47]
    buffer_load_dwordx4 v12, s[12:15], s48 offen offset:2048 lds
    v_exp_f32_e64 v68, -v62
    v_add_f32 v67, 1.0, v67
    v_rcp_f32 v66, v66
    v_mfma_f32_32x32x16_bf16 v[32:47], a[8:11], v[232:235], v[32:47]
    v_mul_f32 v59, v59, v65
    v_exp_f32_e64 v64, -v63
    v_add_f32 v68, 1.0, v68
    v_rcp_f32 v67, v67
    v_mul_f32 v60, v60, v66
    v_mfma_f32_32x32x16_bf16 v[32:47], a[12:15], v[236:239], v[32:47]
    buffer_load_dwordx4 v13, s[12:15], s48 offen offset:3072 lds
    s_waitcnt lgkmcnt(0)
    v_cvt_pk_bf16_f32 v85, v58, v59
    v_add_f32 v64, 1.0, v64
    s_barrier
    v_mfma_f32_32x32x16_bf16 v[32:47], a[16:19], v[240:243], v[32:47]
    ds_read_b64_tr_b16 a[0:1], v6 offset:32768
    ds_read_b64_tr_b16 a[2:3], v6 offset:33024
    ds_read_b64_tr_b16 a[4:5], v6 offset:33792
    ds_read_b64_tr_b16 a[6:7], v6 offset:34048
    ds_read_b64_tr_b16 a[8:9], v6 offset:34816
    ds_read_b64_tr_b16 a[10:11], v6 offset:35072
    ds_read_b64_tr_b16 a[12:13], v6 offset:35840
    ds_read_b64_tr_b16 a[14:15], v6 offset:36096
    s_add_u32 m0, s37, 20480
    s_add_u32 s48, s60, 32768
    v_mfma_f32_32x32x16_bf16 v[32:47], a[20:23], v[244:247], v[32:47]
    buffer_load_dwordx4 v10, s[12:15], s48 offen offset:0 lds
    ds_read_b64_tr_b16 a[16:17], v6 offset:36864
    ds_read_b64_tr_b16 a[18:19], v6 offset:37120
    v_rcp_f32 v68, v68
    v_mul_f32 v61, v61, v67
    v_mfma_f32_32x32x16_bf16 v[32:47], a[24:27], v[248:251], v[32:47]
    ds_read_b64_tr_b16 a[20:21], v6 offset:37888
    ds_read_b64_tr_b16 a[22:23], v6 offset:38144
    v_rcp_f32 v64, v64
    v_mul_f32 v62, v62, v68
    v_cvt_pk_bf16_f32 v86, v60, v61
    v_mul_f32 v63, v63, v64
    v_mfma_f32_32x32x16_bf16 v[32:47], a[28:31], v[252:255], v[32:47]
    buffer_load_dwordx4 v11, s[12:15], s48 offen offset:1024 lds
    ds_read_b64_tr_b16 a[24:25], v6 offset:38912
    ds_read_b64_tr_b16 a[26:27], v6 offset:39168
    s_waitcnt lgkmcnt(6)
    v_cvt_pk_bf16_f32 v87, v62, v63
    v_mfma_f32_32x32x16_bf16 v[48:63], a[0:3], v[128:131], 0
    buffer_store_dwordx4 v[84:87], v2, s[20:23], s28 offen offset:3072 sc1
    ds_read_b64_tr_b16 a[28:29], v6 offset:39936
    ds_read_b64_tr_b16 a[30:31], v6 offset:40192
    v_mfma_f32_32x32x16_bf16 v[48:63], a[4:7], v[132:135], v[48:63]
    ds_read_b64_tr_b16 a[0:1], v7 offset:32768
    ds_read_b64_tr_b16 a[2:3], v7 offset:33024
    v_exp_f32_e64 v64, -v112
    v_exp_f32_e64 v65, -v113
    v_add_f32 v64, 1.0, v64
    v_mfma_f32_32x32x16_bf16 v[48:63], a[8:11], v[136:139], v[48:63]
    ds_read_b64_tr_b16 a[4:5], v7 offset:33792
    ds_read_b64_tr_b16 a[6:7], v7 offset:34048
    v_exp_f32_e64 v66, -v114
    v_add_f32 v65, 1.0, v65
    v_rcp_f32 v64, v64
    v_mfma_f32_32x32x16_bf16 v[48:63], a[12:15], v[140:143], v[48:63]
    ds_read_b64_tr_b16 a[8:9], v7 offset:34816
    ds_read_b64_tr_b16 a[10:11], v7 offset:35072
    s_waitcnt lgkmcnt(6)
    v_exp_f32_e64 v67, -v115
    v_add_f32 v66, 1.0, v66
    v_mfma_f32_32x32x16_bf16 v[48:63], a[16:19], v[144:147], v[48:63]
    ds_read_b64_tr_b16 a[12:13], v7 offset:35840
    ds_read_b64_tr_b16 a[14:15], v7 offset:36096
    v_rcp_f32 v65, v65
    v_mul_f32 v112, v112, v64
    v_exp_f32_e64 v68, -v116
    v_mfma_f32_32x32x16_bf16 v[48:63], a[20:23], v[148:151], v[48:63]
    ds_read_b64_tr_b16 a[16:17], v7 offset:36864
    ds_read_b64_tr_b16 a[18:19], v7 offset:37120
    v_add_f32 v67, 1.0, v67
    v_rcp_f32 v66, v66
    v_mul_f32 v113, v113, v65
    v_mfma_f32_32x32x16_bf16 v[48:63], a[24:27], v[152:155], v[48:63]
    buffer_load_dwordx4 v12, s[12:15], s48 offen offset:2048 lds
    ds_read_b64_tr_b16 a[20:21], v7 offset:37888
    ds_read_b64_tr_b16 a[22:23], v7 offset:38144
    v_exp_f32_e64 v64, -v117
    v_add_f32 v68, 1.0, v68
    v_mfma_f32_32x32x16_bf16 v[48:63], a[28:31], v[156:159], v[48:63]
    ds_read_b64_tr_b16 a[24:25], v7 offset:38912
    ds_read_b64_tr_b16 a[26:27], v7 offset:39168
    s_waitcnt lgkmcnt(6)
    v_rcp_f32 v67, v67
    v_mul_f32 v114, v114, v66
    v_cvt_pk_bf16_f32 v88, v112, v113
    v_mfma_f32_32x32x16_bf16 v[48:63], a[0:3], v[160:163], v[48:63]
    buffer_load_dwordx4 v13, s[12:15], s48 offen offset:3072 lds
    ds_read_b64_tr_b16 a[28:29], v7 offset:39936
    ds_read_b64_tr_b16 a[30:31], v7 offset:40192
    v_exp_f32_e64 v65, -v118
    v_add_f32 v64, 1.0, v64
    v_mfma_f32_32x32x16_bf16 v[48:63], a[4:7], v[164:167], v[48:63]
    ds_read_b64_tr_b16 a[0:1], v8 offset:32768
    ds_read_b64_tr_b16 a[2:3], v8 offset:33024
    v_rcp_f32 v68, v68
    v_mul_f32 v115, v115, v67
    s_add_u32 m0, s37, 24576
    s_add_u32 s48, s52, 0
    v_mfma_f32_32x32x16_bf16 v[48:63], a[8:11], v[168:171], v[48:63]
    buffer_load_dwordx4 v10, s[12:15], s48 offen offset:0 lds
    ds_read_b64_tr_b16 a[4:5], v8 offset:33792
    ds_read_b64_tr_b16 a[6:7], v8 offset:34048
    v_exp_f32_e64 v66, -v119
    v_add_f32 v65, 1.0, v65
    v_mfma_f32_32x32x16_bf16 v[48:63], a[12:15], v[172:175], v[48:63]
    buffer_load_dwordx4 v11, s[12:15], s48 offen offset:1024 lds
    ds_read_b64_tr_b16 a[8:9], v8 offset:34816
    ds_read_b64_tr_b16 a[10:11], v8 offset:35072
    s_waitcnt lgkmcnt(6)
    v_rcp_f32 v64, v64
    v_mfma_f32_32x32x16_bf16 v[48:63], a[16:19], v[176:179], v[48:63]
    ds_read_b64_tr_b16 a[12:13], v8 offset:35840
    ds_read_b64_tr_b16 a[14:15], v8 offset:36096
    v_mul_f32 v116, v116, v68
    v_cvt_pk_bf16_f32 v89, v114, v115
    v_exp_f32_e64 v67, -v120
    v_add_f32 v66, 1.0, v66
    v_mfma_f32_32x32x16_bf16 v[48:63], a[20:23], v[180:183], v[48:63]
    buffer_load_dwordx4 v12, s[12:15], s48 offen offset:2048 lds
    ds_read_b64_tr_b16 a[16:17], v8 offset:36864
    ds_read_b64_tr_b16 a[18:19], v8 offset:37120
    v_rcp_f32 v65, v65
    v_mul_f32 v117, v117, v64
    v_mfma_f32_32x32x16_bf16 v[48:63], a[24:27], v[184:187], v[48:63]
    ds_read_b64_tr_b16 a[20:21], v8 offset:37888
    ds_read_b64_tr_b16 a[22:23], v8 offset:38144
    v_exp_f32_e64 v68, -v121
    v_add_f32 v67, 1.0, v67
    v_rcp_f32 v66, v66
    v_mfma_f32_32x32x16_bf16 v[48:63], a[28:31], v[188:191], v[48:63]
    buffer_load_dwordx4 v13, s[12:15], s48 offen offset:3072 lds
    ds_read_b64_tr_b16 a[24:25], v8 offset:38912
    ds_read_b64_tr_b16 a[26:27], v8 offset:39168
    s_waitcnt lgkmcnt(6)
    v_mul_f32 v118, v118, v65
    v_cvt_pk_bf16_f32 v90, v116, v117
    v_mfma_f32_32x32x16_bf16 v[48:63], a[0:3], v[192:195], v[48:63]
    ds_read_b64_tr_b16 a[28:29], v8 offset:39936
    ds_read_b64_tr_b16 a[30:31], v8 offset:40192
    v_exp_f32_e64 v64, -v122
    v_add_f32 v68, 1.0, v68
    s_add_u32 m0, s37, 28672
    s_add_u32 s48, s52, 32768
    v_mfma_f32_32x32x16_bf16 v[48:63], a[4:7], v[196:199], v[48:63]
    buffer_load_dwordx4 v10, s[12:15], s48 offen offset:0 lds
    ds_read_b64_tr_b16 a[0:1], v9 offset:32768
    ds_read_b64_tr_b16 a[2:3], v9 offset:33024
    v_rcp_f32 v67, v67
    v_mul_f32 v119, v119, v66
    v_mfma_f32_32x32x16_bf16 v[48:63], a[8:11], v[200:203], v[48:63]
    ds_read_b64_tr_b16 a[4:5], v9 offset:33792
    ds_read_b64_tr_b16 a[6:7], v9 offset:34048
    v_exp_f32_e64 v65, -v123
    v_add_f32 v64, 1.0, v64
    v_rcp_f32 v68, v68
    v_mfma_f32_32x32x16_bf16 v[48:63], a[12:15], v[204:207], v[48:63]
    s_waitcnt vmcnt(7)
    s_add_u32 s62, s58, 131072
    buffer_store_dword v22, v20, s[20:23], s62 offen sc1
    ds_read_b64_tr_b16 a[8:9], v9 offset:34816
    ds_read_b64_tr_b16 a[10:11], v9 offset:35072
    s_waitcnt lgkmcnt(6)
    v_mfma_f32_32x32x16_bf16 v[48:63], a[16:19], v[208:211], v[48:63]
    ds_read_b64_tr_b16 a[12:13], v9 offset:35840
    ds_read_b64_tr_b16 a[14:15], v9 offset:36096
    v_mul_f32 v120, v120, v67
    v_cvt_pk_bf16_f32 v91, v118, v119
    v_exp_f32_e64 v66, -v124
    v_add_f32 v65, 1.0, v65
    v_mfma_f32_32x32x16_bf16 v[48:63], a[20:23], v[212:215], v[48:63]
    buffer_store_dwordx4 v[88:91], v14, s[20:23], s28 offen offset:0 sc1
    ds_read_b64_tr_b16 a[16:17], v9 offset:36864
    ds_read_b64_tr_b16 a[18:19], v9 offset:37120
    v_mfma_f32_32x32x16_bf16 v[48:63], a[24:27], v[216:219], v[48:63]
    ds_read_b64_tr_b16 a[20:21], v9 offset:37888
    ds_read_b64_tr_b16 a[22:23], v9 offset:38144
    v_rcp_f32 v64, v64
    v_mul_f32 v121, v121, v68
    v_exp_f32_e64 v67, -v125
    v_mfma_f32_32x32x16_bf16 v[48:63], a[28:31], v[220:223], v[48:63]
    ds_read_b64_tr_b16 a[24:25], v9 offset:38912
    ds_read_b64_tr_b16 a[26:27], v9 offset:39168
    s_waitcnt lgkmcnt(6)
    v_add_f32 v66, 1.0, v66
    v_rcp_f32 v65, v65
    v_mfma_f32_32x32x16_bf16 v[48:63], a[0:3], v[224:227], v[48:63]
    buffer_load_dwordx4 v11, s[12:15], s48 offen offset:1024 lds
    ds_read_b64_tr_b16 a[28:29], v9 offset:39936
    ds_read_b64_tr_b16 a[30:31], v9 offset:40192
    v_mul_f32 v122, v122, v64
    v_cvt_pk_bf16_f32 v92, v120, v121
    v_mfma_f32_32x32x16_bf16 v[48:63], a[4:7], v[228:231], v[48:63]
    v_exp_f32_e64 v68, -v126
    v_add_f32 v67, 1.0, v67
    v_rcp_f32 v66, v66
    v_mul_f32 v123, v123, v65
    v_mfma_f32_32x32x16_bf16 v[48:63], a[8:11], v[232:235], v[48:63]
    buffer_load_dwordx4 v12, s[12:15], s48 offen offset:2048 lds
    v_exp_f32_e64 v64, -v127
    v_add_f32 v68, 1.0, v68
    v_rcp_f32 v67, v67
    v_mfma_f32_32x32x16_bf16 v[48:63], a[12:15], v[236:239], v[48:63]
    s_waitcnt lgkmcnt(0)
    v_mul_f32 v124, v124, v66
    v_cvt_pk_bf16_f32 v93, v122, v123
    v_add_f32 v64, 1.0, v64
    s_barrier
    v_mfma_f32_32x32x16_bf16 v[48:63], a[16:19], v[240:243], v[48:63]
    buffer_load_dwordx4 v13, s[12:15], s48 offen offset:3072 lds
    ds_read_b64_tr_b16 a[0:1], v6 offset:0
    ds_read_b64_tr_b16 a[2:3], v6 offset:256
    ds_read_b64_tr_b16 a[4:5], v6 offset:1024
    ds_read_b64_tr_b16 a[6:7], v6 offset:1280
    ds_read_b64_tr_b16 a[8:9], v6 offset:2048
    ds_read_b64_tr_b16 a[10:11], v6 offset:2304
    ds_read_b64_tr_b16 a[12:13], v6 offset:3072
    ds_read_b64_tr_b16 a[14:15], v6 offset:3328
    v_mfma_f32_32x32x16_bf16 v[48:63], a[20:23], v[244:247], v[48:63]
    ds_read_b64_tr_b16 a[16:17], v6 offset:4096
    ds_read_b64_tr_b16 a[18:19], v6 offset:4352
    v_rcp_f32 v68, v68
    v_mul_f32 v125, v125, v67
    s_add_u32 m0, s37, 32768
    s_add_u32 s48, s59, 0
    v_mfma_f32_32x32x16_bf16 v[48:63], a[24:27], v[248:251], v[48:63]
    buffer_load_dwordx4 v10, s[12:15], s48 offen offset:0 lds
    ds_read_b64_tr_b16 a[20:21], v6 offset:5120
    ds_read_b64_tr_b16 a[22:23], v6 offset:5376
    v_rcp_f32 v64, v64
    v_mul_f32 v126, v126, v68
    v_mfma_f32_32x32x16_bf16 v[48:63], a[28:31], v[252:255], v[48:63]
    ds_read_b64_tr_b16 a[24:25], v6 offset:6144
    ds_read_b64_tr_b16 a[26:27], v6 offset:6400
    s_waitcnt lgkmcnt(6)
    v_cvt_pk_bf16_f32 v94, v124, v125
    v_mul_f32 v127, v127, v64
    v_cvt_pk_bf16_f32 v95, v126, v127
    v_mfma_f32_32x32x16_bf16 v[112:127], a[0:3], v[128:131], 0
    buffer_store_dwordx4 v[92:95], v14, s[20:23], s28 offen offset:1024 sc1
    ds_read_b64_tr_b16 a[28:29], v6 offset:7168
    ds_read_b64_tr_b16 a[30:31], v6 offset:7424
    v_mfma_f32_32x32x16_bf16 v[112:127], a[4:7], v[132:135], v[112:127]
    ds_read_b64_tr_b16 a[0:1], v7 offset:0
    ds_read_b64_tr_b16 a[2:3], v7 offset:256
    v_exp_f32_e64 v64, -v32
    v_exp_f32_e64 v65, -v33
    v_add_f32 v64, 1.0, v64
    v_mfma_f32_32x32x16_bf16 v[112:127], a[8:11], v[136:139], v[112:127]
    ds_read_b64_tr_b16 a[4:5], v7 offset:1024
    ds_read_b64_tr_b16 a[6:7], v7 offset:1280
    v_exp_f32_e64 v66, -v34
    v_add_f32 v65, 1.0, v65
    v_rcp_f32 v64, v64
    v_mfma_f32_32x32x16_bf16 v[112:127], a[12:15], v[140:143], v[112:127]
    ds_read_b64_tr_b16 a[8:9], v7 offset:2048
    ds_read_b64_tr_b16 a[10:11], v7 offset:2304
    s_waitcnt lgkmcnt(6)
    v_exp_f32_e64 v67, -v35
    v_add_f32 v66, 1.0, v66
    v_rcp_f32 v65, v65
    v_mfma_f32_32x32x16_bf16 v[112:127], a[16:19], v[144:147], v[112:127]
    s_mov_b32 s51, 65536
    buffer_load_dword v30, v3, s[20:23], s51 offen sc1
    ds_read_b64_tr_b16 a[12:13], v7 offset:3072
    ds_read_b64_tr_b16 a[14:15], v7 offset:3328
    v_mul_f32 v32, v32, v64
    v_exp_f32_e64 v68, -v36
    v_mfma_f32_32x32x16_bf16 v[112:127], a[20:23], v[148:151], v[112:127]
    buffer_load_dwordx4 v11, s[12:15], s48 offen offset:1024 lds
    ds_read_b64_tr_b16 a[16:17], v7 offset:4096
    ds_read_b64_tr_b16 a[18:19], v7 offset:4352
    v_add_f32 v67, 1.0, v67
    v_rcp_f32 v66, v66
    v_mfma_f32_32x32x16_bf16 v[112:127], a[24:27], v[152:155], v[112:127]
    ds_read_b64_tr_b16 a[20:21], v7 offset:5120
    ds_read_b64_tr_b16 a[22:23], v7 offset:5376
    v_mul_f32 v33, v33, v65
    v_exp_f32_e64 v64, -v37
    v_add_f32 v68, 1.0, v68
    v_mfma_f32_32x32x16_bf16 v[112:127], a[28:31], v[156:159], v[112:127]
    buffer_load_dwordx4 v12, s[12:15], s48 offen offset:2048 lds
    ds_read_b64_tr_b16 a[24:25], v7 offset:6144
    ds_read_b64_tr_b16 a[26:27], v7 offset:6400
    s_waitcnt lgkmcnt(6)
    v_rcp_f32 v67, v67
    v_mfma_f32_32x32x16_bf16 v[112:127], a[0:3], v[160:163], v[112:127]
    ds_read_b64_tr_b16 a[28:29], v7 offset:7168
    ds_read_b64_tr_b16 a[30:31], v7 offset:7424
    v_mul_f32 v34, v34, v66
    v_cvt_pk_bf16_f32 v96, v32, v33
    v_exp_f32_e64 v65, -v38
    v_add_f32 v64, 1.0, v64
    v_mfma_f32_32x32x16_bf16 v[112:127], a[4:7], v[164:167], v[112:127]
    buffer_load_dwordx4 v13, s[12:15], s48 offen offset:3072 lds
    ds_read_b64_tr_b16 a[0:1], v8 offset:0
    ds_read_b64_tr_b16 a[2:3], v8 offset:256
    v_rcp_f32 v68, v68
    v_mul_f32 v35, v35, v67
    v_mfma_f32_32x32x16_bf16 v[112:127], a[8:11], v[168:171], v[112:127]
    ds_read_b64_tr_b16 a[4:5], v8 offset:1024
    ds_read_b64_tr_b16 a[6:7], v8 offset:1280
    v_exp_f32_e64 v66, -v39
    v_add_f32 v65, 1.0, v65
    s_add_u32 m0, s37, 36864
    s_add_u32 s48, s63, 0
    v_mfma_f32_32x32x16_bf16 v[112:127], a[12:15], v[172:175], v[112:127]
    buffer_load_dwordx4 v10, s[12:15], s48 offen offset:0 lds
    ds_read_b64_tr_b16 a[8:9], v8 offset:2048
    ds_read_b64_tr_b16 a[10:11], v8 offset:2304
    s_waitcnt lgkmcnt(6)
    v_rcp_f32 v64, v64
    v_mfma_f32_32x32x16_bf16 v[112:127], a[16:19], v[176:179], v[112:127]
    ds_read_b64_tr_b16 a[12:13], v8 offset:3072
    ds_read_b64_tr_b16 a[14:15], v8 offset:3328
    v_mul_f32 v36, v36, v68
    v_cvt_pk_bf16_f32 v97, v34, v35
    v_exp_f32_e64 v67, -v40
    v_add_f32 v66, 1.0, v66
    v_mfma_f32_32x32x16_bf16 v[112:127], a[20:23], v[180:183], v[112:127]
    buffer_load_dwordx4 v11, s[12:15], s48 offen offset:1024 lds
    ds_read_b64_tr_b16 a[16:17], v8 offset:4096
    ds_read_b64_tr_b16 a[18:19], v8 offset:4352
    v_rcp_f32 v65, v65
    v_mul_f32 v37, v37, v64
    v_mfma_f32_32x32x16_bf16 v[112:127], a[24:27], v[184:187], v[112:127]
    ds_read_b64_tr_b16 a[20:21], v8 offset:5120
    ds_read_b64_tr_b16 a[22:23], v8 offset:5376
    v_exp_f32_e64 v68, -v41
    v_add_f32 v67, 1.0, v67
    v_rcp_f32 v66, v66
    v_mfma_f32_32x32x16_bf16 v[112:127], a[28:31], v[188:191], v[112:127]
    buffer_load_dwordx4 v12, s[12:15], s48 offen offset:2048 lds
    ds_read_b64_tr_b16 a[24:25], v8 offset:6144
    ds_read_b64_tr_b16 a[26:27], v8 offset:6400
    s_waitcnt lgkmcnt(6)
    v_mul_f32 v38, v38, v65
    v_cvt_pk_bf16_f32 v98, v36, v37
    v_mfma_f32_32x32x16_bf16 v[112:127], a[0:3], v[192:195], v[112:127]
    ds_read_b64_tr_b16 a[28:29], v8 offset:7168
    ds_read_b64_tr_b16 a[30:31], v8 offset:7424
    v_exp_f32_e64 v64, -v42
    v_add_f32 v68, 1.0, v68
    v_rcp_f32 v67, v67
    v_mfma_f32_32x32x16_bf16 v[112:127], a[4:7], v[196:199], v[112:127]
    buffer_load_dwordx4 v13, s[12:15], s48 offen offset:3072 lds
    ds_read_b64_tr_b16 a[0:1], v9 offset:0
    ds_read_b64_tr_b16 a[2:3], v9 offset:256
    v_mul_f32 v39, v39, v66
    v_exp_f32_e64 v65, -v43
    v_mfma_f32_32x32x16_bf16 v[112:127], a[8:11], v[200:203], v[112:127]
    ds_read_b64_tr_b16 a[4:5], v9 offset:1024
    ds_read_b64_tr_b16 a[6:7], v9 offset:1280
    v_add_f32 v64, 1.0, v64
    v_rcp_f32 v68, v68
    v_mul_f32 v40, v40, v67
    v_mfma_f32_32x32x16_bf16 v[112:127], a[12:15], v[204:207], v[112:127]
    s_waitcnt vmcnt(8)
    s_add_u32 s62, s58, 196608
    buffer_store_dword v22, v20, s[20:23], s62 offen sc1
    ds_read_b64_tr_b16 a[8:9], v9 offset:2048
    ds_read_b64_tr_b16 a[10:11], v9 offset:2304
    s_waitcnt lgkmcnt(6)
    v_mfma_f32_32x32x16_bf16 v[112:127], a[16:19], v[208:211], v[112:127]
    ds_read_b64_tr_b16 a[12:13], v9 offset:3072
    ds_read_b64_tr_b16 a[14:15], v9 offset:3328
    v_cvt_pk_bf16_f32 v99, v38, v39
    v_exp_f32_e64 v66, -v44
    v_add_f32 v65, 1.0, v65
    v_rcp_f32 v64, v64
    v_mfma_f32_32x32x16_bf16 v[112:127], a[20:23], v[212:215], v[112:127]
    buffer_store_dwordx4 v[96:99], v14, s[20:23], s28 offen offset:2048 sc1
    ds_read_b64_tr_b16 a[16:17], v9 offset:4096
    ds_read_b64_tr_b16 a[18:19], v9 offset:4352
    v_mfma_f32_32x32x16_bf16 v[112:127], a[24:27], v[216:219], v[112:127]
    ds_read_b64_tr_b16 a[20:21], v9 offset:5120
    ds_read_b64_tr_b16 a[22:23], v9 offset:5376
    v_mul_f32 v41, v41, v68
    v_exp_f32_e64 v67, -v45
    s_waitcnt vmcnt(9)
    v_cmp_ne_u32 vcc, s38, v30
    v_mfma_f32_32x32x16_bf16 v[112:127], a[28:31], v[220:223], v[112:127]
    s_cbranch_vccnz L_spin1
L_ok1:
    buffer_load_dwordx4 a[32:35], v2, s[20:23], s29 offen offset:0 sc1
    ds_read_b64_tr_b16 a[24:25], v9 offset:6144
    ds_read_b64_tr_b16 a[26:27], v9 offset:6400
    s_waitcnt lgkmcnt(6)
    v_mfma_f32_32x32x16_bf16 v[112:127], a[0:3], v[224:227], v[112:127]
    ds_read_b64_tr_b16 a[28:29], v9 offset:7168
    ds_read_b64_tr_b16 a[30:31], v9 offset:7424
    v_add_f32 v66, 1.0, v66
    v_rcp_f32 v65, v65
    v_mul_f32 v42, v42, v64
    v_cvt_pk_bf16_f32 v100, v40, v41
    v_mfma_f32_32x32x16_bf16 v[112:127], a[4:7], v[228:231], v[112:127]
    buffer_load_dwordx4 a[36:39], v2, s[20:23], s29 offen offset:1024 sc1
    ds_read_b64_tr_b16 a[0:1], v6 offset:8192
    ds_read_b64_tr_b16 a[2:3], v6 offset:8448
    v_exp_f32_e64 v68, -v46
    v_add_f32 v67, 1.0, v67
    v_mfma_f32_32x32x16_bf16 v[112:127], a[8:11], v[232:235], v[112:127]
    ds_read_b64_tr_b16 a[4:5], v6 offset:9216
    ds_read_b64_tr_b16 a[6:7], v6 offset:9472
    v_rcp_f32 v66, v66
    v_mul_f32 v43, v43, v65
    v_exp_f32_e64 v64, -v47
    v_add_f32 v68, 1.0, v68
    v_mfma_f32_32x32x16_bf16 v[112:127], a[12:15], v[236:239], v[112:127]
    buffer_load_dwordx4 a[40:43], v2, s[20:23], s30 offen offset:0 sc1
    ds_read_b64_tr_b16 a[8:9], v6 offset:10240
    ds_read_b64_tr_b16 a[10:11], v6 offset:10496
    s_waitcnt lgkmcnt(6)
    s_barrier
    v_mfma_f32_32x32x16_bf16 v[112:127], a[16:19], v[240:243], v[112:127]
    ds_read_b64_tr_b16 a[12:13], v6 offset:11264
    ds_read_b64_tr_b16 a[14:15], v6 offset:11520
    v_rcp_f32 v67, v67
    v_mul_f32 v44, v44, v66
    v_cvt_pk_bf16_f32 v101, v42, v43
    s_add_u32 m0, s37, 0
    s_add_u32 s48, s63, 32768
    v_mfma_f32_32x32x16_bf16 v[112:127], a[20:23], v[244:247], v[112:127]
    buffer_load_dwordx4 v10, s[12:15], s48 offen offset:0 lds
    ds_read_b64_tr_b16 a[16:17], v6 offset:12288
    ds_read_b64_tr_b16 a[18:19], v6 offset:12544
    v_add_f32 v64, 1.0, v64
    v_rcp_f32 v68, v68
    v_mfma_f32_32x32x16_bf16 v[112:127], a[24:27], v[248:251], v[112:127]
    ds_read_b64_tr_b16 a[20:21], v6 offset:13312
    ds_read_b64_tr_b16 a[22:23], v6 offset:13568
    v_mul_f32 v45, v45, v67
    v_rcp_f32 v64, v64
    v_mul_f32 v46, v46, v68
    v_cvt_pk_bf16_f32 v102, v44, v45
    v_mfma_f32_32x32x16_bf16 v[112:127], a[28:31], v[252:255], v[112:127]
    buffer_load_dwordx4 v11, s[12:15], s48 offen offset:1024 lds
    ds_read_b64_tr_b16 a[24:25], v6 offset:14336
    ds_read_b64_tr_b16 a[26:27], v6 offset:14592
    s_waitcnt lgkmcnt(6)
    v_mul_f32 v47, v47, v64
    v_cvt_pk_bf16_f32 v103, v46, v47
    v_mfma_f32_32x32x16_bf16 v[32:47], a[0:3], v[128:131], 0
    buffer_store_dwordx4 v[100:103], v14, s[20:23], s28 offen offset:3072 sc1
    ds_read_b64_tr_b16 a[28:29], v6 offset:15360
    ds_read_b64_tr_b16 a[30:31], v6 offset:15616
    v_mfma_f32_32x32x16_bf16 v[32:47], a[4:7], v[132:135], v[32:47]
    ds_read_b64_tr_b16 a[0:1], v7 offset:8192
    ds_read_b64_tr_b16 a[2:3], v7 offset:8448
    v_exp_f32_e64 v64, -v48
    v_exp_f32_e64 v65, -v49
    v_add_f32 v64, 1.0, v64
    v_mfma_f32_32x32x16_bf16 v[32:47], a[8:11], v[136:139], v[32:47]
    ds_read_b64_tr_b16 a[4:5], v7 offset:9216
    ds_read_b64_tr_b16 a[6:7], v7 offset:9472
    v_mov_b32 v128, v21
    v_xor_b32 v129, 64, v21
    v_add_u32 v130, 40960, v128
    v_add_u32 v131, 40960, v129
    v_exp_f32_e64 v66, -v50
    v_mfma_f32_32x32x16_bf16 v[32:47], a[12:15], v[140:143], v[32:47]
    ds_read_b64_tr_b16 a[8:9], v7 offset:10240
    ds_read_b64_tr_b16 a[10:11], v7 offset:10496
    s_waitcnt lgkmcnt(6)
    v_add_u32 v132, 81920, v128
    v_add_u32 v133, 81920, v129
    v_add_u32 v134, 122880, v128
    v_add_f32 v65, 1.0, v65
    v_mfma_f32_32x32x16_bf16 v[32:47], a[16:19], v[144:147], v[32:47]
    ds_read_b64_tr_b16 a[12:13], v7 offset:11264
    ds_read_b64_tr_b16 a[14:15], v7 offset:11520
    v_add_u32 v135, 122880, v129
    v_rcp_f32 v64, v64
    v_exp_f32_e64 v67, -v51
    v_add_f32 v66, 1.0, v66
    v_mfma_f32_32x32x16_bf16 v[32:47], a[20:23], v[148:151], v[32:47]
    ds_read_b64_tr_b16 a[16:17], v7 offset:12288
    ds_read_b64_tr_b16 a[18:19], v7 offset:12544
    v_rcp_f32 v65, v65
    v_mul_f32 v48, v48, v64
    v_exp_f32_e64 v68, -v52
    v_mfma_f32_32x32x16_bf16 v[32:47], a[24:27], v[152:155], v[32:47]
    buffer_load_dwordx4 v12, s[12:15], s48 offen offset:2048 lds
    ds_read_b64_tr_b16 a[20:21], v7 offset:13312
    ds_read_b64_tr_b16 a[22:23], v7 offset:13568
    v_add_f32 v67, 1.0, v67
    v_rcp_f32 v66, v66
    v_mfma_f32_32x32x16_bf16 v[32:47], a[28:31], v[156:159], v[32:47]
    ds_read_b64_tr_b16 a[24:25], v7 offset:14336
    ds_read_b64_tr_b16 a[26:27], v7 offset:14592
    s_waitcnt lgkmcnt(6)
    v_mul_f32 v49, v49, v65
    v_exp_f32_e64 v64, -v53
    v_add_f32 v68, 1.0, v68
    v_mfma_f32_32x32x16_bf16 v[32:47], a[0:3], v[160:163], v[32:47]
    buffer_load_dwordx4 v13, s[12:15], s48 offen offset:3072 lds
    ds_read_b64_tr_b16 a[28:29], v7 offset:15360
    ds_read_b64_tr_b16 a[30:31], v7 offset:15616
    v_rcp_f32 v67, v67
    v_mul_f32 v50, v50, v66
    v_mfma_f32_32x32x16_bf16 v[32:47], a[4:7], v[164:167], v[32:47]
    ds_read_b64_tr_b16 a[0:1], v8 offset:8192
    ds_read_b64_tr_b16 a[2:3], v8 offset:8448
    v_cvt_pk_bf16_f32 v104, v48, v49
    v_exp_f32_e64 v65, -v54
    s_add_u32 m0, s37, 4096
    s_add_u32 s48, s61, 0
    v_mfma_f32_32x32x16_bf16 v[32:47], a[8:11], v[168:171], v[32:47]
    buffer_load_dwordx4 v10, s[16:19], s48 offen offset:0 lds
    ds_read_b64_tr_b16 a[4:5], v8 offset:9216
    ds_read_b64_tr_b16 a[6:7], v8 offset:9472
    v_add_f32 v64, 1.0, v64
    v_rcp_f32 v68, v68
    v_mfma_f32_32x32x16_bf16 v[32:47], a[12:15], v[172:175], v[32:47]
    ds_read_b64_tr_b16 a[8:9], v8 offset:10240
    ds_read_b64_tr_b16 a[10:11], v8 offset:10496
    s_waitcnt lgkmcnt(6)
    v_mul_f32 v51, v51, v67
    v_exp_f32_e64 v66, -v55
    v_add_f32 v65, 1.0, v65
    v_mfma_f32_32x32x16_bf16 v[32:47], a[16:19], v[176:179], v[32:47]
    buffer_load_dwordx4 v11, s[16:19], s48 offen offset:1024 lds
    ds_read_b64_tr_b16 a[12:13], v8 offset:11264
    ds_read_b64_tr_b16 a[14:15], v8 offset:11520
    v_rcp_f32 v64, v64
    v_mul_f32 v52, v52, v68
    v_cvt_pk_bf16_f32 v105, v50, v51
    v_mfma_f32_32x32x16_bf16 v[32:47], a[20:23], v[180:183], v[32:47]
    ds_read_b64_tr_b16 a[16:17], v8 offset:12288
    ds_read_b64_tr_b16 a[18:19], v8 offset:12544
    v_exp_f32_e64 v67, -v56
    v_add_f32 v66, 1.0, v66
    v_rcp_f32 v65, v65
    v_mul_f32 v53, v53, v64
    v_mfma_f32_32x32x16_bf16 v[32:47], a[24:27], v[184:187], v[32:47]
    buffer_load_dwordx4 v12, s[16:19], s48 offen offset:2048 lds
    ds_read_b64_tr_b16 a[20:21], v8 offset:13312
    ds_read_b64_tr_b16 a[22:23], v8 offset:13568
    v_exp_f32_e64 v68, -v57
    v_add_f32 v67, 1.0, v67
    v_mfma_f32_32x32x16_bf16 v[32:47], a[28:31], v[188:191], v[32:47]
    ds_read_b64_tr_b16 a[24:25], v8 offset:14336
    ds_read_b64_tr_b16 a[26:27], v8 offset:14592
    s_waitcnt lgkmcnt(6)
    v_rcp_f32 v66, v66
    v_mul_f32 v54, v54, v65
    v_cvt_pk_bf16_f32 v106, v52, v53
    v_mfma_f32_32x32x16_bf16 v[32:47], a[0:3], v[192:195], v[32:47]
    buffer_load_dwordx4 v13, s[16:19], s48 offen offset:3072 lds
    ds_read_b64_tr_b16 a[28:29], v8 offset:15360
    ds_read_b64_tr_b16 a[30:31], v8 offset:15616
    v_exp_f32_e64 v64, -v58
    v_add_f32 v68, 1.0, v68
    v_mfma_f32_32x32x16_bf16 v[32:47], a[4:7], v[196:199], v[32:47]
    ds_read_b64_tr_b16 a[0:1], v9 offset:8192
    ds_read_b64_tr_b16 a[2:3], v9 offset:8448
    v_rcp_f32 v67, v67
    v_mul_f32 v55, v55, v66
    v_exp_f32_e64 v65, -v59
    v_mfma_f32_32x32x16_bf16 v[32:47], a[8:11], v[200:203], v[32:47]
    ds_read_b64_tr_b16 a[4:5], v9 offset:9216
    ds_read_b64_tr_b16 a[6:7], v9 offset:9472
    v_add_f32 v64, 1.0, v64
    v_rcp_f32 v68, v68
    v_mul_f32 v56, v56, v67
    v_mfma_f32_32x32x16_bf16 v[32:47], a[12:15], v[204:207], v[32:47]
    s_mov_b32 s51, 131072
    buffer_load_dword v31, v26, s[20:23], s51 offen sc1
    s_waitcnt vmcnt(7)
    s_add_u32 s62, s58, 262144
    buffer_store_dword v22, v20, s[20:23], s62 offen sc1
    ds_read_b64_tr_b16 a[8:9], v9 offset:10240
    ds_read_b64_tr_b16 a[10:11], v9 offset:10496
    s_waitcnt lgkmcnt(6)
    v_mfma_f32_32x32x16_bf16 v[32:47], a[16:19], v[208:211], v[32:47]
    ds_read_b64_tr_b16 a[12:13], v9 offset:11264
    ds_read_b64_tr_b16 a[14:15], v9 offset:11520
    v_cvt_pk_bf16_f32 v107, v54, v55
    v_exp_f32_e64 v66, -v60
    v_add_f32 v65, 1.0, v65
    v_rcp_f32 v64, v64
    v_mfma_f32_32x32x16_bf16 v[32:47], a[20:23], v[212:215], v[32:47]
    buffer_store_dwordx4 v[104:107], v15, s[20:23], s28 offen offset:0 sc1
    ds_read_b64_tr_b16 a[16:17], v9 offset:12288
    ds_read_b64_tr_b16 a[18:19], v9 offset:12544
    v_mfma_f32_32x32x16_bf16 v[32:47], a[24:27], v[216:219], v[32:47]
    buffer_load_dwordx4 a[44:47], v2, s[20:23], s30 offen offset:1024 sc1
    ds_read_b64_tr_b16 a[20:21], v9 offset:13312
    ds_read_b64_tr_b16 a[22:23], v9 offset:13568
    v_mul_f32 v57, v57, v68
    v_exp_f32_e64 v67, -v61
    v_add_f32 v66, 1.0, v66
    v_mfma_f32_32x32x16_bf16 v[32:47], a[28:31], v[220:223], v[32:47]
    ds_read_b64_tr_b16 a[24:25], v9 offset:14336
    ds_read_b64_tr_b16 a[26:27], v9 offset:14592
    s_waitcnt lgkmcnt(6)
    v_rcp_f32 v65, v65
    v_mul_f32 v58, v58, v64
    v_cvt_pk_bf16_f32 v108, v56, v57
    v_mfma_f32_32x32x16_bf16 v[32:47], a[0:3], v[224:227], v[32:47]
    buffer_load_dwordx4 a[48:51], v2, s[20:23], s31 offen offset:0 sc1
    ds_read_b64_tr_b16 a[28:29], v9 offset:15360
    ds_read_b64_tr_b16 a[30:31], v9 offset:15616
    v_exp_f32_e64 v68, -v62
    v_add_f32 v67, 1.0, v67
    v_mfma_f32_32x32x16_bf16 v[32:47], a[4:7], v[228:231], v[32:47]
    ds_read_b64_tr_b16 a[0:1], v129 offset:16384
    ds_read_b64_tr_b16 a[2:3], v129 offset:17408
    v_rcp_f32 v66, v66
    v_mul_f32 v59, v59, v65
    v_exp_f32_e64 v64, -v63
    v_mfma_f32_32x32x16_bf16 v[32:47], a[8:11], v[232:235], v[32:47]
    buffer_load_dwordx4 a[52:55], v2, s[20:23], s31 offen offset:1024 sc1
    ds_read_b64_tr_b16 a[4:5], v128 offset:16384
    ds_read_b64_tr_b16 a[6:7], v128 offset:17408
    v_add_f32 v68, 1.0, v68
    v_rcp_f32 v67, v67
    v_mfma_f32_32x32x16_bf16 v[32:47], a[12:15], v[236:239], v[32:47]
    ds_read_b64_tr_b16 a[8:9], v129 offset:18432
    ds_read_b64_tr_b16 a[10:11], v129 offset:19456
    s_waitcnt lgkmcnt(6)
    s_barrier
    s_add_u32 m0, s37, 8192
    s_add_u32 s48, s61, 32768
    v_mfma_f32_32x32x16_bf16 v[32:47], a[16:19], v[240:243], v[32:47]
    buffer_load_dwordx4 v10, s[16:19], s48 offen offset:0 lds
    ds_read_b64_tr_b16 a[12:13], v128 offset:18432
    ds_read_b64_tr_b16 a[14:15], v128 offset:19456
    v_mul_f32 v60, v60, v66
    v_cvt_pk_bf16_f32 v109, v58, v59
    v_add_f32 v64, 1.0, v64
    v_mfma_f32_32x32x16_bf16 v[32:47], a[20:23], v[244:247], v[32:47]
    buffer_load_dwordx4 v11, s[16:19], s48 offen offset:1024 lds
    ds_read_b64_tr_b16 a[16:17], v129 offset:20480
    ds_read_b64_tr_b16 a[18:19], v129 offset:21504
    v_rcp_f32 v68, v68
    v_mul_f32 v61, v61, v67
    v_mfma_f32_32x32x16_bf16 v[32:47], a[24:27], v[248:251], v[32:47]
    ds_read_b64_tr_b16 a[20:21], v128 offset:20480
    ds_read_b64_tr_b16 a[22:23], v128 offset:21504
    v_rcp_f32 v64, v64
    v_mul_f32 v62, v62, v68
    v_cvt_pk_bf16_f32 v110, v60, v61
    v_mul_f32 v63, v63, v64
    v_mfma_f32_32x32x16_bf16 v[32:47], a[28:31], v[252:255], v[32:47]
    buffer_load_dwordx4 v12, s[16:19], s48 offen offset:2048 lds
    ds_read_b64_tr_b16 a[24:25], v129 offset:22528
    ds_read_b64_tr_b16 a[26:27], v129 offset:23552
    s_waitcnt lgkmcnt(6)
    v_cvt_pk_bf16_f32 v111, v62, v63
    v_mfma_f32_32x32x16_bf16 v[224:239], a[0:3], v[72:75], 0
    buffer_store_dwordx4 v[108:111], v15, s[20:23], s28 offen offset:1024 sc1
    ds_read_b64_tr_b16 a[28:29], v128 offset:22528
    ds_read_b64_tr_b16 a[30:31], v128 offset:23552
    v_mfma_f32_32x32x16_bf16 v[240:255], a[4:7], v[72:75], 0
    ds_read_b64_tr_b16 a[0:1], v129 offset:24576
    ds_read_b64_tr_b16 a[2:3], v129 offset:25600
    v_exp_f32_e64 v64, -v112
    v_exp_f32_e64 v65, -v113
    v_add_f32 v64, 1.0, v64
    v_exp_f32_e64 v66, -v114
    v_add_f32 v65, 1.0, v65
    v_mfma_f32_32x32x16_bf16 v[224:239], a[8:11], v[76:79], v[224:239]
    ds_read_b64_tr_b16 a[4:5], v128 offset:24576
    ds_read_b64_tr_b16 a[6:7], v128 offset:25600
    v_rcp_f32 v64, v64
    v_exp_f32_e64 v67, -v115
    v_add_f32 v66, 1.0, v66
    v_rcp_f32 v65, v65
    v_mfma_f32_32x32x16_bf16 v[240:255], a[12:15], v[76:79], v[240:255]
    s_mov_b32 s51, 196608
    buffer_load_dword v23, v3, s[20:23], s51 offen sc1
    ds_read_b64_tr_b16 a[8:9], v129 offset:26624
    ds_read_b64_tr_b16 a[10:11], v129 offset:27648
    s_waitcnt lgkmcnt(6)
    v_mul_f32 v112, v112, v64
    v_exp_f32_e64 v68, -v116
    v_mfma_f32_32x32x16_bf16 v[224:239], a[16:19], v[80:83], v[224:239]
    ds_read_b64_tr_b16 a[12:13], v128 offset:26624
    ds_read_b64_tr_b16 a[14:15], v128 offset:27648
    v_add_f32 v67, 1.0, v67
    v_rcp_f32 v66, v66
    v_mul_f32 v113, v113, v65
    v_exp_f32_e64 v64, -v117
    v_add_f32 v68, 1.0, v68
    v_mfma_f32_32x32x16_bf16 v[240:255], a[20:23], v[80:83], v[240:255]
    buffer_load_dwordx4 v13, s[16:19], s48 offen offset:3072 lds
    ds_read_b64_tr_b16 a[16:17], v129 offset:28672
    ds_read_b64_tr_b16 a[18:19], v129 offset:29696
    v_rcp_f32 v67, v67
    v_mul_f32 v114, v114, v66
    s_waitcnt vmcnt(11)
    v_cmp_ne_u32 vcc, s38, v31
    v_mfma_f32_32x32x16_bf16 v[224:239], a[24:27], v[84:87], v[224:239]
    s_cbranch_vccnz L_spin2
L_ok2:
    buffer_load_dwordx4 a[56:59], v2, s[20:23], s29 offen offset:2048 sc1
    ds_read_b64_tr_b16 a[20:21], v128 offset:28672
    ds_read_b64_tr_b16 a[22:23], v128 offset:29696
    v_cvt_pk_bf16_f32 v112, v112, v113
    v_exp_f32_e64 v65, -v118
    v_mfma_f32_32x32x16_bf16 v[240:255], a[28:31], v[84:87], v[240:255]
    ds_read_b64_tr_b16 a[24:25], v129 offset:30720
    ds_read_b64_tr_b16 a[26:27], v129 offset:31744
    s_waitcnt lgkmcnt(6)
    v_add_f32 v64, 1.0, v64
    v_rcp_f32 v68, v68
    v_mul_f32 v115, v115, v67
    v_exp_f32_e64 v66, -v119
    v_mfma_f32_32x32x16_bf16 v[224:239], a[0:3], v[88:91], v[224:239]
    buffer_load_dwordx4 a[60:63], v2, s[20:23], s29 offen offset:3072 sc1
    ds_read_b64_tr_b16 a[28:29], v128 offset:30720
    ds_read_b64_tr_b16 a[30:31], v128 offset:31744
    v_add_f32 v65, 1.0, v65
    v_rcp_f32 v64, v64
    v_mul_f32 v116, v116, v68
    v_cvt_pk_bf16_f32 v113, v114, v115
    v_mfma_f32_32x32x16_bf16 v[240:255], a[4:7], v[88:91], v[240:255]
    ds_read_b64_tr_b16 a[0:1], v129 offset:32768
    ds_read_b64_tr_b16 a[2:3], v129 offset:33792
    v_exp_f32_e64 v67, -v120
    v_add_f32 v66, 1.0, v66
    v_rcp_f32 v65, v65
    v_mul_f32 v117, v117, v64
    v_exp_f32_e64 v68, -v121
    v_mfma_f32_32x32x16_bf16 v[224:239], a[8:11], v[92:95], v[224:239]
    buffer_load_dwordx4 a[64:67], v2, s[20:23], s30 offen offset:2048 sc1
    ds_read_b64_tr_b16 a[4:5], v128 offset:32768
    ds_read_b64_tr_b16 a[6:7], v128 offset:33792
    v_add_f32 v67, 1.0, v67
    v_rcp_f32 v66, v66
    v_mul_f32 v118, v118, v65
    v_cvt_pk_bf16_f32 v114, v116, v117
    v_mfma_f32_32x32x16_bf16 v[240:255], a[12:15], v[92:95], v[240:255]
    ds_read_b64_tr_b16 a[8:9], v129 offset:34816
    ds_read_b64_tr_b16 a[10:11], v129 offset:35840
    s_waitcnt lgkmcnt(6)
    v_exp_f32_e64 v64, -v122
    v_add_f32 v68, 1.0, v68
    v_rcp_f32 v67, v67
    v_mul_f32 v119, v119, v66
    v_mfma_f32_32x32x16_bf16 v[224:239], a[16:19], v[96:99], v[224:239]
    ds_read_b64_tr_b16 a[12:13], v128 offset:34816
    ds_read_b64_tr_b16 a[14:15], v128 offset:35840
    v_exp_f32_e64 v65, -v123
    v_add_f32 v64, 1.0, v64
    v_rcp_f32 v68, v68
    v_mul_f32 v120, v120, v67
    v_mfma_f32_32x32x16_bf16 v[240:255], a[20:23], v[96:99], v[240:255]
    ds_read_b64_tr_b16 a[16:17], v131 offset:16384
    ds_read_b64_tr_b16 a[18:19], v131 offset:17408
    v_cvt_pk_bf16_f32 v115, v118, v119
    v_exp_f32_e64 v66, -v124
    v_add_f32 v65, 1.0, v65
    v_rcp_f32 v64, v64
    v_mul_f32 v121, v121, v68
    v_mfma_f32_32x32x16_bf16 v[224:239], a[24:27], v[100:103], v[224:239]
    buffer_store_dwordx4 v[112:115], v15, s[20:23], s28 offen offset:2048 sc1
    ds_read_b64_tr_b16 a[20:21], v130 offset:16384
    ds_read_b64_tr_b16 a[22:23], v130 offset:17408
    v_mfma_f32_32x32x16_bf16 v[240:255], a[28:31], v[100:103], v[240:255]
    buffer_load_dwordx4 a[68:71], v2, s[20:23], s30 offen offset:3072 sc1
    ds_read_b64_tr_b16 a[24:25], v131 offset:18432
    ds_read_b64_tr_b16 a[26:27], v131 offset:19456
    s_waitcnt lgkmcnt(6)
    v_exp_f32_e64 v67, -v125
    v_add_f32 v66, 1.0, v66
    v_mfma_f32_32x32x16_bf16 v[224:239], a[0:3], v[104:107], v[224:239]
    ds_read_b64_tr_b16 a[28:29], v130 offset:18432
    ds_read_b64_tr_b16 a[30:31], v130 offset:19456
    v_rcp_f32 v65, v65
    v_mul_f32 v122, v122, v64
    v_cvt_pk_bf16_f32 v116, v120, v121
    v_exp_f32_e64 v68, -v126
    v_add_f32 v67, 1.0, v67
    v_mfma_f32_32x32x16_bf16 v[240:255], a[4:7], v[104:107], v[240:255]
    buffer_load_dwordx4 a[72:75], v2, s[20:23], s31 offen offset:2048 sc1
    ds_read_b64_tr_b16 a[0:1], v133 offset:16384
    ds_read_b64_tr_b16 a[2:3], v133 offset:17408
    v_rcp_f32 v66, v66
    v_mul_f32 v123, v123, v65
    v_exp_f32_e64 v64, -v127
    v_mfma_f32_32x32x16_bf16 v[224:239], a[8:11], v[108:111], v[224:239]
    buffer_load_dwordx4 a[76:79], v2, s[20:23], s31 offen offset:3072 sc1
    ds_read_b64_tr_b16 a[4:5], v132 offset:16384
    ds_read_b64_tr_b16 a[6:7], v132 offset:17408
    v_add_f32 v68, 1.0, v68
    v_rcp_f32 v67, v67
    v_mul_f32 v124, v124, v66
    v_cvt_pk_bf16_f32 v117, v122, v123
    v_mfma_f32_32x32x16_bf16 v[240:255], a[12:15], v[108:111], v[240:255]
    ds_read_b64_tr_b16 a[8:9], v133 offset:18432
    ds_read_b64_tr_b16 a[10:11], v133 offset:19456
    s_waitcnt lgkmcnt(6)
    v_add_f32 v64, 1.0, v64
    v_rcp_f32 v68, v68
    v_mul_f32 v125, v125, v67
    s_waitcnt vmcnt(8)
    v_cmp_ne_u32 vcc, s38, v23
    v_mfma_f32_32x32x16_bf16 v[224:239], a[16:19], a[32:35], v[224:239]
    s_cbranch_vccnz L_spin3
L_ok3:
    buffer_load_dwordx4 a[80:83], v14, s[20:23], s29 offen offset:0 sc1
    ds_read_b64_tr_b16 a[12:13], v132 offset:18432
    ds_read_b64_tr_b16 a[14:15], v132 offset:19456
    v_rcp_f32 v64, v64
    v_mul_f32 v126, v126, v68
    v_mfma_f32_32x32x16_bf16 v[240:255], a[20:23], a[32:35], v[240:255]
    s_mov_b32 s51, 262144
    buffer_load_dword v30, v3, s[20:23], s51 offen sc1
    ds_read_b64_tr_b16 a[16:17], v135 offset:16384
    ds_read_b64_tr_b16 a[18:19], v135 offset:17408
    v_cvt_pk_bf16_f32 v118, v124, v125
    v_mul_f32 v127, v127, v64
    v_cvt_pk_bf16_f32 v119, v126, v127
    v_mfma_f32_32x32x16_bf16 v[224:239], a[24:27], a[36:39], v[224:239]
    buffer_store_dwordx4 v[116:119], v15, s[20:23], s28 offen offset:3072 sc1
    ds_read_b64_tr_b16 a[20:21], v134 offset:16384
    ds_read_b64_tr_b16 a[22:23], v134 offset:17408
    v_mfma_f32_32x32x16_bf16 v[240:255], a[28:31], a[36:39], v[240:255]
    ds_read_b64_tr_b16 a[24:25], v135 offset:18432
    ds_read_b64_tr_b16 a[26:27], v135 offset:19456
    s_waitcnt lgkmcnt(6)
    v_exp_f32_e64 v64, -v32
    v_exp_f32_e64 v65, -v33
    v_add_f32 v64, 1.0, v64
    v_mfma_f32_32x32x16_bf16 v[224:239], a[0:3], a[40:43], v[224:239]
    ds_read_b64_tr_b16 a[28:29], v134 offset:18432
    ds_read_b64_tr_b16 a[30:31], v134 offset:19456
    v_exp_f32_e64 v66, -v34
    v_add_f32 v65, 1.0, v65
    v_rcp_f32 v64, v64
    v_exp_f32_e64 v67, -v35
    v_mfma_f32_32x32x16_bf16 v[240:255], a[4:7], a[40:43], v[240:255]
    ds_read_b64_tr_b16 a[0:1], v131 offset:20480
    ds_read_b64_tr_b16 a[2:3], v131 offset:21504
    v_add_f32 v66, 1.0, v66
    v_rcp_f32 v65, v65
    v_mul_f32 v32, v32, v64
    v_exp_f32_e64 v68, -v36
    v_add_f32 v67, 1.0, v67
    v_mfma_f32_32x32x16_bf16 v[224:239], a[8:11], a[44:47], v[224:239]
    buffer_load_dwordx4 a[84:87], v14, s[20:23], s29 offen offset:1024 sc1
    ds_read_b64_tr_b16 a[4:5], v130 offset:20480
    ds_read_b64_tr_b16 a[6:7], v130 offset:21504
    v_rcp_f32 v66, v66
    v_mul_f32 v33, v33, v65
    v_exp_f32_e64 v64, -v37
    v_mfma_f32_32x32x16_bf16 v[240:255], a[12:15], a[44:47], v[240:255]
    buffer_load_dwordx4 a[88:91], v14, s[20:23], s30 offen offset:0 sc1
    ds_read_b64_tr_b16 a[8:9], v131 offset:22528
    ds_read_b64_tr_b16 a[10:11], v131 offset:23552
    s_waitcnt lgkmcnt(6)
    v_add_f32 v68, 1.0, v68
    v_rcp_f32 v67, v67
    v_mul_f32 v34, v34, v66
    v_mfma_f32_32x32x16_bf16 v[224:239], a[16:19], a[48:51], v[224:239]
    ds_read_b64_tr_b16 a[12:13], v130 offset:22528
    ds_read_b64_tr_b16 a[14:15], v130 offset:23552
    v_cvt_pk_bf16_f32 v120, v32, v33
    v_exp_f32_e64 v65, -v38
    v_add_f32 v64, 1.0, v64
    v_rcp_f32 v68, v68
    v_mul_f32 v35, v35, v67
    v_mfma_f32_32x32x16_bf16 v[240:255], a[20:23], a[48:51], v[240:255]
    buffer_load_dwordx4 a[92:95], v14, s[20:23], s30 offen offset:1024 sc1
    ds_read_b64_tr_b16 a[16:17], v133 offset:20480
    ds_read_b64_tr_b16 a[18:19], v133 offset:21504
    v_exp_f32_e64 v66, -v39
    v_add_f32 v65, 1.0, v65
    v_rcp_f32 v64, v64
    v_mfma_f32_32x32x16_bf16 v[224:239], a[24:27], a[52:55], v[224:239]
    buffer_load_dwordx4 a[96:99], v14, s[20:23], s31 offen offset:0 sc1
    ds_read_b64_tr_b16 a[20:21], v132 offset:20480
    ds_read_b64_tr_b16 a[22:23], v132 offset:21504
    v_mul_f32 v36, v36, v68
    v_cvt_pk_bf16_f32 v121, v34, v35
    v_exp_f32_e64 v67, -v40
    v_add_f32 v66, 1.0, v66
    v_mfma_f32_32x32x16_bf16 v[240:255], a[28:31], a[52:55], v[240:255]
    ds_read_b64_tr_b16 a[24:25], v133 offset:22528
    ds_read_b64_tr_b16 a[26:27], v133 offset:23552
    s_waitcnt lgkmcnt(6)
    v_rcp_f32 v65, v65
    v_mul_f32 v37, v37, v64
    v_exp_f32_e64 v68, -v41
    v_add_f32 v67, 1.0, v67
    s_waitcnt vmcnt(12)
    v_mfma_f32_32x32x16_bf16 v[224:239], a[0:3], a[56:59], v[224:239]
    buffer_load_dwordx4 a[100:103], v14, s[20:23], s31 offen offset:1024 sc1
    ds_read_b64_tr_b16 a[28:29], v132 offset:22528
    ds_read_b64_tr_b16 a[30:31], v132 offset:23552
    v_rcp_f32 v66, v66
    v_mul_f32 v38, v38, v65
    v_cvt_pk_bf16_f32 v122, v36, v37
    v_mfma_f32_32x32x16_bf16 v[240:255], a[4:7], a[56:59], v[240:255]
    ds_read_b64_tr_b16 a[0:1], v135 offset:20480
    ds_read_b64_tr_b16 a[2:3], v135 offset:21504
    v_exp_f32_e64 v64, -v42
    v_add_f32 v68, 1.0, v68
    v_rcp_f32 v67, v67
    v_mul_f32 v39, v39, v66
    v_mfma_f32_32x32x16_bf16 v[224:239], a[8:11], a[60:63], v[224:239]
    ds_read_b64_tr_b16 a[4:5], v134 offset:20480
    ds_read_b64_tr_b16 a[6:7], v134 offset:21504
    v_exp_f32_e64 v65, -v43
    v_add_f32 v64, 1.0, v64
    v_rcp_f32 v68, v68
    v_mul_f32 v40, v40, v67
    v_mfma_f32_32x32x16_bf16 v[240:255], a[12:15], a[60:63], v[240:255]
    ds_read_b64_tr_b16 a[8:9], v135 offset:22528
    ds_read_b64_tr_b16 a[10:11], v135 offset:23552
    s_waitcnt lgkmcnt(6)
    v_cvt_pk_bf16_f32 v123, v38, v39
    v_exp_f32_e64 v66, -v44
    v_add_f32 v65, 1.0, v65
    v_rcp_f32 v64, v64
    s_waitcnt vmcnt(10)
    v_mfma_f32_32x32x16_bf16 v[224:239], a[16:19], a[64:67], v[224:239]
    buffer_store_dwordx4 v[120:123], v16, s[20:23], s28 offen offset:0 sc1
    ds_read_b64_tr_b16 a[12:13], v134 offset:22528
    ds_read_b64_tr_b16 a[14:15], v134 offset:23552
    v_mfma_f32_32x32x16_bf16 v[240:255], a[20:23], a[64:67], v[240:255]
    ds_read_b64_tr_b16 a[16:17], v131 offset:24576
    ds_read_b64_tr_b16 a[18:19], v131 offset:25600
    v_mul_f32 v41, v41, v68
    v_exp_f32_e64 v67, -v45
    v_add_f32 v66, 1.0, v66
    s_waitcnt vmcnt(7)
    v_cmp_ne_u32 vcc, s38, v30
    v_mfma_f32_32x32x16_bf16 v[224:239], a[24:27], a[68:71], v[224:239]
    s_cbranch_vccnz L_spin4
L_ok4:
    buffer_load_dwordx4 a[104:107], v14, s[20:23], s29 offen offset:2048 sc1
    ds_read_b64_tr_b16 a[20:21], v130 offset:24576
    ds_read_b64_tr_b16 a[22:23], v130 offset:25600
    v_rcp_f32 v65, v65
    v_mul_f32 v42, v42, v64
    v_mfma_f32_32x32x16_bf16 v[240:255], a[28:31], a[68:71], v[240:255]
    buffer_load_dwordx4 a[108:111], v14, s[20:23], s29 offen offset:3072 sc1
    ds_read_b64_tr_b16 a[24:25], v131 offset:26624
    ds_read_b64_tr_b16 a[26:27], v131 offset:27648
    s_waitcnt lgkmcnt(6)
    v_cvt_pk_bf16_f32 v124, v40, v41
    v_exp_f32_e64 v68, -v46
    v_add_f32 v67, 1.0, v67
    v_mfma_f32_32x32x16_bf16 v[224:239], a[0:3], a[72:75], v[224:239]
    ds_read_b64_tr_b16 a[28:29], v130 offset:26624
    ds_read_b64_tr_b16 a[30:31], v130 offset:27648
    v_rcp_f32 v66, v66
    v_mul_f32 v43, v43, v65
    v_exp_f32_e64 v64, -v47
    v_add_f32 v68, 1.0, v68
    v_mfma_f32_32x32x16_bf16 v[240:255], a[4:7], a[72:75], v[240:255]
    buffer_load_dwordx4 a[112:115], v14, s[20:23], s30 offen offset:2048 sc1
    ds_read_b64_tr_b16 a[0:1], v133 offset:24576
    ds_read_b64_tr_b16 a[2:3], v133 offset:25600
    v_rcp_f32 v67, v67
    v_mul_f32 v44, v44, v66
    v_cvt_pk_bf16_f32 v125, v42, v43
    v_add_f32 v64, 1.0, v64
    v_mfma_f32_32x32x16_bf16 v[224:239], a[8:11], a[76:79], v[224:239]
    ds_read_b64_tr_b16 a[4:5], v132 offset:24576
    ds_read_b64_tr_b16 a[6:7], v132 offset:25600
    v_rcp_f32 v68, v68
    v_mul_f32 v45, v45, v67
    v_rcp_f32 v64, v64
    v_mul_f32 v46, v46, v68
    v_mfma_f32_32x32x16_bf16 v[240:255], a[12:15], a[76:79], v[240:255]
    buffer_load_dwordx4 a[116:119], v14, s[20:23], s30 offen offset:3072 sc1
    ds_read_b64_tr_b16 a[8:9], v133 offset:26624
    ds_read_b64_tr_b16 a[10:11], v133 offset:27648
    s_waitcnt lgkmcnt(6)
    v_cvt_pk_bf16_f32 v126, v44, v45
    v_mul_f32 v47, v47, v64
    v_cvt_pk_bf16_f32 v127, v46, v47
    s_waitcnt vmcnt(9)
    v_mfma_f32_32x32x16_bf16 v[224:239], a[16:19], a[80:83], v[224:239]
    buffer_store_dwordx4 v[124:127], v16, s[20:23], s28 offen offset:1024 sc1
    ds_read_b64_tr_b16 a[12:13], v132 offset:26624
    ds_read_b64_tr_b16 a[14:15], v132 offset:27648
    v_mfma_f32_32x32x16_bf16 v[240:255], a[20:23], a[80:83], v[240:255]
    ds_read_b64_tr_b16 a[16:17], v135 offset:24576
    ds_read_b64_tr_b16 a[18:19], v135 offset:25600
    v_mfma_f32_32x32x16_bf16 v[224:239], a[24:27], a[84:87], v[224:239]
    ds_read_b64_tr_b16 a[20:21], v134 offset:24576
    ds_read_b64_tr_b16 a[22:23], v134 offset:25600
    v_mfma_f32_32x32x16_bf16 v[240:255], a[28:31], a[84:87], v[240:255]
    ds_read_b64_tr_b16 a[24:25], v135 offset:26624
    ds_read_b64_tr_b16 a[26:27], v135 offset:27648
    s_waitcnt lgkmcnt(6)
    s_waitcnt vmcnt(8)
    v_mfma_f32_32x32x16_bf16 v[224:239], a[0:3], a[88:91], v[224:239]
    ds_read_b64_tr_b16 a[28:29], v134 offset:26624
    ds_read_b64_tr_b16 a[30:31], v134 offset:27648
    v_mfma_f32_32x32x16_bf16 v[240:255], a[4:7], a[88:91], v[240:255]
    buffer_load_dwordx4 a[120:123], v14, s[20:23], s31 offen offset:2048 sc1
    ds_read_b64_tr_b16 a[0:1], v129 offset:36864
    ds_read_b64_tr_b16 a[2:3], v129 offset:37888
    v_mfma_f32_32x32x16_bf16 v[224:239], a[8:11], a[92:95], v[224:239]
    ds_read_b64_tr_b16 a[4:5], v128 offset:36864
    ds_read_b64_tr_b16 a[6:7], v128 offset:37888
    v_mfma_f32_32x32x16_bf16 v[240:255], a[12:15], a[92:95], v[240:255]
    buffer_load_dwordx4 a[124:127], v14, s[20:23], s31 offen offset:3072 sc1
    ds_read_b64_tr_b16 a[8:9], v129 offset:38912
    ds_read_b64_tr_b16 a[10:11], v129 offset:39936
    s_waitcnt lgkmcnt(6)
    s_waitcnt vmcnt(8)
    v_mfma_f32_32x32x16_bf16 v[224:239], a[16:19], a[96:99], v[224:239]
    ds_read_b64_tr_b16 a[12:13], v128 offset:38912
    ds_read_b64_tr_b16 a[14:15], v128 offset:39936
    v_mfma_f32_32x32x16_bf16 v[240:255], a[20:23], a[96:99], v[240:255]
    buffer_load_dwordx4 a[128:131], v15, s[20:23], s29 offen offset:0 sc1
    ds_read_b64_tr_b16 a[16:17], v131 offset:28672
    ds_read_b64_tr_b16 a[18:19], v131 offset:29696
    v_mfma_f32_32x32x16_bf16 v[224:239], a[24:27], a[100:103], v[224:239]
    ds_read_b64_tr_b16 a[20:21], v130 offset:28672
    ds_read_b64_tr_b16 a[22:23], v130 offset:29696
    v_mfma_f32_32x32x16_bf16 v[240:255], a[28:31], a[100:103], v[240:255]
    buffer_load_dwordx4 a[132:135], v15, s[20:23], s29 offen offset:1024 sc1
    ds_read_b64_tr_b16 a[24:25], v131 offset:30720
    ds_read_b64_tr_b16 a[26:27], v131 offset:31744
    s_waitcnt lgkmcnt(6)
    v_mfma_f32_32x32x16_bf16 v[224:239], a[0:3], v[112:115], v[224:239]
    ds_read_b64_tr_b16 a[28:29], v130 offset:30720
    ds_read_b64_tr_b16 a[30:31], v130 offset:31744
    v_mfma_f32_32x32x16_bf16 v[240:255], a[4:7], v[112:115], v[240:255]
    buffer_load_dwordx4 a[136:139], v15, s[20:23], s30 offen offset:0 sc1
    ds_read_b64_tr_b16 a[0:1], v133 offset:28672
    ds_read_b64_tr_b16 a[2:3], v133 offset:29696
    v_mfma_f32_32x32x16_bf16 v[224:239], a[8:11], v[116:119], v[224:239]
    ds_read_b64_tr_b16 a[4:5], v132 offset:28672
    ds_read_b64_tr_b16 a[6:7], v132 offset:29696
    v_mfma_f32_32x32x16_bf16 v[240:255], a[12:15], v[116:119], v[240:255]
    buffer_load_dwordx4 a[140:143], v15, s[20:23], s30 offen offset:1024 sc1
    ds_read_b64_tr_b16 a[8:9], v133 offset:30720
    ds_read_b64_tr_b16 a[10:11], v133 offset:31744
    s_waitcnt lgkmcnt(6)
    s_waitcnt vmcnt(9)
    v_mfma_f32_32x32x16_bf16 v[224:239], a[16:19], a[104:107], v[224:239]
    ds_read_b64_tr_b16 a[12:13], v132 offset:30720
    ds_read_b64_tr_b16 a[14:15], v132 offset:31744
    v_mfma_f32_32x32x16_bf16 v[240:255], a[20:23], a[104:107], v[240:255]
    buffer_load_dwordx4 a[144:147], v15, s[20:23], s31 offen offset:0 sc1
    ds_read_b64_tr_b16 a[16:17], v135 offset:28672
    ds_read_b64_tr_b16 a[18:19], v135 offset:29696
    v_mfma_f32_32x32x16_bf16 v[224:239], a[24:27], a[108:111], v[224:239]
    ds_read_b64_tr_b16 a[20:21], v134 offset:28672
    ds_read_b64_tr_b16 a[22:23], v134 offset:29696
    v_mfma_f32_32x32x16_bf16 v[240:255], a[28:31], a[108:111], v[240:255]
    buffer_load_dwordx4 a[148:151], v15, s[20:23], s31 offen offset:1024 sc1
    ds_read_b64_tr_b16 a[24:25], v135 offset:30720
    ds_read_b64_tr_b16 a[26:27], v135 offset:31744
    s_waitcnt lgkmcnt(6)
    s_barrier
    s_waitcnt vmcnt(9)
    v_mfma_f32_32x32x16_bf16 v[224:239], a[0:3], a[112:115], v[224:239]
    ds_read_b64_tr_b16 a[28:29], v134 offset:30720
    ds_read_b64_tr_b16 a[30:31], v134 offset:31744
    v_mfma_f32_32x32x16_bf16 v[240:255], a[4:7], a[112:115], v[240:255]
    buffer_load_dwordx4 a[152:155], v15, s[20:23], s29 offen offset:2048 sc1
    ds_read_b64_tr_b16 a[0:1], v129 offset:0
    ds_read_b64_tr_b16 a[2:3], v129 offset:1024
    v_mfma_f32_32x32x16_bf16 v[224:239], a[8:11], a[116:119], v[224:239]
    ds_read_b64_tr_b16 a[4:5], v128 offset:0
    ds_read_b64_tr_b16 a[6:7], v128 offset:1024
    v_mfma_f32_32x32x16_bf16 v[240:255], a[12:15], a[116:119], v[240:255]
    buffer_load_dwordx4 a[156:159], v15, s[20:23], s29 offen offset:3072 sc1
    ds_read_b64_tr_b16 a[8:9], v129 offset:2048
    ds_read_b64_tr_b16 a[10:11], v129 offset:3072
    s_waitcnt lgkmcnt(6)
    s_waitcnt vmcnt(8)
    v_mfma_f32_32x32x16_bf16 v[224:239], a[16:19], a[120:123], v[224:239]
    ds_read_b64_tr_b16 a[12:13], v128 offset:2048
    ds_read_b64_tr_b16 a[14:15], v128 offset:3072
    v_mfma_f32_32x32x16_bf16 v[240:255], a[20:23], a[120:123], v[240:255]
    buffer_load_dwordx4 a[160:163], v15, s[20:23], s30 offen offset:2048 sc1
    ds_read_b64_tr_b16 a[16:17], v131 offset:32768
    ds_read_b64_tr_b16 a[18:19], v131 offset:33792
    v_mfma_f32_32x32x16_bf16 v[224:239], a[24:27], a[124:127], v[224:239]
    ds_read_b64_tr_b16 a[20:21], v130 offset:32768
    ds_read_b64_tr_b16 a[22:23], v130 offset:33792
    v_mfma_f32_32x32x16_bf16 v[240:255], a[28:31], a[124:127], v[240:255]
    buffer_load_dwordx4 a[164:167], v15, s[20:23], s30 offen offset:3072 sc1
    ds_read_b64_tr_b16 a[24:25], v131 offset:34816
    ds_read_b64_tr_b16 a[26:27], v131 offset:35840
    s_waitcnt lgkmcnt(6)
    v_mfma_f32_32x32x16_bf16 v[224:239], a[0:3], v[120:123], v[224:239]
    ds_read_b64_tr_b16 a[28:29], v130 offset:34816
    ds_read_b64_tr_b16 a[30:31], v130 offset:35840
    v_mfma_f32_32x32x16_bf16 v[240:255], a[4:7], v[120:123], v[240:255]
    buffer_load_dwordx4 a[168:171], v15, s[20:23], s31 offen offset:2048 sc1
    ds_read_b64_tr_b16 a[0:1], v133 offset:32768
    ds_read_b64_tr_b16 a[2:3], v133 offset:33792
    v_mfma_f32_32x32x16_bf16 v[224:239], a[8:11], v[124:127], v[224:239]
    ds_read_b64_tr_b16 a[4:5], v132 offset:32768
    ds_read_b64_tr_b16 a[6:7], v132 offset:33792
    s_waitcnt vmcnt(9)
    v_accvgpr_read_b32 v48, a128
    v_accvgpr_read_b32 v49, a132
    v_max_u32 v48, v48, v49
    v_cmp_eq_u32 vcc, -1, v48
    v_mfma_f32_32x32x16_bf16 v[240:255], a[12:15], v[124:127], v[240:255]
    buffer_load_dwordx4 a[172:175], v15, s[20:23], s31 offen offset:3072 sc1
    ds_read_b64_tr_b16 a[8:9], v133 offset:34816
    ds_read_b64_tr_b16 a[10:11], v133 offset:35840
    s_waitcnt lgkmcnt(6)
    s_cbranch_vccnz L_spin5
L_ok5:
    v_mfma_f32_32x32x16_bf16 v[224:239], a[16:19], a[128:131], v[224:239]
    ds_read_b64_tr_b16 a[12:13], v132 offset:34816
    ds_read_b64_tr_b16 a[14:15], v132 offset:35840
    v_mfma_f32_32x32x16_bf16 v[240:255], a[20:23], a[128:131], v[240:255]
    buffer_load_dwordx4 a[176:179], v16, s[20:23], s29 offen offset:0 sc1
    ds_read_b64_tr_b16 a[16:17], v135 offset:32768
    ds_read_b64_tr_b16 a[18:19], v135 offset:33792
    v_mfma_f32_32x32x16_bf16 v[224:239], a[24:27], a[132:135], v[224:239]
    ds_read_b64_tr_b16 a[20:21], v134 offset:32768
    ds_read_b64_tr_b16 a[22:23], v134 offset:33792
    s_waitcnt vmcnt(9)
    v_accvgpr_read_b32 v48, a136
    v_accvgpr_read_b32 v49, a140
    v_max_u32 v48, v48, v49
    v_cmp_eq_u32 vcc, -1, v48
    v_mfma_f32_32x32x16_bf16 v[240:255], a[28:31], a[132:135], v[240:255]
    buffer_load_dwordx4 a[180:183], v16, s[20:23], s29 offen offset:1024 sc1
    ds_read_b64_tr_b16 a[24:25], v135 offset:34816
    ds_read_b64_tr_b16 a[26:27], v135 offset:35840
    s_waitcnt lgkmcnt(6)
    s_cbranch_vccnz L_spin6
L_ok6:
    v_mfma_f32_32x32x16_bf16 v[224:239], a[0:3], a[136:139], v[224:239]
    ds_read_b64_tr_b16 a[28:29], v134 offset:34816
    ds_read_b64_tr_b16 a[30:31], v134 offset:35840
    v_mfma_f32_32x32x16_bf16 v[240:255], a[4:7], a[136:139], v[240:255]
    buffer_load_dwordx4 a[184:187], v16, s[20:23], s30 offen offset:0 sc1
    ds_read_b64_tr_b16 a[0:1], v131 offset:36864
    ds_read_b64_tr_b16 a[2:3], v131 offset:37888
    v_mfma_f32_32x32x16_bf16 v[224:239], a[8:11], a[140:143], v[224:239]
    ds_read_b64_tr_b16 a[4:5], v130 offset:36864
    ds_read_b64_tr_b16 a[6:7], v130 offset:37888
    s_waitcnt vmcnt(9)
    v_accvgpr_read_b32 v48, a144
    v_accvgpr_read_b32 v49, a148
    v_max_u32 v48, v48, v49
    v_cmp_eq_u32 vcc, -1, v48
    v_mfma_f32_32x32x16_bf16 v[240:255], a[12:15], a[140:143], v[240:255]
    buffer_load_dwordx4 a[188:191], v16, s[20:23], s30 offen offset:1024 sc1
    ds_read_b64_tr_b16 a[8:9], v131 offset:38912
    ds_read_b64_tr_b16 a[10:11], v131 offset:39936
    s_waitcnt lgkmcnt(6)
    s_cbranch_vccnz L_spin7
L_ok7:
    v_mfma_f32_32x32x16_bf16 v[224:239], a[16:19], a[144:147], v[224:239]
    ds_read_b64_tr_b16 a[12:13], v130 offset:38912
    ds_read_b64_tr_b16 a[14:15], v130 offset:39936
    v_mfma_f32_32x32x16_bf16 v[240:255], a[20:23], a[144:147], v[240:255]
    buffer_load_dwordx4 a[192:195], v16, s[20:23], s31 offen offset:0 sc1
    ds_read_b64_tr_b16 a[16:17], v133 offset:36864
    ds_read_b64_tr_b16 a[18:19], v133 offset:37888
    v_mfma_f32_32x32x16_bf16 v[224:239], a[24:27], a[148:151], v[224:239]
    ds_read_b64_tr_b16 a[20:21], v132 offset:36864
    ds_read_b64_tr_b16 a[22:23], v132 offset:37888
    s_waitcnt vmcnt(9)
    v_accvgpr_read_b32 v48, a152
    v_accvgpr_read_b32 v49, a156
    v_max_u32 v48, v48, v49
    v_cmp_eq_u32 vcc, -1, v48
    v_mfma_f32_32x32x16_bf16 v[240:255], a[28:31], a[148:151], v[240:255]
    buffer_load_dwordx4 a[196:199], v16, s[20:23], s31 offen offset:1024 sc1
    ds_read_b64_tr_b16 a[24:25], v133 offset:38912
    ds_read_b64_tr_b16 a[26:27], v133 offset:39936
    s_waitcnt lgkmcnt(6)
    s_cbranch_vccnz L_spin8
L_ok8:
    v_mfma_f32_32x32x16_bf16 v[224:239], a[0:3], a[152:155], v[224:239]
    ds_read_b64_tr_b16 a[28:29], v132 offset:38912
    ds_read_b64_tr_b16 a[30:31], v132 offset:39936
    v_mfma_f32_32x32x16_bf16 v[240:255], a[4:7], a[152:155], v[240:255]
    buffer_load_dwordx4 a[200:203], v16, s[20:23], s28 offen offset:2048 sc1
    ds_read_b64_tr_b16 a[0:1], v135 offset:36864
    ds_read_b64_tr_b16 a[2:3], v135 offset:37888
    v_mfma_f32_32x32x16_bf16 v[224:239], a[8:11], a[156:159], v[224:239]
    ds_read_b64_tr_b16 a[4:5], v134 offset:36864
    ds_read_b64_tr_b16 a[6:7], v134 offset:37888
    s_waitcnt vmcnt(9)
    v_accvgpr_read_b32 v48, a160
    v_accvgpr_read_b32 v49, a164
    v_max_u32 v48, v48, v49
    v_cmp_eq_u32 vcc, -1, v48
    v_mfma_f32_32x32x16_bf16 v[240:255], a[12:15], a[156:159], v[240:255]
    buffer_load_dwordx4 a[204:207], v16, s[20:23], s28 offen offset:3072 sc1
    ds_read_b64_tr_b16 a[8:9], v135 offset:38912
    ds_read_b64_tr_b16 a[10:11], v135 offset:39936
    s_waitcnt lgkmcnt(6)
    s_cbranch_vccnz L_spin9
L_ok9:
    v_mfma_f32_32x32x16_bf16 v[224:239], a[16:19], a[160:163], v[224:239]
    ds_read_b64_tr_b16 a[12:13], v134 offset:38912
    ds_read_b64_tr_b16 a[14:15], v134 offset:39936
    v_mfma_f32_32x32x16_bf16 v[240:255], a[20:23], a[160:163], v[240:255]
    buffer_load_dwordx4 a[208:211], v16, s[20:23], s29 offen offset:2048 sc1
    ds_read_b64_tr_b16 a[16:17], v131 offset:0
    ds_read_b64_tr_b16 a[18:19], v131 offset:1024
    v_mfma_f32_32x32x16_bf16 v[224:239], a[24:27], a[164:167], v[224:239]
    ds_read_b64_tr_b16 a[20:21], v130 offset:0
    ds_read_b64_tr_b16 a[22:23], v130 offset:1024
    s_waitcnt vmcnt(9)
    v_accvgpr_read_b32 v48, a168
    v_accvgpr_read_b32 v49, a172
    v_max_u32 v48, v48, v49
    v_cmp_eq_u32 vcc, -1, v48
    v_mfma_f32_32x32x16_bf16 v[240:255], a[28:31], a[164:167], v[240:255]
    buffer_load_dwordx4 a[212:215], v16, s[20:23], s29 offen offset:3072 sc1
    ds_read_b64_tr_b16 a[24:25], v131 offset:2048
    ds_read_b64_tr_b16 a[26:27], v131 offset:3072
    s_waitcnt lgkmcnt(6)
    s_cbranch_vccnz L_spin10
L_ok10:
    v_mfma_f32_32x32x16_bf16 v[224:239], a[0:3], a[168:171], v[224:239]
    ds_read_b64_tr_b16 a[28:29], v130 offset:2048
    ds_read_b64_tr_b16 a[30:31], v130 offset:3072
    v_mfma_f32_32x32x16_bf16 v[240:255], a[4:7], a[168:171], v[240:255]
    buffer_load_dwordx4 a[216:219], v16, s[20:23], s30 offen offset:2048 sc1
    ds_read_b64_tr_b16 a[0:1], v133 offset:0
    ds_read_b64_tr_b16 a[2:3], v133 offset:1024
    v_mfma_f32_32x32x16_bf16 v[224:239], a[8:11], a[172:175], v[224:239]
    ds_read_b64_tr_b16 a[4:5], v132 offset:0
    ds_read_b64_tr_b16 a[6:7], v132 offset:1024
    s_waitcnt vmcnt(9)
    v_accvgpr_read_b32 v48, a176
    v_accvgpr_read_b32 v49, a180
    v_max_u32 v48, v48, v49
    v_cmp_eq_u32 vcc, -1, v48
    v_mfma_f32_32x32x16_bf16 v[240:255], a[12:15], a[172:175], v[240:255]
    buffer_load_dwordx4 a[220:223], v16, s[20:23], s30 offen offset:3072 sc1
    ds_read_b64_tr_b16 a[8:9], v133 offset:2048
    ds_read_b64_tr_b16 a[10:11], v133 offset:3072
    s_waitcnt lgkmcnt(6)
    s_cbranch_vccnz L_spin11
L_ok11:
    v_mfma_f32_32x32x16_bf16 v[224:239], a[16:19], a[176:179], v[224:239]
    ds_read_b64_tr_b16 a[12:13], v132 offset:2048
    ds_read_b64_tr_b16 a[14:15], v132 offset:3072
    v_mfma_f32_32x32x16_bf16 v[240:255], a[20:23], a[176:179], v[240:255]
    buffer_load_dwordx4 a[224:227], v16, s[20:23], s31 offen offset:2048 sc1
    ds_read_b64_tr_b16 a[16:17], v135 offset:0
    ds_read_b64_tr_b16 a[18:19], v135 offset:1024
    v_mfma_f32_32x32x16_bf16 v[224:239], a[24:27], a[180:183], v[224:239]
    ds_read_b64_tr_b16 a[20:21], v134 offset:0
    ds_read_b64_tr_b16 a[22:23], v134 offset:1024
    s_waitcnt vmcnt(9)
    v_accvgpr_read_b32 v48, a184
    v_accvgpr_read_b32 v49, a188
    v_max_u32 v48, v48, v49
    v_cmp_eq_u32 vcc, -1, v48
    v_mfma_f32_32x32x16_bf16 v[240:255], a[28:31], a[180:183], v[240:255]
    buffer_load_dwordx4 a[228:231], v16, s[20:23], s31 offen offset:3072 sc1
    ds_read_b64_tr_b16 a[24:25], v135 offset:2048
    ds_read_b64_tr_b16 a[26:27], v135 offset:3072
    s_waitcnt lgkmcnt(6)
    s_cbranch_vccnz L_spin12
L_ok12:
    v_mfma_f32_32x32x16_bf16 v[224:239], a[0:3], a[184:187], v[224:239]
    ds_read_b64_tr_b16 a[28:29], v134 offset:2048
    ds_read_b64_tr_b16 a[30:31], v134 offset:3072
    v_accvgpr_read_b32 v136, a248
    v_accvgpr_read_b32 v137, a249
    v_accvgpr_read_b32 v138, a250
    v_accvgpr_read_b32 v139, a251
    v_mfma_f32_32x32x16_bf16 v[240:255], a[4:7], a[184:187], v[240:255]
    buffer_load_dwordx4 a[232:235], v17, s[20:23], s28 offen offset:0 sc1
    ds_read_b64_tr_b16 a[0:1], v129 offset:4096
    ds_read_b64_tr_b16 a[2:3], v129 offset:5120
    v_accvgpr_read_b32 v140, a252
    v_accvgpr_read_b32 v141, a253
    v_mfma_f32_32x32x16_bf16 v[224:239], a[8:11], a[188:191], v[224:239]
    ds_read_b64_tr_b16 a[4:5], v128 offset:4096
    ds_read_b64_tr_b16 a[6:7], v128 offset:5120
    s_waitcnt vmcnt(9)
    v_accvgpr_read_b32 v48, a192
    v_accvgpr_read_b32 v49, a196
    v_max_u32 v48, v48, v49
    v_cmp_eq_u32 vcc, -1, v48
    v_mfma_f32_32x32x16_bf16 v[240:255], a[12:15], a[188:191], v[240:255]
    buffer_load_dwordx4 a[236:239], v17, s[20:23], s28 offen offset:1024 sc1
    ds_read_b64_tr_b16 a[8:9], v129 offset:6144
    ds_read_b64_tr_b16 a[10:11], v129 offset:7168
    s_waitcnt lgkmcnt(6)
    s_cbranch_vccnz L_spin13
L_ok13:
    v_mfma_f32_32x32x16_bf16 v[224:239], a[16:19], a[192:195], v[224:239]
    buffer_load_dwordx4 a[240:243], v17, s[20:23], s29 offen offset:0 sc1
    ds_read_b64_tr_b16 a[12:13], v128 offset:6144
    ds_read_b64_tr_b16 a[14:15], v128 offset:7168
    v_accvgpr_read_b32 v142, a254
    v_accvgpr_read_b32 v143, a255
    v_mfma_f32_32x32x16_bf16 v[240:255], a[20:23], a[192:195], v[240:255]
    ds_read_b64_tr_b16 a[16:17], v131 offset:4096
    ds_read_b64_tr_b16 a[18:19], v131 offset:5120
    v_permlane32_swap_b32 v136, v138
    v_permlane32_swap_b32 v137, v139
    v_permlane32_swap_b32 v140, v142
    v_permlane32_swap_b32 v141, v143
    v_mfma_f32_32x32x16_bf16 v[224:239], a[24:27], a[196:199], v[224:239]
    ds_read_b64_tr_b16 a[20:21], v130 offset:4096
    ds_read_b64_tr_b16 a[22:23], v130 offset:5120
    s_waitcnt vmcnt(9)
    v_accvgpr_read_b32 v48, a200
    v_accvgpr_read_b32 v49, a204
    v_max_u32 v48, v48, v49
    v_cmp_eq_u32 vcc, -1, v48
    v_mfma_f32_32x32x16_bf16 v[240:255], a[28:31], a[196:199], v[240:255]
    buffer_load_dwordx4 a[244:247], v17, s[20:23], s29 offen offset:1024 sc1
    ds_read_b64_tr_b16 a[24:25], v131 offset:6144
    ds_read_b64_tr_b16 a[26:27], v131 offset:7168
    s_waitcnt lgkmcnt(6)
    s_cbranch_vccnz L_spin14
L_ok14:
    v_mfma_f32_32x32x16_bf16 v[224:239], a[0:3], a[200:203], v[224:239]
    buffer_load_dwordx4 a[32:35], v17, s[20:23], s30 offen offset:0 sc1
    ds_read_b64_tr_b16 a[28:29], v130 offset:6144
    ds_read_b64_tr_b16 a[30:31], v130 offset:7168
    v_lshlrev_b32 v208, 16, v136
    v_and_b32 v209, s53, v136
    v_mfma_f32_32x32x16_bf16 v[240:255], a[4:7], a[200:203], v[240:255]
    ds_read_b64_tr_b16 a[0:1], v133 offset:4096
    ds_read_b64_tr_b16 a[2:3], v133 offset:5120
    v_lshlrev_b32 v210, 16, v137
    v_and_b32 v211, s53, v137
    v_lshlrev_b32 v212, 16, v138
    v_and_b32 v213, s53, v138
    v_mfma_f32_32x32x16_bf16 v[224:239], a[8:11], a[204:207], v[224:239]
    ds_read_b64_tr_b16 a[4:5], v132 offset:4096
    ds_read_b64_tr_b16 a[6:7], v132 offset:5120
    s_waitcnt vmcnt(9)
    v_accvgpr_read_b32 v48, a208
    v_accvgpr_read_b32 v49, a212
    v_max_u32 v48, v48, v49
    v_cmp_eq_u32 vcc, -1, v48
    v_mfma_f32_32x32x16_bf16 v[240:255], a[12:15], a[204:207], v[240:255]
    buffer_load_dwordx4 a[36:39], v17, s[20:23], s30 offen offset:1024 sc1
    ds_read_b64_tr_b16 a[8:9], v133 offset:6144
    ds_read_b64_tr_b16 a[10:11], v133 offset:7168
    s_waitcnt lgkmcnt(6)
    s_cbranch_vccnz L_spin15
L_ok15:
    v_mfma_f32_32x32x16_bf16 v[224:239], a[16:19], a[208:211], v[224:239]
    buffer_load_dwordx4 a[40:43], v17, s[20:23], s31 offen offset:0 sc1
    ds_read_b64_tr_b16 a[12:13], v132 offset:6144
    ds_read_b64_tr_b16 a[14:15], v132 offset:7168
    v_lshlrev_b32 v214, 16, v139
    v_and_b32 v215, s53, v139
    v_mfma_f32_32x32x16_bf16 v[240:255], a[20:23], a[208:211], v[240:255]
    ds_read_b64_tr_b16 a[16:17], v135 offset:4096
    ds_read_b64_tr_b16 a[18:19], v135 offset:5120
    v_lshlrev_b32 v216, 16, v140
    v_and_b32 v217, s53, v140
    v_lshlrev_b32 v218, 16, v141
    v_and_b32 v219, s53, v141
    v_mfma_f32_32x32x16_bf16 v[224:239], a[24:27], a[212:215], v[224:239]
    buffer_load_dwordx4 a[44:47], v17, s[20:23], s31 offen offset:1024 sc1
    ds_read_b64_tr_b16 a[20:21], v134 offset:4096
    ds_read_b64_tr_b16 a[22:23], v134 offset:5120
    s_waitcnt vmcnt(10)
    v_accvgpr_read_b32 v48, a216
    v_accvgpr_read_b32 v49, a220
    v_max_u32 v48, v48, v49
    v_cmp_eq_u32 vcc, -1, v48
    v_mfma_f32_32x32x16_bf16 v[240:255], a[28:31], a[212:215], v[240:255]
    ds_read_b64_tr_b16 a[24:25], v135 offset:6144
    ds_read_b64_tr_b16 a[26:27], v135 offset:7168
    s_waitcnt lgkmcnt(6)
    s_cbranch_vccnz L_spin16
L_ok16:
    v_lshlrev_b32 v220, 16, v142
    v_mfma_f32_32x32x16_bf16 v[224:239], a[0:3], a[216:219], v[224:239]
    ds_read_b64_tr_b16 a[28:29], v134 offset:6144
    ds_read_b64_tr_b16 a[30:31], v134 offset:7168
    v_and_b32 v221, s53, v142
    v_lshlrev_b32 v222, 16, v143
    v_and_b32 v223, s53, v143
    v_mov_b32 v147, v22
    v_mfma_f32_32x32x16_bf16 v[240:255], a[4:7], a[216:219], v[240:255]
    ds_read_b64_tr_b16 a[0:1], v129 offset:8192
    ds_read_b64_tr_b16 a[2:3], v129 offset:9216
    v_mov_b32 v151, v22
    v_mov_b32 v154, v22
    v_mov_b32 v155, v22
    s_lshl3_add_u32 s56, s32, s36
    v_mfma_f32_32x32x16_bf16 v[224:239], a[8:11], a[220:223], v[224:239]
    ds_read_b64_tr_b16 a[4:5], v128 offset:8192
    ds_read_b64_tr_b16 a[6:7], v128 offset:9216
    s_waitcnt vmcnt(8)
    v_accvgpr_read_b32 v48, a224
    v_accvgpr_read_b32 v49, a228
    v_max_u32 v48, v48, v49
    v_cmp_eq_u32 vcc, -1, v48
    v_mfma_f32_32x32x16_bf16 v[240:255], a[12:15], a[220:223], v[240:255]
    ds_read_b64_tr_b16 a[8:9], v129 offset:10240
    ds_read_b64_tr_b16 a[10:11], v129 offset:11264
    s_waitcnt lgkmcnt(6)
    s_cbranch_vccnz L_spin17
L_ok17:
    s_lshl1_add_u32 s56, s56, s35
    v_mfma_f32_32x32x16_bf16 v[224:239], a[16:19], a[224:227], v[224:239]
    ds_read_b64_tr_b16 a[12:13], v128 offset:10240
    ds_read_b64_tr_b16 a[14:15], v128 offset:11264
    s_lshl2_add_u32 s56, s56, s3
    s_lshl_b32 s56, s56, 12
    s_add_u32 s56, s56, 12582912
    s_xor_b32 s57, s56, 16384
    v_mfma_f32_32x32x16_bf16 v[240:255], a[20:23], a[224:227], v[240:255]
    ds_read_b64_tr_b16 a[16:17], v131 offset:8192
    ds_read_b64_tr_b16 a[18:19], v131 offset:9216
    s_mov_b32 s54, 0x3f317218
    v_and_b32 v27, 31, v1
    v_mul_u32_u24 v27, 80, v27
    v_lshrrev_b32 v28, 5, v1
    v_mfma_f32_32x32x16_bf16 v[224:239], a[24:27], a[228:231], v[224:239]
    ds_read_b64_tr_b16 a[20:21], v130 offset:8192
    ds_read_b64_tr_b16 a[22:23], v130 offset:9216
    s_waitcnt vmcnt(6)
    v_accvgpr_read_b32 v48, a232
    v_accvgpr_read_b32 v49, a236
    v_max_u32 v48, v48, v49
    v_cmp_eq_u32 vcc, -1, v48
    v_mfma_f32_32x32x16_bf16 v[240:255], a[28:31], a[228:231], v[240:255]
    ds_read_b64_tr_b16 a[24:25], v131 offset:10240
    ds_read_b64_tr_b16 a[26:27], v131 offset:11264
    s_waitcnt lgkmcnt(6)
    s_cbranch_vccnz L_spin18
L_ok18:
    v_lshl_add_u32 v27, v28, 3, v27
    v_mfma_f32_32x32x16_bf16 v[224:239], a[0:3], a[232:235], v[224:239]
    ds_read_b64_tr_b16 a[28:29], v130 offset:10240
    ds_read_b64_tr_b16 a[30:31], v130 offset:11264
    v_add_u32 v4, s37, v27
    v_lshrrev_b32 v27, 2, v1
    v_mul_u32_u24 v27, 80, v27
    v_and_b32 v28, 3, v1
    v_mfma_f32_32x32x16_bf16 v[240:255], a[4:7], a[232:235], v[240:255]
    ds_read_b64_tr_b16 a[0:1], v133 offset:8192
    ds_read_b64_tr_b16 a[2:3], v133 offset:9216
    v_lshl_add_u32 v27, v28, 4, v27
    v_add_u32 v5, s37, v27
    s_movk_i32 s58, 16384
    v_mfma_f32_32x32x16_bf16 v[224:239], a[8:11], a[236:239], v[224:239]
    ds_read_b64_tr_b16 a[4:5], v132 offset:8192
    ds_read_b64_tr_b16 a[6:7], v132 offset:9216
    s_waitcnt vmcnt(4)
    v_accvgpr_read_b32 v48, a240
    v_accvgpr_read_b32 v49, a244
    v_max_u32 v48, v48, v49
    v_cmp_eq_u32 vcc, -1, v48
    v_mfma_f32_32x32x16_bf16 v[240:255], a[12:15], a[236:239], v[240:255]
    ds_read_b64_tr_b16 a[8:9], v133 offset:10240
    ds_read_b64_tr_b16 a[10:11], v133 offset:11264
    s_waitcnt lgkmcnt(6)
    s_cbranch_vccnz L_spin19
L_ok19:
    v_mfma_f32_32x32x16_bf16 v[224:239], a[16:19], a[240:243], v[224:239]
    ds_read_b64_tr_b16 a[12:13], v132 offset:10240
    ds_read_b64_tr_b16 a[14:15], v132 offset:11264
    v_mfma_f32_32x32x16_bf16 v[240:255], a[20:23], a[240:243], v[240:255]
    ds_read_b64_tr_b16 a[16:17], v135 offset:8192
    ds_read_b64_tr_b16 a[18:19], v135 offset:9216
    v_mfma_f32_32x32x16_bf16 v[224:239], a[24:27], a[244:247], v[224:239]
    ds_read_b64_tr_b16 a[20:21], v135 offset:10240
    ds_read_b64_tr_b16 a[22:23], v135 offset:11264
    s_waitcnt vmcnt(2)
    v_accvgpr_read_b32 v48, a32
    v_accvgpr_read_b32 v49, a36
    v_max_u32 v48, v48, v49
    v_cmp_eq_u32 vcc, -1, v48
    v_mfma_f32_32x32x16_bf16 v[240:255], a[28:31], a[244:247], v[240:255]
    ds_read_b64_tr_b16 a[24:25], v134 offset:8192
    ds_read_b64_tr_b16 a[26:27], v134 offset:9216
    s_waitcnt lgkmcnt(6)
    s_cbranch_vccnz L_spin20
L_ok20:
    v_mfma_f32_32x32x16_bf16 v[224:239], a[0:3], a[32:35], v[224:239]
    ds_read_b64_tr_b16 a[28:29], v134 offset:10240
    ds_read_b64_tr_b16 a[30:31], v134 offset:11264
    v_mfma_f32_32x32x16_bf16 v[240:255], a[4:7], a[32:35], v[240:255]
    v_mfma_f32_32x32x16_bf16 v[224:239], a[8:11], a[36:39], v[224:239]
    s_waitcnt vmcnt(0)
    v_accvgpr_read_b32 v48, a40
    v_accvgpr_read_b32 v49, a44
    v_max_u32 v48, v48, v49
    v_cmp_eq_u32 vcc, -1, v48
    v_mfma_f32_32x32x16_bf16 v[240:255], a[12:15], a[36:39], v[240:255]
    s_waitcnt lgkmcnt(0)
    s_cbranch_vccnz L_spin21
L_ok21:
    v_mfma_f32_32x32x16_bf16 v[224:239], a[16:19], a[40:43], v[224:239]
    v_mfma_f32_32x32x16_bf16 v[224:239], a[20:23], a[44:47], v[224:239]
    v_mfma_f32_32x32x16_bf16 v[240:255], a[24:27], a[40:43], v[240:255]
    v_mfma_f32_32x32x16_bf16 v[240:255], a[28:31], a[44:47], v[240:255]
    s_nop 9
    v_cvt_pk_bf16_f32 v144, v224, v225
    v_cvt_pk_bf16_f32 v145, v226, v227
    v_cvt_pk_bf16_f32 v146, v228, v229
    buffer_store_dwordx4 v[144:147], v2, s[20:23], s56 offen offset:0 sc1
    v_cvt_pk_bf16_f32 v148, v230, v231
    v_cvt_pk_bf16_f32 v149, v232, v233
    v_cvt_pk_bf16_f32 v150, v234, v235
    buffer_store_dwordx4 v[148:151], v2, s[20:23], s56 offen offset:1024 sc1
    v_cvt_pk_bf16_f32 v152, v236, v237
    v_cvt_pk_bf16_f32 v153, v238, v239
    buffer_store_dwordx4 v[152:155], v2, s[20:23], s56 offen offset:2048 sc1
    v_fmac_f32 v208, s54, v240
    v_fmac_f32 v209, s54, v241
    v_fmac_f32 v210, s54, v242
    v_fmac_f32 v211, s54, v243
    v_fmac_f32 v212, s54, v244
    v_fmac_f32 v213, s54, v245
    v_fmac_f32 v214, s54, v246
    v_fmac_f32 v215, s54, v247
    v_fmac_f32 v216, s54, v248
    v_fmac_f32 v217, s54, v249
    v_fmac_f32 v218, s54, v250
    v_fmac_f32 v219, s54, v251
    v_fmac_f32 v220, s54, v252
    v_fmac_f32 v221, s54, v253
    v_fmac_f32 v222, s54, v254
    v_fmac_f32 v223, s54, v255
    s_waitcnt vmcnt(0)
    buffer_load_dwordx4 v[160:163], v2, s[20:23], s57 offen offset:0 sc1
    buffer_load_dwordx4 v[164:167], v2, s[20:23], s57 offen offset:1024 sc1
    buffer_load_dwordx4 v[168:171], v2, s[20:23], s57 offen offset:2048 sc1
    s_waitcnt vmcnt(0)
    v_bitop3_b32 v26, v163, v167, v22 bitop3:0x7e
    v_xor_b32 v27, v171, v22
    v_or_b32 v26, v26, v27
    v_cmp_ne_u32 vcc, 0, v26
    s_cbranch_vccnz L_spin22
L_ok22:
    v_lshlrev_b32 v176, 16, v160
    v_and_b32 v177, s53, v160
    v_lshlrev_b32 v178, 16, v161
    v_and_b32 v179, s53, v161
    v_lshlrev_b32 v180, 16, v162
    v_and_b32 v181, s53, v162
    v_lshlrev_b32 v182, 16, v164
    v_and_b32 v183, s53, v164
    v_fmac_f32 v208, s54, v176
    v_fmac_f32 v209, s54, v177
    v_fmac_f32 v210, s54, v178
    v_fmac_f32 v211, s54, v179
    v_fmac_f32 v212, s54, v180
    v_fmac_f32 v213, s54, v181
    v_fmac_f32 v214, s54, v182
    v_fmac_f32 v215, s54, v183
    v_cvt_pk_bf16_f32 v136, v208, v209
    v_cvt_pk_bf16_f32 v137, v210, v211
    v_cvt_pk_bf16_f32 v138, v212, v213
    v_cvt_pk_bf16_f32 v139, v214, v215
    ds_write_b64 v4, v[136:137] offset:12288
    ds_write_b64 v4, v[138:139] offset:12304
    v_lshlrev_b32 v184, 16, v165
    v_and_b32 v185, s53, v165
    v_lshlrev_b32 v186, 16, v166
    v_and_b32 v187, s53, v166
    v_lshlrev_b32 v188, 16, v168
    v_and_b32 v189, s53, v168
    v_lshlrev_b32 v190, 16, v169
    v_and_b32 v191, s53, v169
    v_fmac_f32 v216, s54, v184
    v_fmac_f32 v217, s54, v185
    v_fmac_f32 v218, s54, v186
    v_fmac_f32 v219, s54, v187
    v_fmac_f32 v220, s54, v188
    v_fmac_f32 v221, s54, v189
    v_fmac_f32 v222, s54, v190
    v_fmac_f32 v223, s54, v191
    v_cvt_pk_bf16_f32 v140, v216, v217
    v_cvt_pk_bf16_f32 v141, v218, v219
    v_cvt_pk_bf16_f32 v142, v220, v221
    v_cvt_pk_bf16_f32 v143, v222, v223
    ds_write_b64 v4, v[140:141] offset:12320
    ds_write_b64 v4, v[142:143] offset:12336
    ds_read_b128 v[176:179], v5 offset:12288
    ds_read_b128 v[180:183], v5 offset:13568
    s_waitcnt lgkmcnt(1)
    buffer_store_dwordx4 v[176:179], v19, s[24:27], 0 offen sc1
    s_waitcnt lgkmcnt(0)
    buffer_store_dwordx4 v[180:183], v19, s[24:27], s58 offen sc1
    s_endpgm
L_spin0:
    s_mov_b32 s62, 0
L_spinl0:
    global_load_dword v30, v18, s[0:1] sc1
    s_add_u32 s62, s62, 1
    s_cmp_gt_u32 s62, 400000
    s_waitcnt vmcnt(0)
    s_cbranch_scc1 L_ok0
    v_cmp_eq_u32 vcc, 0, v30
    s_cbranch_vccnz L_spinl0
    s_branch L_ok0
L_spin1:
    s_mov_b32 s62, 0
    s_mov_b32 s51, 65536
L_spinl1:
    buffer_load_dword v30, v3, s[20:23], s51 offen sc1
    s_add_u32 s62, s62, 1
    s_cmp_gt_u32 s62, 400000
    s_waitcnt vmcnt(0)
    s_cbranch_scc1 L_ok1
    v_cmp_ne_u32 vcc, s38, v30
    s_cbranch_vccnz L_spinl1
    s_branch L_ok1
L_spin2:
    s_mov_b32 s62, 0
    s_mov_b32 s51, 131072
L_spinl2:
    buffer_load_dword v31, v26, s[20:23], s51 offen sc1
    s_add_u32 s62, s62, 1
    s_cmp_gt_u32 s62, 400000
    s_waitcnt vmcnt(0)
    s_cbranch_scc1 L_ok2
    v_cmp_ne_u32 vcc, s38, v31
    s_cbranch_vccnz L_spinl2
    s_branch L_ok2
L_spin3:
    s_mov_b32 s62, 0
    s_mov_b32 s51, 196608
L_spinl3:
    buffer_load_dword v23, v3, s[20:23], s51 offen sc1
    s_add_u32 s62, s62, 1
    s_cmp_gt_u32 s62, 400000
    s_waitcnt vmcnt(0)
    s_cbranch_scc1 L_ok3
    v_cmp_ne_u32 vcc, s38, v23
    s_cbranch_vccnz L_spinl3
    s_branch L_ok3
L_spin4:
    s_mov_b32 s62, 0
    s_mov_b32 s51, 262144
L_spinl4:
    buffer_load_dword v30, v3, s[20:23], s51 offen sc1
    s_add_u32 s62, s62, 1
    s_cmp_gt_u32 s62, 400000
    s_waitcnt vmcnt(0)
    s_cbranch_scc1 L_ok4
    v_cmp_ne_u32 vcc, s38, v30
    s_cbranch_vccnz L_spinl4
    s_branch L_ok4
L_spin5:
    s_mov_b32 s62, 0
L_spinl5:
    buffer_load_dwordx4 a[128:131], v15, s[20:23], s29 offen offset:0 sc1
    buffer_load_dwordx4 a[132:135], v15, s[20:23], s29 offen offset:1024 sc1
    buffer_load_dwordx4 a[136:139], v15, s[20:23], s30 offen offset:0 sc1
    buffer_load_dwordx4 a[140:143], v15, s[20:23], s30 offen offset:1024 sc1
    buffer_load_dwordx4 a[144:147], v15, s[20:23], s31 offen offset:0 sc1
    buffer_load_dwordx4 a[148:151], v15, s[20:23], s31 offen offset:1024 sc1
    buffer_load_dwordx4 a[152:155], v15, s[20:23], s29 offen offset:2048 sc1
    buffer_load_dwordx4 a[156:159], v15, s[20:23], s29 offen offset:3072 sc1
    s_add_u32 s62, s62, 1
    s_cmp_gt_u32 s62, 400000
    s_waitcnt vmcnt(0)
    s_cbranch_scc1 L_ok5
    v_accvgpr_read_b32 v48, a128
    v_accvgpr_read_b32 v49, a132
    v_max_u32 v48, v48, v49
    v_cmp_eq_u32 vcc, -1, v48
    s_cbranch_vccnz L_spinl5
    s_branch L_ok5
L_spin6:
    s_mov_b32 s62, 0
L_spinl6:
    buffer_load_dwordx4 a[136:139], v15, s[20:23], s30 offen offset:0 sc1
    buffer_load_dwordx4 a[140:143], v15, s[20:23], s30 offen offset:1024 sc1
    buffer_load_dwordx4 a[144:147], v15, s[20:23], s31 offen offset:0 sc1
    buffer_load_dwordx4 a[148:151], v15, s[20:23], s31 offen offset:1024 sc1
    buffer_load_dwordx4 a[152:155], v15, s[20:23], s29 offen offset:2048 sc1
    buffer_load_dwordx4 a[156:159], v15, s[20:23], s29 offen offset:3072 sc1
    buffer_load_dwordx4 a[160:163], v15, s[20:23], s30 offen offset:2048 sc1
    buffer_load_dwordx4 a[164:167], v15, s[20:23], s30 offen offset:3072 sc1
    s_add_u32 s62, s62, 1
    s_cmp_gt_u32 s62, 400000
    s_waitcnt vmcnt(0)
    s_cbranch_scc1 L_ok6
    v_accvgpr_read_b32 v48, a136
    v_accvgpr_read_b32 v49, a140
    v_max_u32 v48, v48, v49
    v_cmp_eq_u32 vcc, -1, v48
    s_cbranch_vccnz L_spinl6
    s_branch L_ok6
L_spin7:
    s_mov_b32 s62, 0
L_spinl7:
    buffer_load_dwordx4 a[144:147], v15, s[20:23], s31 offen offset:0 sc1
    buffer_load_dwordx4 a[148:151], v15, s[20:23], s31 offen offset:1024 sc1
    buffer_load_dwordx4 a[152:155], v15, s[20:23], s29 offen offset:2048 sc1
    buffer_load_dwordx4 a[156:159], v15, s[20:23], s29 offen offset:3072 sc1
    buffer_load_dwordx4 a[160:163], v15, s[20:23], s30 offen offset:2048 sc1
    buffer_load_dwordx4 a[164:167], v15, s[20:23], s30 offen offset:3072 sc1
    buffer_load_dwordx4 a[168:171], v15, s[20:23], s31 offen offset:2048 sc1
    buffer_load_dwordx4 a[172:175], v15, s[20:23], s31 offen offset:3072 sc1
    s_add_u32 s62, s62, 1
    s_cmp_gt_u32 s62, 400000
    s_waitcnt vmcnt(0)
    s_cbranch_scc1 L_ok7
    v_accvgpr_read_b32 v48, a144
    v_accvgpr_read_b32 v49, a148
    v_max_u32 v48, v48, v49
    v_cmp_eq_u32 vcc, -1, v48
    s_cbranch_vccnz L_spinl7
    s_branch L_ok7
L_spin8:
    s_mov_b32 s62, 0
L_spinl8:
    buffer_load_dwordx4 a[152:155], v15, s[20:23], s29 offen offset:2048 sc1
    buffer_load_dwordx4 a[156:159], v15, s[20:23], s29 offen offset:3072 sc1
    buffer_load_dwordx4 a[160:163], v15, s[20:23], s30 offen offset:2048 sc1
    buffer_load_dwordx4 a[164:167], v15, s[20:23], s30 offen offset:3072 sc1
    buffer_load_dwordx4 a[168:171], v15, s[20:23], s31 offen offset:2048 sc1
    buffer_load_dwordx4 a[172:175], v15, s[20:23], s31 offen offset:3072 sc1
    buffer_load_dwordx4 a[176:179], v16, s[20:23], s29 offen offset:0 sc1
    buffer_load_dwordx4 a[180:183], v16, s[20:23], s29 offen offset:1024 sc1
    s_add_u32 s62, s62, 1
    s_cmp_gt_u32 s62, 400000
    s_waitcnt vmcnt(0)
    s_cbranch_scc1 L_ok8
    v_accvgpr_read_b32 v48, a152
    v_accvgpr_read_b32 v49, a156
    v_max_u32 v48, v48, v49
    v_cmp_eq_u32 vcc, -1, v48
    s_cbranch_vccnz L_spinl8
    s_branch L_ok8
L_spin9:
    s_mov_b32 s62, 0
L_spinl9:
    buffer_load_dwordx4 a[160:163], v15, s[20:23], s30 offen offset:2048 sc1
    buffer_load_dwordx4 a[164:167], v15, s[20:23], s30 offen offset:3072 sc1
    buffer_load_dwordx4 a[168:171], v15, s[20:23], s31 offen offset:2048 sc1
    buffer_load_dwordx4 a[172:175], v15, s[20:23], s31 offen offset:3072 sc1
    buffer_load_dwordx4 a[176:179], v16, s[20:23], s29 offen offset:0 sc1
    buffer_load_dwordx4 a[180:183], v16, s[20:23], s29 offen offset:1024 sc1
    buffer_load_dwordx4 a[184:187], v16, s[20:23], s30 offen offset:0 sc1
    buffer_load_dwordx4 a[188:191], v16, s[20:23], s30 offen offset:1024 sc1
    s_add_u32 s62, s62, 1
    s_cmp_gt_u32 s62, 400000
    s_waitcnt vmcnt(0)
    s_cbranch_scc1 L_ok9
    v_accvgpr_read_b32 v48, a160
    v_accvgpr_read_b32 v49, a164
    v_max_u32 v48, v48, v49
    v_cmp_eq_u32 vcc, -1, v48
    s_cbranch_vccnz L_spinl9
    s_branch L_ok9
L_spin10:
    s_mov_b32 s62, 0
L_spinl10:
    buffer_load_dwordx4 a[168:171], v15, s[20:23], s31 offen offset:2048 sc1
    buffer_load_dwordx4 a[172:175], v15, s[20:23], s31 offen offset:3072 sc1
    buffer_load_dwordx4 a[176:179], v16, s[20:23], s29 offen offset:0 sc1
    buffer_load_dwordx4 a[180:183], v16, s[20:23], s29 offen offset:1024 sc1
    buffer_load_dwordx4 a[184:187], v16, s[20:23], s30 offen offset:0 sc1
    buffer_load_dwordx4 a[188:191], v16, s[20:23], s30 offen offset:1024 sc1
    buffer_load_dwordx4 a[192:195], v16, s[20:23], s31 offen offset:0 sc1
    buffer_load_dwordx4 a[196:199], v16, s[20:23], s31 offen offset:1024 sc1
    s_add_u32 s62, s62, 1
    s_cmp_gt_u32 s62, 400000
    s_waitcnt vmcnt(0)
    s_cbranch_scc1 L_ok10
    v_accvgpr_read_b32 v48, a168
    v_accvgpr_read_b32 v49, a172
    v_max_u32 v48, v48, v49
    v_cmp_eq_u32 vcc, -1, v48
    s_cbranch_vccnz L_spinl10
    s_branch L_ok10
L_spin11:
    s_mov_b32 s62, 0
L_spinl11:
    buffer_load_dwordx4 a[176:179], v16, s[20:23], s29 offen offset:0 sc1
    buffer_load_dwordx4 a[180:183], v16, s[20:23], s29 offen offset:1024 sc1
    buffer_load_dwordx4 a[184:187], v16, s[20:23], s30 offen offset:0 sc1
    buffer_load_dwordx4 a[188:191], v16, s[20:23], s30 offen offset:1024 sc1
    buffer_load_dwordx4 a[192:195], v16, s[20:23], s31 offen offset:0 sc1
    buffer_load_dwordx4 a[196:199], v16, s[20:23], s31 offen offset:1024 sc1
    buffer_load_dwordx4 a[200:203], v16, s[20:23], s28 offen offset:2048 sc1
    buffer_load_dwordx4 a[204:207], v16, s[20:23], s28 offen offset:3072 sc1
    s_add_u32 s62, s62, 1
    s_cmp_gt_u32 s62, 400000
    s_waitcnt vmcnt(0)
    s_cbranch_scc1 L_ok11
    v_accvgpr_read_b32 v48, a176
    v_accvgpr_read_b32 v49, a180
    v_max_u32 v48, v48, v49
    v_cmp_eq_u32 vcc, -1, v48
    s_cbranch_vccnz L_spinl11
    s_branch L_ok11
L_spin12:
    s_mov_b32 s62, 0
L_spinl12:
    buffer_load_dwordx4 a[184:187], v16, s[20:23], s30 offen offset:0 sc1
    buffer_load_dwordx4 a[188:191], v16, s[20:23], s30 offen offset:1024 sc1
    buffer_load_dwordx4 a[192:195], v16, s[20:23], s31 offen offset:0 sc1
    buffer_load_dwordx4 a[196:199], v16, s[20:23], s31 offen offset:1024 sc1
    buffer_load_dwordx4 a[200:203], v16, s[20:23], s28 offen offset:2048 sc1
    buffer_load_dwordx4 a[204:207], v16, s[20:23], s28 offen offset:3072 sc1
    buffer_load_dwordx4 a[208:211], v16, s[20:23], s29 offen offset:2048 sc1
    buffer_load_dwordx4 a[212:215], v16, s[20:23], s29 offen offset:3072 sc1
    s_add_u32 s62, s62, 1
    s_cmp_gt_u32 s62, 400000
    s_waitcnt vmcnt(0)
    s_cbranch_scc1 L_ok12
    v_accvgpr_read_b32 v48, a184
    v_accvgpr_read_b32 v49, a188
    v_max_u32 v48, v48, v49
    v_cmp_eq_u32 vcc, -1, v48
    s_cbranch_vccnz L_spinl12
    s_branch L_ok12
L_spin13:
    s_mov_b32 s62, 0
L_spinl13:
    buffer_load_dwordx4 a[192:195], v16, s[20:23], s31 offen offset:0 sc1
    buffer_load_dwordx4 a[196:199], v16, s[20:23], s31 offen offset:1024 sc1
    buffer_load_dwordx4 a[200:203], v16, s[20:23], s28 offen offset:2048 sc1
    buffer_load_dwordx4 a[204:207], v16, s[20:23], s28 offen offset:3072 sc1
    buffer_load_dwordx4 a[208:211], v16, s[20:23], s29 offen offset:2048 sc1
    buffer_load_dwordx4 a[212:215], v16, s[20:23], s29 offen offset:3072 sc1
    buffer_load_dwordx4 a[216:219], v16, s[20:23], s30 offen offset:2048 sc1
    buffer_load_dwordx4 a[220:223], v16, s[20:23], s30 offen offset:3072 sc1
    s_add_u32 s62, s62, 1
    s_cmp_gt_u32 s62, 400000
    s_waitcnt vmcnt(0)
    s_cbranch_scc1 L_ok13
    v_accvgpr_read_b32 v48, a192
    v_accvgpr_read_b32 v49, a196
    v_max_u32 v48, v48, v49
    v_cmp_eq_u32 vcc, -1, v48
    s_cbranch_vccnz L_spinl13
    s_branch L_ok13
L_spin14:
    s_mov_b32 s62, 0
L_spinl14:
    buffer_load_dwordx4 a[200:203], v16, s[20:23], s28 offen offset:2048 sc1
    buffer_load_dwordx4 a[204:207], v16, s[20:23], s28 offen offset:3072 sc1
    buffer_load_dwordx4 a[208:211], v16, s[20:23], s29 offen offset:2048 sc1
    buffer_load_dwordx4 a[212:215], v16, s[20:23], s29 offen offset:3072 sc1
    buffer_load_dwordx4 a[216:219], v16, s[20:23], s30 offen offset:2048 sc1
    buffer_load_dwordx4 a[220:223], v16, s[20:23], s30 offen offset:3072 sc1
    buffer_load_dwordx4 a[224:227], v16, s[20:23], s31 offen offset:2048 sc1
    buffer_load_dwordx4 a[228:231], v16, s[20:23], s31 offen offset:3072 sc1
    s_add_u32 s62, s62, 1
    s_cmp_gt_u32 s62, 400000
    s_waitcnt vmcnt(0)
    s_cbranch_scc1 L_ok14
    v_accvgpr_read_b32 v48, a200
    v_accvgpr_read_b32 v49, a204
    v_max_u32 v48, v48, v49
    v_cmp_eq_u32 vcc, -1, v48
    s_cbranch_vccnz L_spinl14
    s_branch L_ok14
L_spin15:
    s_mov_b32 s62, 0
L_spinl15:
    buffer_load_dwordx4 a[208:211], v16, s[20:23], s29 offen offset:2048 sc1
    buffer_load_dwordx4 a[212:215], v16, s[20:23], s29 offen offset:3072 sc1
    buffer_load_dwordx4 a[216:219], v16, s[20:23], s30 offen offset:2048 sc1
    buffer_load_dwordx4 a[220:223], v16, s[20:23], s30 offen offset:3072 sc1
    buffer_load_dwordx4 a[224:227], v16, s[20:23], s31 offen offset:2048 sc1
    buffer_load_dwordx4 a[228:231], v16, s[20:23], s31 offen offset:3072 sc1
    buffer_load_dwordx4 a[232:235], v17, s[20:23], s28 offen offset:0 sc1
    buffer_load_dwordx4 a[236:239], v17, s[20:23], s28 offen offset:1024 sc1
    s_add_u32 s62, s62, 1
    s_cmp_gt_u32 s62, 400000
    s_waitcnt vmcnt(0)
    s_cbranch_scc1 L_ok15
    v_accvgpr_read_b32 v48, a208
    v_accvgpr_read_b32 v49, a212
    v_max_u32 v48, v48, v49
    v_cmp_eq_u32 vcc, -1, v48
    s_cbranch_vccnz L_spinl15
    s_branch L_ok15
L_spin16:
    s_mov_b32 s62, 0
L_spinl16:
    buffer_load_dwordx4 a[216:219], v16, s[20:23], s30 offen offset:2048 sc1
    buffer_load_dwordx4 a[220:223], v16, s[20:23], s30 offen offset:3072 sc1
    buffer_load_dwordx4 a[224:227], v16, s[20:23], s31 offen offset:2048 sc1
    buffer_load_dwordx4 a[228:231], v16, s[20:23], s31 offen offset:3072 sc1
    buffer_load_dwordx4 a[232:235], v17, s[20:23], s28 offen offset:0 sc1
    buffer_load_dwordx4 a[236:239], v17, s[20:23], s28 offen offset:1024 sc1
    buffer_load_dwordx4 a[240:243], v17, s[20:23], s29 offen offset:0 sc1
    buffer_load_dwordx4 a[244:247], v17, s[20:23], s29 offen offset:1024 sc1
    s_add_u32 s62, s62, 1
    s_cmp_gt_u32 s62, 400000
    s_waitcnt vmcnt(0)
    s_cbranch_scc1 L_ok16
    v_accvgpr_read_b32 v48, a216
    v_accvgpr_read_b32 v49, a220
    v_max_u32 v48, v48, v49
    v_cmp_eq_u32 vcc, -1, v48
    s_cbranch_vccnz L_spinl16
    s_branch L_ok16
L_spin17:
    s_mov_b32 s62, 0
L_spinl17:
    buffer_load_dwordx4 a[224:227], v16, s[20:23], s31 offen offset:2048 sc1
    buffer_load_dwordx4 a[228:231], v16, s[20:23], s31 offen offset:3072 sc1
    buffer_load_dwordx4 a[232:235], v17, s[20:23], s28 offen offset:0 sc1
    buffer_load_dwordx4 a[236:239], v17, s[20:23], s28 offen offset:1024 sc1
    buffer_load_dwordx4 a[240:243], v17, s[20:23], s29 offen offset:0 sc1
    buffer_load_dwordx4 a[244:247], v17, s[20:23], s29 offen offset:1024 sc1
    buffer_load_dwordx4 a[32:35], v17, s[20:23], s30 offen offset:0 sc1
    buffer_load_dwordx4 a[36:39], v17, s[20:23], s30 offen offset:1024 sc1
    s_add_u32 s62, s62, 1
    s_cmp_gt_u32 s62, 400000
    s_waitcnt vmcnt(0)
    s_cbranch_scc1 L_ok17
    v_accvgpr_read_b32 v48, a224
    v_accvgpr_read_b32 v49, a228
    v_max_u32 v48, v48, v49
    v_cmp_eq_u32 vcc, -1, v48
    s_cbranch_vccnz L_spinl17
    s_branch L_ok17
L_spin18:
    s_mov_b32 s62, 0
L_spinl18:
    buffer_load_dwordx4 a[232:235], v17, s[20:23], s28 offen offset:0 sc1
    buffer_load_dwordx4 a[236:239], v17, s[20:23], s28 offen offset:1024 sc1
    buffer_load_dwordx4 a[240:243], v17, s[20:23], s29 offen offset:0 sc1
    buffer_load_dwordx4 a[244:247], v17, s[20:23], s29 offen offset:1024 sc1
    buffer_load_dwordx4 a[32:35], v17, s[20:23], s30 offen offset:0 sc1
    buffer_load_dwordx4 a[36:39], v17, s[20:23], s30 offen offset:1024 sc1
    buffer_load_dwordx4 a[40:43], v17, s[20:23], s31 offen offset:0 sc1
    buffer_load_dwordx4 a[44:47], v17, s[20:23], s31 offen offset:1024 sc1
    s_add_u32 s62, s62, 1
    s_cmp_gt_u32 s62, 400000
    s_waitcnt vmcnt(0)
    s_cbranch_scc1 L_ok18
    v_accvgpr_read_b32 v48, a232
    v_accvgpr_read_b32 v49, a236
    v_max_u32 v48, v48, v49
    v_cmp_eq_u32 vcc, -1, v48
    s_cbranch_vccnz L_spinl18
    s_branch L_ok18
L_spin19:
    s_mov_b32 s62, 0
L_spinl19:
    buffer_load_dwordx4 a[240:243], v17, s[20:23], s29 offen offset:0 sc1
    buffer_load_dwordx4 a[244:247], v17, s[20:23], s29 offen offset:1024 sc1
    buffer_load_dwordx4 a[32:35], v17, s[20:23], s30 offen offset:0 sc1
    buffer_load_dwordx4 a[36:39], v17, s[20:23], s30 offen offset:1024 sc1
    buffer_load_dwordx4 a[40:43], v17, s[20:23], s31 offen offset:0 sc1
    buffer_load_dwordx4 a[44:47], v17, s[20:23], s31 offen offset:1024 sc1
    s_add_u32 s62, s62, 1
    s_cmp_gt_u32 s62, 400000
    s_waitcnt vmcnt(0)
    s_cbranch_scc1 L_ok19
    v_accvgpr_read_b32 v48, a240
    v_accvgpr_read_b32 v49, a244
    v_max_u32 v48, v48, v49
    v_cmp_eq_u32 vcc, -1, v48
    s_cbranch_vccnz L_spinl19
    s_branch L_ok19
L_spin20:
    s_mov_b32 s62, 0
L_spinl20:
    buffer_load_dwordx4 a[32:35], v17, s[20:23], s30 offen offset:0 sc1
    buffer_load_dwordx4 a[36:39], v17, s[20:23], s30 offen offset:1024 sc1
    buffer_load_dwordx4 a[40:43], v17, s[20:23], s31 offen offset:0 sc1
    buffer_load_dwordx4 a[44:47], v17, s[20:23], s31 offen offset:1024 sc1
    s_add_u32 s62, s62, 1
    s_cmp_gt_u32 s62, 400000
    s_waitcnt vmcnt(0)
    s_cbranch_scc1 L_ok20
    v_accvgpr_read_b32 v48, a32
    v_accvgpr_read_b32 v49, a36
    v_max_u32 v48, v48, v49
    v_cmp_eq_u32 vcc, -1, v48
    s_cbranch_vccnz L_spinl20
    s_branch L_ok20
L_spin21:
    s_mov_b32 s62, 0
L_spinl21:
    buffer_load_dwordx4 a[40:43], v17, s[20:23], s31 offen offset:0 sc1
    buffer_load_dwordx4 a[44:47], v17, s[20:23], s31 offen offset:1024 sc1
    s_add_u32 s62, s62, 1
    s_cmp_gt_u32 s62, 400000
    s_waitcnt vmcnt(0)
    s_cbranch_scc1 L_ok21
    v_accvgpr_read_b32 v48, a40
    v_accvgpr_read_b32 v49, a44
    v_max_u32 v48, v48, v49
    v_cmp_eq_u32 vcc, -1, v48
    s_cbranch_vccnz L_spinl21
    s_branch L_ok21
L_spin22:
    s_mov_b32 s62, 0
L_spinl22:
    buffer_load_dwordx4 v[160:163], v2, s[20:23], s57 offen offset:0 sc1
    buffer_load_dwordx4 v[164:167], v2, s[20:23], s57 offen offset:1024 sc1
    buffer_load_dwordx4 v[168:171], v2, s[20:23], s57 offen offset:2048 sc1
    s_add_u32 s62, s62, 1
    s_cmp_gt_u32 s62, 400000
    s_waitcnt vmcnt(0)
    s_cbranch_scc1 L_ok22
    v_bitop3_b32 v26, v163, v167, v22 bitop3:0x7e
    v_xor_b32 v27, v171, v22
    v_or_b32 v26, v26, v27
    v_cmp_ne_u32 vcc, 0, v26
    s_cbranch_vccnz L_spinl22
    s_branch L_ok22
L_attn:
    s_waitcnt lgkmcnt(6)
    s_add_u32 m0, s37, 19456
    v_mfma_f32_32x32x16_bf16 v[32:47], v[128:131], a[0:3], 0
    buffer_load_dwordx4 v4, s[8:11], s43 offen lds
    ds_read_b64_tr_b16 a[28:29], v6 offset:12288
    ds_read_b64_tr_b16 a[30:31], v6 offset:12544
    v_mov_b32 v68, -1
    v_mov_b32 v69, -1
    v_mov_b32 v70, -1
    v_mov_b32 v71, -1
    v_mfma_f32_32x32x16_bf16 v[48:63], v[128:131], a[4:7], 0
    ds_read_b64_tr_b16 a[0:1], v6 offset:5120
    ds_read_b64_tr_b16 a[2:3], v6 offset:5376
    v_fma_f32 v72, v72, v24, v25
    v_fma_f32 v168, v168, v24, v25
    v_fma_f32 v73, v73, v24, v25
    v_fma_f32 v169, v169, v24, v25
    s_add_u32 m0, s37, 27648
    v_mfma_f32_32x32x16_bf16 v[32:47], v[132:135], a[8:11], v[32:47]
    buffer_load_dwordx4 v5, s[8:11], s43 offen lds
    ds_read_b64_tr_b16 a[4:5], v6 offset:13312
    ds_read_b64_tr_b16 a[6:7], v6 offset:13568
    v_fma_f32 v74, v74, v24, v25
    v_fma_f32 v170, v170, v24, v25
    v_fma_f32 v75, v75, v24, v25
    v_mfma_f32_32x32x16_bf16 v[48:63], v[132:135], a[12:15], v[48:63]
    buffer_store_dwordx4 v[68:71], v16, s[20:23], s28 offen offset:2048 sc1
    ds_read_b64_tr_b16 a[8:9], v6 offset:6144
    ds_read_b64_tr_b16 a[10:11], v6 offset:6400
    s_waitcnt lgkmcnt(6)
    v_mfma_f32_32x32x16_bf16 v[32:47], v[136:139], a[16:19], v[32:47]
    ds_read_b64_tr_b16 a[12:13], v6 offset:14336
    ds_read_b64_tr_b16 a[14:15], v6 offset:14592
    v_fma_f32 v171, v171, v24, v25
    v_cvt_pk_bf16_f32 v168, v72, v168
    v_cvt_pk_bf16_f32 v169, v73, v169
    v_cvt_pk_bf16_f32 v170, v74, v170
    v_cvt_pk_bf16_f32 v171, v75, v171
    v_mfma_f32_32x32x16_bf16 v[48:63], v[136:139], a[20:23], v[48:63]
    ds_read_b64_tr_b16 a[16:17], v7 offset:0
    ds_read_b64_tr_b16 a[18:19], v7 offset:256
    v_fma_f32 v76, v76, v24, v25
    v_fma_f32 v176, v176, v24, v25
    v_fma_f32 v77, v77, v24, v25
    v_fma_f32 v177, v177, v24, v25
    v_fma_f32 v78, v78, v24, v25
    v_mfma_f32_32x32x16_bf16 v[32:47], v[144:147], a[24:27], v[32:47]
    ds_read_b64_tr_b16 a[20:21], v7 offset:8192
    ds_read_b64_tr_b16 a[22:23], v7 offset:8448
    v_fma_f32 v178, v178, v24, v25
    v_fma_f32 v79, v79, v24, v25
    v_fma_f32 v179, v179, v24, v25
    v_cvt_pk_bf16_f32 v176, v76, v176
    s_add_u32 m0, s37, 20480
    v_mfma_f32_32x32x16_bf16 v[48:63], v[144:147], a[28:31], v[48:63]
    buffer_load_dwordx4 v4, s[8:11], s44 offen lds
    ds_read_b64_tr_b16 a[24:25], v7 offset:1024
    ds_read_b64_tr_b16 a[26:27], v7 offset:1280
    s_waitcnt lgkmcnt(6)
    v_cvt_pk_bf16_f32 v177, v77, v177
    v_cvt_pk_bf16_f32 v178, v78, v178
    v_mfma_f32_32x32x16_bf16 v[32:47], v[148:151], a[0:3], v[32:47]
    ds_read_b64_tr_b16 a[28:29], v7 offset:9216
    ds_read_b64_tr_b16 a[30:31], v7 offset:9472
    v_cvt_pk_bf16_f32 v179, v79, v179
    v_fma_f32 v80, v80, v24, v25
    v_fma_f32 v180, v180, v24, v25
    v_fma_f32 v81, v81, v24, v25
    s_add_u32 m0, s37, 28672
    v_mfma_f32_32x32x16_bf16 v[48:63], v[148:151], a[4:7], v[48:63]
    buffer_load_dwordx4 v5, s[8:11], s44 offen lds
    ds_read_b64_tr_b16 a[0:1], v6 offset:3072
    ds_read_b64_tr_b16 a[2:3], v6 offset:3328
    v_fma_f32 v181, v181, v24, v25
    v_fma_f32 v82, v82, v24, v25
    v_fma_f32 v182, v182, v24, v25
    v_mfma_f32_32x32x16_bf16 v[32:47], v[152:155], a[8:11], v[32:47]
    ds_read_b64_tr_b16 a[4:5], v6 offset:11264
    ds_read_b64_tr_b16 a[6:7], v6 offset:11520
    v_fma_f32 v83, v83, v24, v25
    v_fma_f32 v183, v183, v24, v25
    v_cvt_pk_bf16_f32 v180, v80, v180
    v_cvt_pk_bf16_f32 v181, v81, v181
    v_cvt_pk_bf16_f32 v182, v82, v182
    v_mfma_f32_32x32x16_bf16 v[48:63], v[152:155], a[12:15], v[48:63]
    ds_read_b64_tr_b16 a[8:9], v6 offset:7168
    ds_read_b64_tr_b16 a[10:11], v6 offset:7424
    s_waitcnt lgkmcnt(6)
    v_cvt_pk_bf16_f32 v183, v83, v183
    v_fma_f32 v84, v84, v24, v25
    v_fma_f32 v184, v184, v24, v25
    s_add_u32 m0, s37, 21504
    v_mfma_f32_32x32x16_bf16 v[32:47], v[160:163], a[16:19], v[32:47]
    buffer_load_dwordx4 v4, s[8:11], s45 offen lds
    ds_read_b64_tr_b16 a[12:13], v6 offset:15360
    ds_read_b64_tr_b16 a[14:15], v6 offset:15616
    v_fma_f32 v85, v85, v24, v25
    v_fma_f32 v185, v185, v24, v25
    v_fma_f32 v86, v86, v24, v25
    v_mfma_f32_32x32x16_bf16 v[48:63], v[160:163], a[20:23], v[48:63]
    buffer_store_dwordx4 v[68:71], v16, s[20:23], s28 offen offset:3072 sc1
    ds_read_b64_tr_b16 a[16:17], v7 offset:3072
    ds_read_b64_tr_b16 a[18:19], v7 offset:3328
    v_mfma_f32_32x32x16_bf16 v[32:47], v[164:167], a[24:27], v[32:47]
    ds_read_b64_tr_b16 a[20:21], v7 offset:11264
    ds_read_b64_tr_b16 a[22:23], v7 offset:11520
    v_fma_f32 v186, v186, v24, v25
    v_fma_f32 v87, v87, v24, v25
    v_fma_f32 v187, v187, v24, v25
    v_cvt_pk_bf16_f32 v184, v84, v184
    v_cvt_pk_bf16_f32 v185, v85, v185
    v_mfma_f32_32x32x16_bf16 v[48:63], v[164:167], a[28:31], v[48:63]
    ds_read_b64_tr_b16 a[24:25], v7 offset:7168
    ds_read_b64_tr_b16 a[26:27], v7 offset:7424
    s_waitcnt lgkmcnt(6)
    v_cvt_pk_bf16_f32 v186, v86, v186
    v_cvt_pk_bf16_f32 v187, v87, v187
    v_fma_f32 v88, v88, v24, v25
    v_fma_f32 v192, v192, v24, v25
    v_mfma_f32_32x32x16_bf16 v[32:47], v[140:143], a[0:3], v[32:47]
    ds_read_b64_tr_b16 a[28:29], v7 offset:15360
    ds_read_b64_tr_b16 a[30:31], v7 offset:15616
    v_fma_f32 v89, v89, v24, v25
    v_fma_f32 v193, v193, v24, v25
    v_fma_f32 v90, v90, v24, v25
    v_fma_f32 v194, v194, v24, v25
    s_add_u32 m0, s37, 29696
    v_mfma_f32_32x32x16_bf16 v[48:63], v[140:143], a[4:7], v[48:63]
    buffer_load_dwordx4 v5, s[8:11], s45 offen lds
    ds_read_b64_tr_b16 a[0:1], v8 offset:3072
    ds_read_b64_tr_b16 a[2:3], v8 offset:3328
    v_fma_f32 v91, v91, v24, v25
    v_fma_f32 v195, v195, v24, v25
    v_cvt_pk_bf16_f32 v192, v88, v192
    v_mfma_f32_32x32x16_bf16 v[32:47], v[156:159], a[8:11], v[32:47]
    ds_read_b64_tr_b16 a[4:5], v8 offset:11264
    ds_read_b64_tr_b16 a[6:7], v8 offset:11520
    v_cvt_pk_bf16_f32 v193, v89, v193
    v_cvt_pk_bf16_f32 v194, v90, v194
    v_cvt_pk_bf16_f32 v195, v91, v195
    v_fma_f32 v92, v92, v24, v25
    s_add_u32 m0, s37, 22528
    v_mfma_f32_32x32x16_bf16 v[48:63], v[156:159], a[12:15], v[48:63]
    buffer_load_dwordx4 v4, s[8:11], s46 offen lds
    ds_read_b64_tr_b16 a[8:9], v8 offset:7168
    ds_read_b64_tr_b16 a[10:11], v8 offset:7424
    s_waitcnt lgkmcnt(6)
    v_fma_f32 v196, v196, v24, v25
    v_fma_f32 v93, v93, v24, v25
    v_mfma_f32_32x32x16_bf16 v[32:47], v[172:175], a[16:19], v[32:47]
    ds_read_b64_tr_b16 a[12:13], v8 offset:15360
    ds_read_b64_tr_b16 a[14:15], v8 offset:15616
    v_fma_f32 v197, v197, v24, v25
    v_fma_f32 v94, v94, v24, v25
    v_fma_f32 v198, v198, v24, v25
    v_fma_f32 v95, v95, v24, v25
    s_add_u32 m0, s37, 30720
    v_mfma_f32_32x32x16_bf16 v[48:63], v[172:175], a[20:23], v[48:63]
    buffer_load_dwordx4 v5, s[8:11], s46 offen lds
    ds_read_b64_tr_b16 a[16:17], v9 offset:3072
    ds_read_b64_tr_b16 a[18:19], v9 offset:3328
    v_fma_f32 v199, v199, v24, v25
    v_cvt_pk_bf16_f32 v196, v92, v196
    v_cvt_pk_bf16_f32 v197, v93, v197
    v_mfma_f32_32x32x16_bf16 v[32:47], v[188:191], a[24:27], v[32:47]
    ds_read_b64_tr_b16 a[20:21], v9 offset:11264
    ds_read_b64_tr_b16 a[22:23], v9 offset:11520
    v_cvt_pk_bf16_f32 v198, v94, v198
    v_cvt_pk_bf16_f32 v199, v95, v199
    v_fma_f32 v96, v96, v24, v25
    v_fma_f32 v200, v200, v24, v25
    v_fma_f32 v97, v97, v24, v25
    v_mfma_f32_32x32x16_bf16 v[48:63], v[188:191], a[28:31], v[48:63]
    buffer_store_dwordx4 v[68:71], v17, s[20:23], s28 offen offset:0 sc1
    ds_read_b64_tr_b16 a[24:25], v9 offset:4096
    ds_read_b64_tr_b16 a[26:27], v9 offset:4352
    s_waitcnt lgkmcnt(6)
    v_mfma_f32_32x32x16_bf16 v[32:47], v[204:207], a[0:3], v[32:47]
    ds_read_b64_tr_b16 a[28:29], v9 offset:12288
    ds_read_b64_tr_b16 a[30:31], v9 offset:12544
    v_fma_f32 v201, v201, v24, v25
    v_fma_f32 v98, v98, v24, v25
    v_fma_f32 v202, v202, v24, v25
    v_fma_f32 v99, v99, v24, v25
    v_fma_f32 v203, v203, v24, v25
    v_mfma_f32_32x32x16_bf16 v[48:63], v[204:207], a[4:7], v[48:63]
    ds_read_b64_tr_b16 a[0:1], v9 offset:5120
    ds_read_b64_tr_b16 a[2:3], v9 offset:5376
    v_cvt_pk_bf16_f32 v200, v96, v200
    v_cvt_pk_bf16_f32 v201, v97, v201
    v_cvt_pk_bf16_f32 v202, v98, v202
    s_add_u32 m0, s37, 23552
    v_mfma_f32_32x32x16_bf16 v[32:47], v[220:223], a[8:11], v[32:47]
    buffer_load_dwordx4 v4, s[8:11], s47 offen lds
    ds_read_b64_tr_b16 a[4:5], v9 offset:13312
    ds_read_b64_tr_b16 a[6:7], v9 offset:13568
    v_cvt_pk_bf16_f32 v203, v99, v203
    v_fma_f32 v100, v100, v24, v25
    v_mfma_f32_32x32x16_bf16 v[48:63], v[220:223], a[12:15], v[48:63]
    ds_read_b64_tr_b16 a[8:9], v9 offset:6144
    ds_read_b64_tr_b16 a[10:11], v9 offset:6400
    s_waitcnt lgkmcnt(6)
    v_fma_f32 v208, v208, v24, v25
    v_fma_f32 v101, v101, v24, v25
    v_fma_f32 v209, v209, v24, v25
    v_mfma_f32_32x32x16_bf16 v[32:47], v[236:239], a[16:19], v[32:47]
    ds_read_b64_tr_b16 a[12:13], v9 offset:14336
    ds_read_b64_tr_b16 a[14:15], v9 offset:14592
    v_fma_f32 v102, v102, v24, v25
    v_fma_f32 v210, v210, v24, v25
    v_fma_f32 v103, v103, v24, v25
    s_add_u32 m0, s37, 31744
    v_mfma_f32_32x32x16_bf16 v[48:63], v[236:239], a[20:23], v[48:63]
    buffer_load_dwordx4 v5, s[8:11], s47 offen lds
    ds_read_b64_tr_b16 a[16:17], v7 offset:2048
    ds_read_b64_tr_b16 a[18:19], v7 offset:2304
    v_subrev_u32 v4, 2048, v4
    v_subrev_u32 v5, 2048, v5
    v_fma_f32 v211, v211, v24, v25
    v_cvt_pk_bf16_f32 v208, v100, v208
    v_mfma_f32_32x32x16_bf16 v[32:47], v[240:243], a[24:27], v[32:47]
    ds_read_b64_tr_b16 a[20:21], v7 offset:10240
    ds_read_b64_tr_b16 a[22:23], v7 offset:10496
    v_cvt_pk_bf16_f32 v209, v101, v209
    v_cvt_pk_bf16_f32 v210, v102, v210
    s_add_u32 m0, s37, 32768
    s_add_u32 s48, s60, 0
    v_mfma_f32_32x32x16_bf16 v[48:63], v[240:243], a[28:31], v[48:63]
    buffer_load_dwordx4 v10, s[12:15], s48 offen offset:0 lds
    ds_read_b64_tr_b16 a[24:25], v7 offset:4096
    ds_read_b64_tr_b16 a[26:27], v7 offset:4352
    s_waitcnt lgkmcnt(6)
    v_cvt_pk_bf16_f32 v211, v103, v211
    v_mfma_f32_32x32x16_bf16 v[32:47], v[244:247], a[0:3], v[32:47]
    ds_read_b64_tr_b16 a[28:29], v7 offset:12288
    ds_read_b64_tr_b16 a[30:31], v7 offset:12544
    v_fma_f32 v104, v104, v24, v25
    v_fma_f32 v212, v212, v24, v25
    v_fma_f32 v105, v105, v24, v25
    v_fma_f32 v213, v213, v24, v25
    v_mfma_f32_32x32x16_bf16 v[48:63], v[244:247], a[4:7], v[48:63]
    buffer_store_dwordx4 v[68:71], v17, s[20:23], s28 offen offset:1024 sc1
    ds_read_b64_tr_b16 a[0:1], v7 offset:5120
    ds_read_b64_tr_b16 a[2:3], v7 offset:5376
    v_mfma_f32_32x32x16_bf16 v[32:47], v[248:251], a[8:11], v[32:47]
    ds_read_b64_tr_b16 a[4:5], v7 offset:13312
    ds_read_b64_tr_b16 a[6:7], v7 offset:13568
    v_fma_f32 v106, v106, v24, v25
    v_fma_f32 v214, v214, v24, v25
    v_fma_f32 v107, v107, v24, v25
    v_fma_f32 v215, v215, v24, v25
    v_mfma_f32_32x32x16_bf16 v[48:63], v[248:251], a[12:15], v[48:63]
    ds_read_b64_tr_b16 a[8:9], v7 offset:6144
    ds_read_b64_tr_b16 a[10:11], v7 offset:6400
    s_waitcnt lgkmcnt(6)
    v_cvt_pk_bf16_f32 v212, v104, v212
    v_cvt_pk_bf16_f32 v213, v105, v213
    v_cvt_pk_bf16_f32 v214, v106, v214
    v_mfma_f32_32x32x16_bf16 v[32:47], v[168:171], a[16:19], v[32:47]
    buffer_load_dwordx4 v11, s[12:15], s48 offen offset:1024 lds
    ds_read_b64_tr_b16 a[12:13], v7 offset:14336
    ds_read_b64_tr_b16 a[14:15], v7 offset:14592
    v_cvt_pk_bf16_f32 v215, v107, v215
    v_fma_f32 v108, v108, v24, v25
    v_mfma_f32_32x32x16_bf16 v[48:63], v[168:171], a[20:23], v[48:63]
    ds_read_b64_tr_b16 a[16:17], v8 offset:0
    ds_read_b64_tr_b16 a[18:19], v8 offset:256
    v_fma_f32 v216, v216, v24, v25
    v_fma_f32 v109, v109, v24, v25
    v_fma_f32 v217, v217, v24, v25
    v_fma_f32 v110, v110, v24, v25
    v_mfma_f32_32x32x16_bf16 v[32:47], v[176:179], a[24:27], v[32:47]
    buffer_load_dwordx4 v12, s[12:15], s48 offen offset:2048 lds
    ds_read_b64_tr_b16 a[20:21], v8 offset:8192
    ds_read_b64_tr_b16 a[22:23], v8 offset:8448
    v_fma_f32 v218, v218, v24, v25
    v_fma_f32 v111, v111, v24, v25
    v_mfma_f32_32x32x16_bf16 v[48:63], v[176:179], a[28:31], v[48:63]
    ds_read_b64_tr_b16 a[24:25], v8 offset:1024
    ds_read_b64_tr_b16 a[26:27], v8 offset:1280
    s_waitcnt lgkmcnt(6)
    v_fma_f32 v219, v219, v24, v25
    v_cvt_pk_bf16_f32 v216, v108, v216
    v_cvt_pk_bf16_f32 v217, v109, v217
    v_mfma_f32_32x32x16_bf16 v[32:47], v[180:183], a[0:3], v[32:47]
    ds_read_b64_tr_b16 a[28:29], v8 offset:9216
    ds_read_b64_tr_b16 a[30:31], v8 offset:9472
    v_cvt_pk_bf16_f32 v218, v110, v218
    v_cvt_pk_bf16_f32 v219, v111, v219
    v_fma_f32 v112, v112, v24, v25
    v_fma_f32 v224, v224, v24, v25
    v_mfma_f32_32x32x16_bf16 v[48:63], v[180:183], a[4:7], v[48:63]
    buffer_load_dwordx4 v13, s[12:15], s48 offen offset:3072 lds
    ds_read_b64_tr_b16 a[0:1], v8 offset:2048
    ds_read_b64_tr_b16 a[2:3], v8 offset:2304
    v_fma_f32 v113, v113, v24, v25
    v_fma_f32 v225, v225, v24, v25
    v_mfma_f32_32x32x16_bf16 v[32:47], v[184:187], a[8:11], v[32:47]
    ds_read_b64_tr_b16 a[4:5], v8 offset:10240
    ds_read_b64_tr_b16 a[6:7], v8 offset:10496
    v_fma_f32 v114, v114, v24, v25
    v_fma_f32 v226, v226, v24, v25
    s_add_u32 m0, s37, 36864
    s_add_u32 s48, s60, 32768
    v_mfma_f32_32x32x16_bf16 v[48:63], v[184:187], a[12:15], v[48:63]
    buffer_load_dwordx4 v10, s[12:15], s48 offen offset:0 lds
    ds_read_b64_tr_b16 a[8:9], v8 offset:4096
    ds_read_b64_tr_b16 a[10:11], v8 offset:4352
    s_waitcnt lgkmcnt(6)
    v_fma_f32 v115, v115, v24, v25
    v_mfma_f32_32x32x16_bf16 v[32:47], v[192:195], a[16:19], v[32:47]
    ds_read_b64_tr_b16 a[12:13], v8 offset:12288
    ds_read_b64_tr_b16 a[14:15], v8 offset:12544
    v_fma_f32 v227, v227, v24, v25
    v_cvt_pk_bf16_f32 v224, v112, v224
    v_cvt_pk_bf16_f32 v225, v113, v225
    v_cvt_pk_bf16_f32 v226, v114, v226
    v_mfma_f32_32x32x16_bf16 v[48:63], v[192:195], a[20:23], v[48:63]
    buffer_load_dwordx4 v11, s[12:15], s48 offen offset:1024 lds
    ds_read_b64_tr_b16 a[16:17], v8 offset:5120
    ds_read_b64_tr_b16 a[18:19], v8 offset:5376
    v_cvt_pk_bf16_f32 v227, v115, v227
    v_fma_f32 v116, v116, v24, v25
    v_mfma_f32_32x32x16_bf16 v[32:47], v[196:199], a[24:27], v[32:47]
    ds_read_b64_tr_b16 a[20:21], v8 offset:13312
    ds_read_b64_tr_b16 a[22:23], v8 offset:13568
    v_fma_f32 v228, v228, v24, v25
    v_fma_f32 v117, v117, v24, v25
    v_fma_f32 v229, v229, v24, v25
    v_fma_f32 v118, v118, v24, v25
    v_mfma_f32_32x32x16_bf16 v[48:63], v[196:199], a[28:31], v[48:63]
    ds_read_b64_tr_b16 a[24:25], v8 offset:6144
    ds_read_b64_tr_b16 a[26:27], v8 offset:6400
    s_waitcnt lgkmcnt(6)
    v_fma_f32 v230, v230, v24, v25
    v_fma_f32 v119, v119, v24, v25
    v_fma_f32 v231, v231, v24, v25
    v_mfma_f32_32x32x16_bf16 v[32:47], v[200:203], a[0:3], v[32:47]
    buffer_load_dwordx4 v12, s[12:15], s48 offen offset:2048 lds
    ds_read_b64_tr_b16 a[28:29], v8 offset:14336
    ds_read_b64_tr_b16 a[30:31], v8 offset:14592
    v_cvt_pk_bf16_f32 v228, v116, v228
    v_cvt_pk_bf16_f32 v229, v117, v229
    v_mfma_f32_32x32x16_bf16 v[48:63], v[200:203], a[4:7], v[48:63]
    ds_read_b64_tr_b16 a[0:1], v9 offset:0
    ds_read_b64_tr_b16 a[2:3], v9 offset:256
    v_cvt_pk_bf16_f32 v230, v118, v230
    v_cvt_pk_bf16_f32 v231, v119, v231
    v_fma_f32 v120, v120, v24, v25
    v_fma_f32 v232, v232, v24, v25
    v_mfma_f32_32x32x16_bf16 v[32:47], v[208:211], a[8:11], v[32:47]
    buffer_load_dwordx4 v13, s[12:15], s48 offen offset:3072 lds
    ds_read_b64_tr_b16 a[4:5], v9 offset:8192
    ds_read_b64_tr_b16 a[6:7], v9 offset:8448
    v_fma_f32 v121, v121, v24, v25
    v_fma_f32 v233, v233, v24, v25
    v_mfma_f32_32x32x16_bf16 v[48:63], v[208:211], a[12:15], v[48:63]
    ds_read_b64_tr_b16 a[8:9], v9 offset:1024
    ds_read_b64_tr_b16 a[10:11], v9 offset:1280
    s_waitcnt lgkmcnt(6)
    v_fma_f32 v122, v122, v24, v25
    v_fma_f32 v234, v234, v24, v25
    s_add_u32 s48, s63, 0
    v_mfma_f32_32x32x16_bf16 v[32:47], v[212:215], a[16:19], v[32:47]
    buffer_load_dwordx4 a[184:187], v10, s[12:15], s48 offen offset:0
    ds_read_b64_tr_b16 a[12:13], v9 offset:9216
    ds_read_b64_tr_b16 a[14:15], v9 offset:9472
    v_fma_f32 v123, v123, v24, v25
    v_fma_f32 v235, v235, v24, v25
    v_mfma_f32_32x32x16_bf16 v[48:63], v[212:215], a[20:23], v[48:63]
    ds_read_b64_tr_b16 a[16:17], v9 offset:2048
    ds_read_b64_tr_b16 a[18:19], v9 offset:2304
    v_cvt_pk_bf16_f32 v232, v120, v232
    v_cvt_pk_bf16_f32 v233, v121, v233
    v_cvt_pk_bf16_f32 v234, v122, v234
    v_cvt_pk_bf16_f32 v235, v123, v235
    v_mfma_f32_32x32x16_bf16 v[32:47], v[216:219], a[24:27], v[32:47]
    ds_read_b64_tr_b16 a[20:21], v9 offset:10240
    ds_read_b64_tr_b16 a[22:23], v9 offset:10496
    v_lshlrev_b32 v124, 16, v252
    v_and_b32 v252, s53, v252
    v_lshlrev_b32 v125, 16, v253
    v_and_b32 v253, s53, v253
    v_mfma_f32_32x32x16_bf16 v[48:63], v[216:219], a[28:31], v[48:63]
    buffer_load_dwordx4 a[188:191], v11, s[12:15], s48 offen offset:1024
    ds_read_b64_tr_b16 a[24:25], v9 offset:7168
    ds_read_b64_tr_b16 a[26:27], v9 offset:7424
    s_waitcnt lgkmcnt(6)
    v_lshlrev_b32 v126, 16, v254
    v_mfma_f32_32x32x16_bf16 v[32:47], v[224:227], a[0:3], v[32:47]
    ds_read_b64_tr_b16 a[28:29], v9 offset:15360
    ds_read_b64_tr_b16 a[30:31], v9 offset:15616
    v_and_b32 v254, s53, v254
    v_lshlrev_b32 v127, 16, v255
    v_and_b32 v255, s53, v255
    v_fma_f32 v124, v124, v24, v25
    v_mfma_f32_32x32x16_bf16 v[48:63], v[224:227], a[4:7], v[48:63]
    buffer_load_dwordx4 a[192:195], v12, s[12:15], s48 offen offset:2048
    v_fma_f32 v252, v252, v24, v25
    v_fma_f32 v125, v125, v24, v25
    v_fma_f32 v253, v253, v24, v25
    v_fma_f32 v126, v126, v24, v25
    v_mfma_f32_32x32x16_bf16 v[32:47], v[228:231], a[8:11], v[32:47]
    v_fma_f32 v254, v254, v24, v25
    v_fma_f32 v127, v127, v24, v25
    v_fma_f32 v255, v255, v24, v25
    v_cvt_pk_bf16_f32 v252, v124, v252
    v_cvt_pk_bf16_f32 v253, v125, v253
    v_cvt_pk_bf16_f32 v254, v126, v254
    v_mfma_f32_32x32x16_bf16 v[48:63], v[228:231], a[12:15], v[48:63]
    buffer_load_dwordx4 a[196:199], v13, s[12:15], s48 offen offset:3072
    s_waitcnt lgkmcnt(0)
    v_cvt_pk_bf16_f32 v255, v127, v255
    s_waitcnt vmcnt(13)
    s_barrier
    v_mfma_f32_32x32x16_bf16 v[32:47], v[232:235], a[16:19], v[32:47]
    ds_read_b64_tr_b16 a[0:1], v6 offset:16384
    ds_read_b64_tr_b16 a[2:3], v6 offset:16640
    ds_read_b64_tr_b16 a[4:5], v6 offset:17408
    ds_read_b64_tr_b16 a[6:7], v6 offset:17664
    ds_read_b64_tr_b16 a[8:9], v6 offset:18432
    ds_read_b64_tr_b16 a[10:11], v6 offset:18688
    ds_read_b64_tr_b16 a[12:13], v6 offset:19456
    ds_read_b64_tr_b16 a[14:15], v6 offset:19712
    s_add_u32 m0, s37, 0
    v_mfma_f32_32x32x16_bf16 v[48:63], v[232:235], a[20:23], v[48:63]
    buffer_load_dwordx4 v4, s[8:11], s40 offen lds
    ds_read_b64_tr_b16 a[16:17], v6 offset:20480
    ds_read_b64_tr_b16 a[18:19], v6 offset:20736
    v_mfma_f32_32x32x16_bf16 v[32:47], v[252:255], a[24:27], v[32:47]
    ds_read_b64_tr_b16 a[20:21], v6 offset:21504
    ds_read_b64_tr_b16 a[22:23], v6 offset:21760
    v_cmp_eq_u32 vcc, 0, v30
    s_cbranch_vccnz L_spin23
L_ok23:
    v_readfirstlane_b32 s38, v30
    v_mov_b32 v22, v30
    s_mov_b32 s54, 0x3f317218
    s_mov_b32 s55, 0x35c1a2a0
    s_mov_b32 s82, 0x0000ffff
    s_mov_b32 s83, 0x0000ffff
    s_lshl2_add_u32 s49, s33, s3
    s_lshl_b32 s39, s49, 14
    v_mfma_f32_32x32x16_bf16 v[48:63], v[252:255], a[28:31], v[48:63]
    ds_read_b64_tr_b16 a[24:25], v6 offset:22528
    ds_read_b64_tr_b16 a[26:27], v6 offset:22784
    s_waitcnt lgkmcnt(6)
    s_add_u32 s39, s39, 10485760
    s_lshl_b32 s49, s32, 10
    s_add_u32 s57, s39, s49
    s_add_u32 m0, s37, 8192
    v_mfma_f32_32x32x16_bf16 v[96:111], v[128:131], a[0:3], 0
    buffer_load_dwordx4 v5, s[8:11], s40 offen lds
    ds_read_b64_tr_b16 a[28:29], v6 offset:23552
    ds_read_b64_tr_b16 a[30:31], v6 offset:23808
    s_andn2_b32 s84, s57, 0xfff
    s_xor_b32 s85, s84, 0x1000
    s_xor_b32 s86, s84, 0x2000
    v_mfma_f32_32x32x16_bf16 v[96:111], v[132:135], a[4:7], v[96:111]
    ds_read_b64_tr_b16 a[0:1], v7 offset:16384
    ds_read_b64_tr_b16 a[2:3], v7 offset:16640
    s_xor_b32 s87, s84, 0x3000
    v_add_u32 v122, s37, v2
    s_lshl_b32 s49, s3, 10
    v_add_u32 v123, s49, v2
    s_add_u32 m0, s37, 1024
    v_mfma_f32_32x32x16_bf16 v[96:111], v[136:139], a[8:11], v[96:111]
    buffer_load_dwordx4 v4, s[8:11], s41 offen lds
    ds_read_b64_tr_b16 a[4:5], v7 offset:17408
    ds_read_b64_tr_b16 a[6:7], v7 offset:17664
    v_exp_f32_e64 v64, v32 clamp
    v_max_f32 v32, s55, v32
    v_mfma_f32_32x32x16_bf16 v[96:111], v[140:143], a[12:15], v[96:111]
    ds_read_b64_tr_b16 a[8:9], v7 offset:18432
    ds_read_b64_tr_b16 a[10:11], v7 offset:18688
    s_waitcnt lgkmcnt(6)
    v_exp_f32_e64 v65, v33 clamp
    v_max_f32 v33, s55, v33
    s_add_u32 m0, s37, 9216
    v_mfma_f32_32x32x16_bf16 v[96:111], v[144:147], a[16:19], v[96:111]
    buffer_load_dwordx4 v5, s[8:11], s41 offen lds
    ds_read_b64_tr_b16 a[12:13], v7 offset:19456
    ds_read_b64_tr_b16 a[14:15], v7 offset:19712
    v_fmac_f32 v64, s54, v32
    v_exp_f32_e64 v66, v34 clamp
    v_mfma_f32_32x32x16_bf16 v[96:111], v[148:151], a[20:23], v[96:111]
    ds_read_b64_tr_b16 a[16:17], v7 offset:20480
    ds_read_b64_tr_b16 a[18:19], v7 offset:20736
    v_max_f32 v34, s55, v34
    v_fmac_f32 v65, s54, v33
    v_exp_f32_e64 v67, v35 clamp
    s_add_u32 m0, s37, 2048
    v_mfma_f32_32x32x16_bf16 v[96:111], v[152:155], a[24:27], v[96:111]
    buffer_load_dwordx4 v4, s[8:11], s42 offen lds
    ds_read_b64_tr_b16 a[20:21], v7 offset:21504
    ds_read_b64_tr_b16 a[22:23], v7 offset:21760
    v_max_f32 v35, s55, v35
    v_fmac_f32 v66, s54, v34
    v_cvt_pk_bf16_f32 v72, v64, v65
    v_mfma_f32_32x32x16_bf16 v[96:111], v[156:159], a[28:31], v[96:111]
    ds_read_b64_tr_b16 a[24:25], v7 offset:22528
    ds_read_b64_tr_b16 a[26:27], v7 offset:22784
    s_waitcnt lgkmcnt(6)
    v_add_f32 v120, v64, v65
    v_exp_f32_e64 v68, v36 clamp
    s_add_u32 m0, s37, 10240
    v_mfma_f32_32x32x16_bf16 v[96:111], v[160:163], a[0:3], v[96:111]
    buffer_load_dwordx4 v5, s[8:11], s42 offen lds
    ds_read_b64_tr_b16 a[28:29], v7 offset:23552
    ds_read_b64_tr_b16 a[30:31], v7 offset:23808
    v_max_f32 v36, s55, v36
    v_fmac_f32 v67, s54, v35
    v_mfma_f32_32x32x16_bf16 v[96:111], v[164:167], a[4:7], v[96:111]
    ds_read_b64_tr_b16 a[0:1], v8 offset:16384
    ds_read_b64_tr_b16 a[2:3], v8 offset:16640
    v_exp_f32_e64 v69, v37 clamp
    v_max_f32 v37, s55, v37
    v_fmac_f32 v68, s54, v36
    s_add_u32 m0, s37, 3072
    v_mfma_f32_32x32x16_bf16 v[96:111], v[168:171], a[8:11], v[96:111]
    buffer_load_dwordx4 v4, s[8:11], s43 offen lds
    ds_read_b64_tr_b16 a[4:5], v8 offset:17408
    ds_read_b64_tr_b16 a[6:7], v8 offset:17664
    v_cvt_pk_bf16_f32 v73, v66, v67
    v_add_f32 v120, v120, v66
    v_add_f32 v120, v120, v67
    v_mfma_f32_32x32x16_bf16 v[96:111], v[172:175], a[12:15], v[96:111]
    ds_read_b64_tr_b16 a[8:9], v8 offset:18432
    ds_read_b64_tr_b16 a[10:11], v8 offset:18688
    s_waitcnt lgkmcnt(6)
    v_exp_f32_e64 v64, v38 clamp
    v_max_f32 v38, s55, v38
    s_add_u32 m0, s37, 11264
    v_mfma_f32_32x32x16_bf16 v[96:111], v[176:179], a[16:19], v[96:111]
    buffer_load_dwordx4 v5, s[8:11], s43 offen lds
    ds_read_b64_tr_b16 a[12:13], v8 offset:19456
    ds_read_b64_tr_b16 a[14:15], v8 offset:19712
    v_fmac_f32 v69, s54, v37
    v_exp_f32_e64 v65, v39 clamp
    v_mfma_f32_32x32x16_bf16 v[96:111], v[180:183], a[20:23], v[96:111]
    ds_read_b64_tr_b16 a[16:17], v8 offset:20480
    ds_read_b64_tr_b16 a[18:19], v8 offset:20736
    v_max_f32 v39, s55, v39
    v_fmac_f32 v64, s54, v38
    v_cvt_pk_bf16_f32 v74, v68, v69
    v_add_f32 v120, v120, v68
    s_add_u32 m0, s37, 4096
    v_mfma_f32_32x32x16_bf16 v[96:111], v[184:187], a[24:27], v[96:111]
    buffer_load_dwordx4 v4, s[8:11], s44 offen lds
    ds_read_b64_tr_b16 a[20:21], v8 offset:21504
    ds_read_b64_tr_b16 a[22:23], v8 offset:21760
    v_add_f32 v120, v120, v69
    v_exp_f32_e64 v66, v40 clamp
    v_mfma_f32_32x32x16_bf16 v[96:111], v[188:191], a[28:31], v[96:111]
    ds_read_b64_tr_b16 a[24:25], v8 offset:22528
    ds_read_b64_tr_b16 a[26:27], v8 offset:22784
    s_waitcnt lgkmcnt(6)
    v_max_f32 v40, s55, v40
    v_fmac_f32 v65, s54, v39
    v_exp_f32_e64 v67, v41 clamp
    v_mfma_f32_32x32x16_bf16 v[96:111], v[192:195], a[0:3], v[96:111]
    s_waitcnt vmcnt(20)
    s_add_u32 s62, s58, 524288
    buffer_store_dword v22, v20, s[20:23], s62 offen sc1
    ds_read_b64_tr_b16 a[28:29], v8 offset:23552
    ds_read_b64_tr_b16 a[30:31], v8 offset:23808
    s_add_u32 m0, s37, 12288
    v_mfma_f32_32x32x16_bf16 v[96:111], v[196:199], a[4:7], v[96:111]
    buffer_load_dwordx4 v5, s[8:11], s44 offen lds
    ds_read_b64_tr_b16 a[0:1], v9 offset:16384
    ds_read_b64_tr_b16 a[2:3], v9 offset:16640
    v_max_f32 v41, s55, v41
    v_fmac_f32 v66, s54, v40
    v_cvt_pk_bf16_f32 v75, v64, v65
    v_mfma_f32_32x32x16_bf16 v[96:111], v[200:203], a[8:11], v[96:111]
    ds_read_b64_tr_b16 a[4:5], v9 offset:17408
    ds_read_b64_tr_b16 a[6:7], v9 offset:17664
    v_add_f32 v120, v120, v64
    v_add_f32 v120, v120, v65
    v_exp_f32_e64 v68, v42 clamp
    s_add_u32 m0, s37, 5120
    v_mfma_f32_32x32x16_bf16 v[96:111], v[204:207], a[12:15], v[96:111]
    buffer_load_dwordx4 v4, s[8:11], s45 offen lds
    ds_read_b64_tr_b16 a[8:9], v9 offset:18432
    ds_read_b64_tr_b16 a[10:11], v9 offset:18688
    s_waitcnt lgkmcnt(6)
    v_max_f32 v42, s55, v42
    v_fmac_f32 v67, s54, v41
    v_mfma_f32_32x32x16_bf16 v[96:111], v[208:211], a[16:19], v[96:111]
    ds_read_b64_tr_b16 a[12:13], v9 offset:19456
    ds_read_b64_tr_b16 a[14:15], v9 offset:19712
    v_exp_f32_e64 v69, v43 clamp
    v_max_f32 v43, s55, v43
    v_fmac_f32 v68, s54, v42
    s_add_u32 m0, s37, 13312
    v_mfma_f32_32x32x16_bf16 v[96:111], v[212:215], a[20:23], v[96:111]
    buffer_load_dwordx4 v5, s[8:11], s45 offen lds
    ds_read_b64_tr_b16 a[16:17], v9 offset:20480
    ds_read_b64_tr_b16 a[18:19], v9 offset:20736
    v_cvt_pk_bf16_f32 v76, v66, v67
    v_add_f32 v120, v120, v66
    v_add_f32 v120, v120, v67
    v_mfma_f32_32x32x16_bf16 v[96:111], v[216:219], a[24:27], v[96:111]
    ds_read_b64_tr_b16 a[20:21], v9 offset:21504
    ds_read_b64_tr_b16 a[22:23], v9 offset:21760
    v_exp_f32_e64 v64, v44 clamp
    v_max_f32 v44, s55, v44
    v_fmac_f32 v69, s54, v43
    v_mfma_f32_32x32x16_bf16 v[96:111], v[220:223], a[28:31], v[96:111]
    ds_read_b64_tr_b16 a[24:25], v9 offset:22528
    ds_read_b64_tr_b16 a[26:27], v9 offset:22784
    s_waitcnt lgkmcnt(6)
    v_exp_f32_e64 v65, v45 clamp
    v_max_f32 v45, s55, v45
    v_mfma_f32_32x32x16_bf16 v[96:111], v[224:227], a[0:3], v[96:111]
    ds_read_b64_tr_b16 a[28:29], v9 offset:23552
    ds_read_b64_tr_b16 a[30:31], v9 offset:23808
    v_fmac_f32 v64, s54, v44
    v_cvt_pk_bf16_f32 v77, v68, v69
    v_add_f32 v120, v120, v68
    v_add_f32 v120, v120, v69
    v_mfma_f32_32x32x16_bf16 v[96:111], v[228:231], a[4:7], v[96:111]
    ds_read_b64_tr_b16 a[0:1], v6 offset:24576
    ds_read_b64_tr_b16 a[2:3], v6 offset:24832
    v_exp_f32_e64 v66, v46 clamp
    v_max_f32 v46, s55, v46
    v_fmac_f32 v65, s54, v45
    s_add_u32 m0, s37, 6144
    v_mfma_f32_32x32x16_bf16 v[96:111], v[232:235], a[8:11], v[96:111]
    buffer_load_dwordx4 v4, s[8:11], s46 offen lds
    ds_read_b64_tr_b16 a[4:5], v6 offset:25600
    ds_read_b64_tr_b16 a[6:7], v6 offset:25856
    v_exp_f32_e64 v67, v47 clamp
    v_mfma_f32_32x32x16_bf16 v[96:111], v[236:239], a[12:15], v[96:111]
    ds_read_b64_tr_b16 a[8:9], v6 offset:26624
    ds_read_b64_tr_b16 a[10:11], v6 offset:26880
    s_waitcnt lgkmcnt(6)
    s_barrier
    s_add_u32 m0, s37, 14336
    v_mfma_f32_32x32x16_bf16 v[96:111], v[240:243], a[16:19], v[96:111]
    buffer_load_dwordx4 v5, s[8:11], s46 offen lds
    ds_read_b64_tr_b16 a[12:13], v6 offset:27648
    ds_read_b64_tr_b16 a[14:15], v6 offset:27904
    v_max_f32 v47, s55, v47
    v_fmac_f32 v66, s54, v46
    v_mfma_f32_32x32x16_bf16 v[96:111], v[244:247], a[20:23], v[96:111]
    ds_read_b64_tr_b16 a[16:17], v6 offset:28672
    ds_read_b64_tr_b16 a[18:19], v6 offset:28928
    v_cvt_pk_bf16_f32 v78, v64, v65
    v_add_f32 v120, v120, v64
    v_add_f32 v120, v120, v65
    s_add_u32 m0, s37, 7168
    v_mfma_f32_32x32x16_bf16 v[96:111], v[248:251], a[24:27], v[96:111]
    buffer_load_dwordx4 v4, s[8:11], s47 offen lds
    ds_read_b64_tr_b16 a[20:21], v6 offset:29696
    ds_read_b64_tr_b16 a[22:23], v6 offset:29952
    v_fmac_f32 v67, s54, v47
    v_cvt_pk_bf16_f32 v79, v66, v67
    v_mfma_f32_32x32x16_bf16 v[96:111], v[252:255], a[28:31], v[96:111]
    ds_read_b64_tr_b16 a[24:25], v6 offset:30720
    ds_read_b64_tr_b16 a[26:27], v6 offset:30976
    s_waitcnt lgkmcnt(6)
    v_add_f32 v120, v120, v66
    v_add_f32 v120, v120, v67
    s_add_u32 m0, s37, 15360
    v_mfma_f32_32x32x16_bf16 v[32:47], v[128:131], a[0:3], 0
    buffer_load_dwordx4 v5, s[8:11], s47 offen lds
    ds_read_b64_tr_b16 a[28:29], v6 offset:31744
    ds_read_b64_tr_b16 a[30:31], v6 offset:32000
    v_exp_f32_e64 v64, v48 clamp
    v_max_f32 v48, s55, v48
    v_mfma_f32_32x32x16_bf16 v[32:47], v[132:135], a[4:7], v[32:47]
    ds_read_b64_tr_b16 a[0:1], v7 offset:24576
    ds_read_b64_tr_b16 a[2:3], v7 offset:24832
    v_exp_f32_e64 v65, v49 clamp
    v_max_f32 v49, s55, v49
    s_add_u32 m0, s37, 20480
    s_add_u32 s48, s52, 0
    v_mfma_f32_32x32x16_bf16 v[32:47], v[136:139], a[8:11], v[32:47]
    buffer_load_dwordx4 v10, s[12:15], s48 offen offset:0 lds
    ds_read_b64_tr_b16 a[4:5], v7 offset:25600
    ds_read_b64_tr_b16 a[6:7], v7 offset:25856
    v_fmac_f32 v64, s54, v48
    v_exp_f32_e64 v66, v50 clamp
    v_mfma_f32_32x32x16_bf16 v[32:47], v[140:143], a[12:15], v[32:47]
    ds_read_b64_tr_b16 a[8:9], v7 offset:26624
    ds_read_b64_tr_b16 a[10:11], v7 offset:26880
    s_waitcnt lgkmcnt(6)
    v_cvt_pk_bf16_f32 v88, v96, v97
    v_cvt_pk_bf16_f32 v89, v98, v99
    v_cvt_pk_bf16_f32 v90, v100, v101
    v_cvt_pk_bf16_f32 v91, v102, v103
    v_mfma_f32_32x32x16_bf16 v[32:47], v[144:147], a[16:19], v[32:47]
    buffer_load_dwordx4 v11, s[12:15], s48 offen offset:1024 lds
    ds_read_b64_tr_b16 a[12:13], v7 offset:27648
    ds_read_b64_tr_b16 a[14:15], v7 offset:27904
    v_cvt_pk_bf16_f32 v92, v104, v105
    v_cvt_pk_bf16_f32 v93, v106, v107
    v_cvt_pk_bf16_f32 v94, v108, v109
    v_cvt_pk_bf16_f32 v95, v110, v111
    v_mfma_f32_32x32x16_bf16 v[32:47], v[148:151], a[20:23], v[32:47]
    ds_read_b64_tr_b16 a[16:17], v7 offset:28672
    ds_read_b64_tr_b16 a[18:19], v7 offset:28928
    v_mfma_f32_32x32x16_bf16 v[96:111], v[72:75], v[88:91], 0
    v_mfma_f32_32x32x16_bf16 v[96:111], v[76:79], v[92:95], v[96:111]
    v_mfma_f32_32x32x16_bf16 v[32:47], v[152:155], a[24:27], v[32:47]
    buffer_load_dwordx4 v12, s[12:15], s48 offen offset:2048 lds
    ds_read_b64_tr_b16 a[20:21], v7 offset:29696
    ds_read_b64_tr_b16 a[22:23], v7 offset:29952
    v_max_f32 v50, s55, v50
    v_fmac_f32 v65, s54, v49
    v_mfma_f32_32x32x16_bf16 v[32:47], v[156:159], a[28:31], v[32:47]
    ds_read_b64_tr_b16 a[24:25], v7 offset:30720
    ds_read_b64_tr_b16 a[26:27], v7 offset:30976
    s_waitcnt lgkmcnt(6)
    v_exp_f32_e64 v67, v51 clamp
    v_max_f32 v51, s55, v51
    v_fmac_f32 v66, s54, v50
    v_mfma_f32_32x32x16_bf16 v[32:47], v[160:163], a[0:3], v[32:47]
    ds_read_b64_tr_b16 a[28:29], v7 offset:31744
    ds_read_b64_tr_b16 a[30:31], v7 offset:32000
    v_cvt_pk_bf16_f32 v80, v64, v65
    v_add_f32 v121, v64, v65
    v_exp_f32_e64 v68, v52 clamp
    v_max_f32 v52, s55, v52
    v_mfma_f32_32x32x16_bf16 v[32:47], v[164:167], a[4:7], v[32:47]
    ds_read_b64_tr_b16 a[0:1], v8 offset:24576
    ds_read_b64_tr_b16 a[2:3], v8 offset:24832
    v_cndmask_b32 v112, v104, v96, s[82:83]
    v_cndmask_b32 v113, v105, v97, s[82:83]
    v_cndmask_b32 v114, v106, v98, s[82:83]
    v_cndmask_b32 v115, v107, v99, s[82:83]
    v_fmac_f32 v67, s54, v51
    v_mfma_f32_32x32x16_bf16 v[32:47], v[168:171], a[8:11], v[32:47]
    ds_write_b128 v122, v[112:115] offset:16384
    ds_read_b64_tr_b16 a[4:5], v8 offset:25600
    ds_read_b64_tr_b16 a[6:7], v8 offset:25856
    v_cndmask_b32 v116, v108, v100, s[82:83]
    v_cndmask_b32 v117, v109, v101, s[82:83]
    v_cndmask_b32 v118, v110, v102, s[82:83]
    v_cndmask_b32 v119, v111, v103, s[82:83]
    v_mfma_f32_32x32x16_bf16 v[32:47], v[172:175], a[12:15], v[32:47]
    ds_write_b128 v122, v[116:119] offset:17408
    buffer_load_dwordx4 v13, s[12:15], s48 offen offset:3072 lds
    ds_read_b64_tr_b16 a[8:9], v8 offset:26624
    s_waitcnt lgkmcnt(11)
    ds_read_b64_tr_b16 a[10:11], v8 offset:26880
    s_waitcnt lgkmcnt(8)
    v_mfma_f32_32x32x16_bf16 v[32:47], v[176:179], a[16:19], v[32:47]
    ds_read_b64_tr_b16 a[12:13], v8 offset:27648
    ds_read_b64_tr_b16 a[14:15], v8 offset:27904
    v_exp_f32_e64 v69, v53 clamp
    v_max_f32 v53, s55, v53
    v_fmac_f32 v68, s54, v52
    s_add_u32 s48, s63, 32768
    v_mfma_f32_32x32x16_bf16 v[32:47], v[180:183], a[20:23], v[32:47]
    buffer_load_dwordx4 a[200:203], v10, s[12:15], s48 offen offset:0
    ds_read_b64_tr_b16 a[16:17], v8 offset:28672
    ds_read_b64_tr_b16 a[18:19], v8 offset:28928
    v_cvt_pk_bf16_f32 v81, v66, v67
    v_add_f32 v121, v121, v66
    v_add_f32 v121, v121, v67
    v_mfma_f32_32x32x16_bf16 v[32:47], v[184:187], a[24:27], v[32:47]
    ds_read_b64_tr_b16 a[20:21], v8 offset:29696
    ds_read_b64_tr_b16 a[22:23], v8 offset:29952
    v_exp_f32_e64 v64, v54 clamp
    v_max_f32 v54, s55, v54
    v_fmac_f32 v69, s54, v53
    v_mfma_f32_32x32x16_bf16 v[32:47], v[188:191], a[28:31], v[32:47]
    buffer_load_dwordx4 a[204:207], v11, s[12:15], s48 offen offset:1024
    ds_read_b64_tr_b16 a[24:25], v8 offset:30720
    s_waitcnt lgkmcnt(11)
    ds_read_b64_tr_b16 a[26:27], v8 offset:30976
    s_waitcnt lgkmcnt(6)
    v_exp_f32_e64 v65, v55 clamp
    v_mfma_f32_32x32x16_bf16 v[32:47], v[192:195], a[0:3], v[32:47]
    ds_read_b64_tr_b16 a[28:29], v8 offset:31744
    ds_read_b64_tr_b16 a[30:31], v8 offset:32000
    v_max_f32 v55, s55, v55
    v_fmac_f32 v64, s54, v54
    v_cvt_pk_bf16_f32 v82, v68, v69
    v_add_f32 v121, v121, v68
    v_add_f32 v121, v121, v69
    v_mfma_f32_32x32x16_bf16 v[32:47], v[196:199], a[4:7], v[32:47]
    buffer_load_dwordx4 a[208:211], v12, s[12:15], s48 offen offset:2048
    ds_read_b64_tr_b16 a[0:1], v9 offset:24576
    ds_read_b64_tr_b16 a[2:3], v9 offset:24832
    v_exp_f32_e64 v66, v56 clamp
    v_max_f32 v56, s55, v56
    v_mfma_f32_32x32x16_bf16 v[32:47], v[200:203], a[8:11], v[32:47]
    ds_read_b64_tr_b16 a[4:5], v9 offset:25600
    ds_read_b64_tr_b16 a[6:7], v9 offset:25856
    v_fmac_f32 v65, s54, v55
    v_exp_f32_e64 v67, v57 clamp
    v_max_f32 v57, s55, v57
    v_fmac_f32 v66, s54, v56
    v_mfma_f32_32x32x16_bf16 v[32:47], v[204:207], a[12:15], v[32:47]
    buffer_load_dwordx4 a[212:215], v13, s[12:15], s48 offen offset:3072
    ds_read_b64_tr_b16 a[8:9], v9 offset:26624
    ds_read_b64_tr_b16 a[10:11], v9 offset:26880
    s_waitcnt lgkmcnt(6)
    v_cvt_pk_bf16_f32 v83, v64, v65
    v_add_f32 v121, v121, v64
    v_mfma_f32_32x32x16_bf16 v[32:47], v[208:211], a[16:19], v[32:47]
    ds_read_b64_tr_b16 a[12:13], v9 offset:27648
    ds_read_b64_tr_b16 a[14:15], v9 offset:27904
    v_add_f32 v121, v121, v65
    v_exp_f32_e64 v68, v58 clamp
    s_add_u32 s48, s61, 0
    v_mfma_f32_32x32x16_bf16 v[32:47], v[212:215], a[20:23], v[32:47]
    buffer_load_dwordx4 a[216:219], v10, s[16:19], s48 offen offset:0
    ds_read_b64_tr_b16 a[16:17], v9 offset:28672
    ds_read_b64_tr_b16 a[18:19], v9 offset:28928
    v_max_f32 v58, s55, v58
    v_fmac_f32 v67, s54, v57
    v_mfma_f32_32x32x16_bf16 v[32:47], v[216:219], a[24:27], v[32:47]
    ds_read_b64_tr_b16 a[20:21], v9 offset:29696
    ds_read_b64_tr_b16 a[22:23], v9 offset:29952
    v_exp_f32_e64 v69, v59 clamp
    v_max_f32 v59, s55, v59
    v_fmac_f32 v68, s54, v58
    v_mfma_f32_32x32x16_bf16 v[32:47], v[220:223], a[28:31], v[32:47]
    ds_read_b64_tr_b16 a[24:25], v9 offset:30720
    ds_read_b64_tr_b16 a[26:27], v9 offset:30976
    s_waitcnt lgkmcnt(6)
    v_cvt_pk_bf16_f32 v84, v66, v67
    v_add_f32 v121, v121, v66
    v_add_f32 v121, v121, v67
    v_mfma_f32_32x32x16_bf16 v[32:47], v[224:227], a[0:3], v[32:47]
    ds_read_b64_tr_b16 a[28:29], v9 offset:31744
    ds_read_b64_tr_b16 a[30:31], v9 offset:32000
    v_exp_f32_e64 v64, v60 clamp
    v_max_f32 v60, s55, v60
    v_fmac_f32 v69, s54, v59
    v_mfma_f32_32x32x16_bf16 v[32:47], v[228:231], a[4:7], v[32:47]
    v_exp_f32_e64 v65, v61 clamp
    v_max_f32 v61, s55, v61
    v_fmac_f32 v64, s54, v60
    v_cvt_pk_bf16_f32 v85, v68, v69
    v_add_f32 v121, v121, v68
    v_mfma_f32_32x32x16_bf16 v[32:47], v[232:235], a[8:11], v[32:47]
    buffer_load_dwordx4 a[220:223], v11, s[16:19], s48 offen offset:1024
    v_add_f32 v121, v121, v69
    v_exp_f32_e64 v66, v62 clamp
    v_max_f32 v62, s55, v62
    v_mfma_f32_32x32x16_bf16 v[32:47], v[236:239], a[12:15], v[32:47]
    s_waitcnt lgkmcnt(0)
    v_fmac_f32 v65, s54, v61
    v_exp_f32_e64 v67, v63 clamp
    s_waitcnt vmcnt(10)
    s_barrier
    v_mfma_f32_32x32x16_bf16 v[32:47], v[240:243], a[16:19], v[32:47]
    buffer_load_dwordx4 a[224:227], v12, s[16:19], s48 offen offset:2048
    ds_read_b64_tr_b16 a[0:1], v6 offset:0
    ds_read_b64_tr_b16 a[2:3], v6 offset:256
    ds_read_b64_tr_b16 a[4:5], v6 offset:1024
    ds_read_b64_tr_b16 a[6:7], v6 offset:1280
    ds_read_b64_tr_b16 a[8:9], v6 offset:2048
    ds_read_b64_tr_b16 a[10:11], v6 offset:2304
    ds_read_b64_tr_b16 a[12:13], v6 offset:3072
    ds_read_b64_tr_b16 a[14:15], v6 offset:3328
    v_mfma_f32_32x32x16_bf16 v[32:47], v[244:247], a[20:23], v[32:47]
    ds_read_b64_tr_b16 a[16:17], v6 offset:4096
    ds_read_b64_tr_b16 a[18:19], v6 offset:4352
    v_max_f32 v63, s55, v63
    v_fmac_f32 v66, s54, v62
    v_cvt_pk_bf16_f32 v86, v64, v65
    v_add_f32 v121, v121, v64
    v_mfma_f32_32x32x16_bf16 v[32:47], v[248:251], a[24:27], v[32:47]
    buffer_load_dwordx4 a[228:231], v13, s[16:19], s48 offen offset:3072
    ds_read_b64_tr_b16 a[20:21], v6 offset:5120
    ds_read_b64_tr_b16 a[22:23], v6 offset:5376
    v_add_f32 v121, v121, v65
    v_fmac_f32 v67, s54, v63
    v_mfma_f32_32x32x16_bf16 v[32:47], v[252:255], a[28:31], v[32:47]
    ds_read_b64_tr_b16 a[24:25], v6 offset:6144
    ds_read_b64_tr_b16 a[26:27], v6 offset:6400
    s_waitcnt lgkmcnt(6)
    v_cvt_pk_bf16_f32 v87, v66, v67
    v_add_f32 v121, v121, v66
    v_add_f32 v121, v121, v67
    v_mfma_f32_32x32x16_bf16 v[48:63], a[0:3], v[128:131], 0
    ds_read_b64_tr_b16 a[28:29], v6 offset:7168
    ds_read_b64_tr_b16 a[30:31], v6 offset:7424
    s_add_u32 m0, s37, 24576
    s_add_u32 s48, s52, 32768
    v_mfma_f32_32x32x16_bf16 v[48:63], a[4:7], v[132:135], v[48:63]
    buffer_load_dwordx4 v10, s[12:15], s48 offen offset:0 lds
    ds_read_b64_tr_b16 a[0:1], v7 offset:0
    ds_read_b64_tr_b16 a[2:3], v7 offset:256
    v_permlane32_swap_b32 v120, v121
    v_add_u32 v29, 81920, v123
    v_mfma_f32_32x32x16_bf16 v[48:63], a[8:11], v[136:139], v[48:63]
    ds_read_b64_tr_b16 a[4:5], v7 offset:1024
    ds_read_b64_tr_b16 a[6:7], v7 offset:1280
    v_mfma_f32_32x32x16_bf16 v[48:63], a[12:15], v[140:143], v[48:63]
    buffer_load_dwordx4 v11, s[12:15], s48 offen offset:1024 lds
    ds_read_b64_tr_b16 a[8:9], v7 offset:2048
    ds_read_b64_tr_b16 a[10:11], v7 offset:2304
    s_waitcnt lgkmcnt(6)
    v_cvt_pk_bf16_f32 v88, v32, v33
    v_cvt_pk_bf16_f32 v89, v34, v35
    v_cvt_pk_bf16_f32 v90, v36, v37
    v_cvt_pk_bf16_f32 v91, v38, v39
    v_mfma_f32_32x32x16_bf16 v[48:63], a[16:19], v[144:147], v[48:63]
    ds_read_b64_tr_b16 a[12:13], v7 offset:3072
    ds_read_b64_tr_b16 a[14:15], v7 offset:3328
    v_cvt_pk_bf16_f32 v92, v40, v41
    v_cvt_pk_bf16_f32 v93, v42, v43
    v_cvt_pk_bf16_f32 v94, v44, v45
    v_cvt_pk_bf16_f32 v95, v46, v47
    v_mfma_f32_32x32x16_bf16 v[48:63], a[20:23], v[148:151], v[48:63]
    buffer_load_dwordx4 v12, s[12:15], s48 offen offset:2048 lds
    ds_read_b64_tr_b16 a[16:17], v7 offset:4096
    ds_read_b64_tr_b16 a[18:19], v7 offset:4352
    v_mfma_f32_32x32x16_bf16 v[96:111], v[80:83], v[88:91], 0
    v_mfma_f32_32x32x16_bf16 v[96:111], v[84:87], v[92:95], v[96:111]
    v_mfma_f32_32x32x16_bf16 v[48:63], a[24:27], v[152:155], v[48:63]
    ds_read_b64_tr_b16 a[20:21], v7 offset:5120
    ds_read_b64_tr_b16 a[22:23], v7 offset:5376
    v_mfma_f32_32x32x16_bf16 v[48:63], a[28:31], v[156:159], v[48:63]
    buffer_load_dwordx4 v13, s[12:15], s48 offen offset:3072 lds
    ds_read_b64_tr_b16 a[24:25], v7 offset:6144
    ds_read_b64_tr_b16 a[26:27], v7 offset:6400
    s_waitcnt lgkmcnt(6)
    v_mfma_f32_32x32x16_bf16 v[48:63], a[0:3], v[160:163], v[48:63]
    ds_read_b64_tr_b16 a[28:29], v7 offset:7168
    ds_read_b64_tr_b16 a[30:31], v7 offset:7424
    v_mfma_f32_32x32x16_bf16 v[48:63], a[4:7], v[164:167], v[48:63]
    ds_read_b64_tr_b16 a[0:1], v8 offset:0
    ds_read_b64_tr_b16 a[2:3], v8 offset:256
    v_cndmask_b32 v112, v104, v96, s[82:83]
    v_cndmask_b32 v113, v105, v97, s[82:83]
    v_cndmask_b32 v114, v106, v98, s[82:83]
    v_cndmask_b32 v115, v107, v99, s[82:83]
    v_mfma_f32_32x32x16_bf16 v[48:63], a[8:11], v[168:171], v[48:63]
    ds_write_b128 v122, v[112:115] offset:18432
    ds_read_b64_tr_b16 a[4:5], v8 offset:1024
    ds_read_b64_tr_b16 a[6:7], v8 offset:1280
    v_cndmask_b32 v116, v108, v100, s[82:83]
    v_cndmask_b32 v117, v109, v101, s[82:83]
    v_cndmask_b32 v118, v110, v102, s[82:83]
    v_cndmask_b32 v119, v111, v103, s[82:83]
    v_mfma_f32_32x32x16_bf16 v[48:63], a[12:15], v[172:175], v[48:63]
    ds_write_b128 v122, v[116:119] offset:19456
    ds_read_b64_tr_b16 a[8:9], v8 offset:2048
    s_waitcnt lgkmcnt(11)
    ds_read_b64_tr_b16 a[10:11], v8 offset:2304
    s_waitcnt lgkmcnt(8)
    s_add_u32 m0, s37, 28672
    s_add_u32 s48, s59, 0
    v_mfma_f32_32x32x16_bf16 v[48:63], a[16:19], v[176:179], v[48:63]
    buffer_load_dwordx4 v10, s[12:15], s48 offen offset:0 lds
    ds_read_b64_tr_b16 a[12:13], v8 offset:3072
    ds_read_b64_tr_b16 a[14:15], v8 offset:3328
    v_add_f32 v90, v120, v121
    v_mov_b32 v91, v22
    v_mfma_f32_32x32x16_bf16 v[48:63], a[20:23], v[180:183], v[48:63]
    ds_read_b64_tr_b16 a[16:17], v8 offset:4096
    ds_read_b64_tr_b16 a[18:19], v8 offset:4352
    s_waitcnt vmcnt(13) lgkmcnt(6)
    s_barrier
    v_mfma_f32_32x32x16_bf16 v[48:63], a[24:27], v[184:187], v[48:63]
    ds_read_b128 v[96:99], v123 offset:16384
    ds_read_b128 v[100:103], v123 offset:57344
    ds_read_b128 v[104:107], v29 offset:16384
    ds_read_b128 v[108:111], v29 offset:57344
    buffer_load_dwordx4 v11, s[12:15], s48 offen offset:1024 lds
    ds_read_b64_tr_b16 a[20:21], v8 offset:5120
    ds_read_b64_tr_b16 a[22:23], v8 offset:5376
    v_mfma_f32_32x32x16_bf16 v[48:63], a[28:31], v[188:191], v[48:63]
    s_mov_b32 s51, 65536
    buffer_load_dword v30, v3, s[20:23], s51 offen sc1
    ds_read_b64_tr_b16 a[24:25], v8 offset:6144
    ds_read_b64_tr_b16 a[26:27], v8 offset:6400
    s_waitcnt lgkmcnt(10)
    v_mfma_f32_32x32x16_bf16 v[48:63], a[0:3], v[192:195], v[48:63]
    buffer_load_dwordx4 v12, s[12:15], s48 offen offset:2048 lds
    ds_read_b64_tr_b16 a[28:29], v8 offset:7168
    ds_read_b64_tr_b16 a[30:31], v8 offset:7424
    s_waitcnt lgkmcnt(6)
    v_add_f32 v96, v96, v100
    v_add_f32 v97, v97, v101
    v_add_f32 v98, v98, v102
    v_add_f32 v99, v99, v103
    v_mfma_f32_32x32x16_bf16 v[48:63], a[4:7], v[196:199], v[48:63]
    ds_read_b64_tr_b16 a[0:1], v9 offset:0
    ds_read_b64_tr_b16 a[2:3], v9 offset:256
    v_add_f32 v104, v104, v108
    v_add_f32 v105, v105, v109
    v_add_f32 v106, v106, v110
    v_add_f32 v107, v107, v111
    v_mfma_f32_32x32x16_bf16 v[48:63], a[8:11], v[200:203], v[48:63]
    buffer_load_dwordx4 v13, s[12:15], s48 offen offset:3072 lds
    ds_read_b64_tr_b16 a[4:5], v9 offset:1024
    ds_read_b64_tr_b16 a[6:7], v9 offset:1280
    v_add_f32 v96, v96, v104
    v_add_f32 v97, v97, v105
    v_add_f32 v98, v98, v106
    v_add_f32 v99, v99, v107
    v_cvt_pk_bf16_f32 v88, v96, v97
    v_cvt_pk_bf16_f32 v89, v98, v99
    v_mfma_f32_32x32x16_bf16 v[48:63], a[12:15], v[204:207], v[48:63]
    buffer_store_dwordx4 v[88:91], v2, s[20:23], s57 offen sc1
    ds_read_b64_tr_b16 a[8:9], v9 offset:2048
    ds_read_b64_tr_b16 a[10:11], v9 offset:2304
    s_waitcnt lgkmcnt(6)
    v_mfma_f32_32x32x16_bf16 v[48:63], a[16:19], v[208:211], v[48:63]
    ds_read_b64_tr_b16 a[12:13], v9 offset:3072
    ds_read_b64_tr_b16 a[14:15], v9 offset:3328
    s_lshr_b32 s50, s3, 1
    s_lshl_b32 s50, s50, 10
    s_and_b32 s49, s3, 1
    s_lshl3_add_u32 s50, s49, s50
    v_mfma_f32_32x32x16_bf16 v[48:63], a[20:23], v[212:215], v[48:63]
    ds_read_b64_tr_b16 a[16:17], v9 offset:4096
    ds_read_b64_tr_b16 a[18:19], v9 offset:4352
    v_add_u32 v124, s50, v2
    v_bfe_u32 v126, v1, 2, 1
    v_lshlrev_b32 v126, 4, v126
    v_bfe_u32 v127, v1, 3, 1
    v_mfma_f32_32x32x16_bf16 v[48:63], a[24:27], v[216:219], v[48:63]
    ds_read_b64_tr_b16 a[20:21], v9 offset:5120
    ds_read_b64_tr_b16 a[22:23], v9 offset:5376
    v_lshl_add_u32 v126, v127, 3, v126
    v_bfe_u32 v127, v1, 4, 1
    v_lshl_add_u32 v126, v127, 7, v126
    v_lshrrev_b32 v27, 5, v1
    v_mfma_f32_32x32x16_bf16 v[48:63], a[28:31], v[220:223], v[48:63]
    ds_read_b64_tr_b16 a[24:25], v9 offset:6144
    ds_read_b64_tr_b16 a[26:27], v9 offset:6400
    s_waitcnt lgkmcnt(6)
    v_lshl_add_u32 v126, v27, 10, v126
    v_and_b32 v127, 3, v1
    v_lshl_add_u32 v126, v127, 1, v126
    v_mfma_f32_32x32x16_bf16 v[48:63], a[0:3], v[224:227], v[48:63]
    ds_read_b64_tr_b16 a[28:29], v9 offset:7168
    ds_read_b64_tr_b16 a[30:31], v9 offset:7424
    s_lshl_b32 s49, s3, 5
    v_add_u32 v125, s49, v126
    v_lshlrev_b32 v126, 4, v27
    s_add_u32 s48, s61, 32768
    v_mfma_f32_32x32x16_bf16 v[48:63], a[4:7], v[228:231], v[48:63]
    buffer_load_dwordx4 a[232:235], v10, s[16:19], s48 offen offset:0
    ds_read_b64_tr_b16 a[0:1], v6 offset:8192
    ds_read_b64_tr_b16 a[2:3], v6 offset:8448
    v_lshl_add_u32 v126, v127, 5, v126
    v_add_u32 v126, 2048, v126
    v_mfma_f32_32x32x16_bf16 v[48:63], a[8:11], v[232:235], v[48:63]
    ds_read_b64_tr_b16 a[4:5], v6 offset:9216
    ds_read_b64_tr_b16 a[6:7], v6 offset:9472
    v_add_u32 v127, 128, v126
    v_cndmask_b32 v126, v126, v2, s[82:83]
    v_cndmask_b32 v127, v2, v127, s[82:83]
    v_and_b32 v27, 1, v1
    v_mfma_f32_32x32x16_bf16 v[48:63], a[12:15], v[236:239], v[48:63]
    ds_read_b64_tr_b16 a[8:9], v6 offset:10240
    ds_read_b64_tr_b16 a[10:11], v6 offset:10496
    s_waitcnt lgkmcnt(6)
    v_lshlrev_b32 v27, 4, v27
    v_mov_b32 v28, 0x3f80
    v_lshlrev_b32 v27, v27, v28
    v_mfma_f32_32x32x16_bf16 v[48:63], a[16:19], v[240:243], v[48:63]
    ds_read_b64_tr_b16 a[12:13], v6 offset:11264
    ds_read_b64_tr_b16 a[14:15], v6 offset:11520
    s_mov_b32 s82, 0x00300003
    s_mov_b32 s83, 0x30000300
    v_cndmask_b32 v92, 0, v27, s[82:83]
    s_lshl_b64 s[82:83], s[82:83], 2
    v_mfma_f32_32x32x16_bf16 v[48:63], a[20:23], v[244:247], v[48:63]
    ds_read_b64_tr_b16 a[16:17], v6 offset:12288
    ds_read_b64_tr_b16 a[18:19], v6 offset:12544
    v_cndmask_b32 v93, 0, v27, s[82:83]
    v_mfma_f32_32x32x16_bf16 v[48:63], a[24:27], v[248:251], v[48:63]
    buffer_load_dwordx4 a[236:239], v11, s[16:19], s48 offen offset:1024
    ds_read_b64_tr_b16 a[20:21], v6 offset:13312
    ds_read_b64_tr_b16 a[22:23], v6 offset:13568
    v_mfma_f32_32x32x16_bf16 v[48:63], a[28:31], v[252:255], v[48:63]
    ds_read_b64_tr_b16 a[24:25], v6 offset:14336
    ds_read_b64_tr_b16 a[26:27], v6 offset:14592
    s_waitcnt lgkmcnt(6)
    v_mfma_f32_32x32x16_bf16 v[32:47], a[0:3], v[128:131], 0
    buffer_load_dwordx4 a[240:243], v12, s[16:19], s48 offen offset:2048
    ds_read_b64_tr_b16 a[28:29], v6 offset:15360
    ds_read_b64_tr_b16 a[30:31], v6 offset:15616
    v_mfma_f32_32x32x16_bf16 v[32:47], a[4:7], v[132:135], v[32:47]
    ds_read_b64_tr_b16 a[0:1], v7 offset:8192
    ds_read_b64_tr_b16 a[2:3], v7 offset:8448
    v_mfma_f32_32x32x16_bf16 v[32:47], a[8:11], v[136:139], v[32:47]
    buffer_load_dwordx4 a[244:247], v13, s[16:19], s48 offen offset:3072
    ds_read_b64_tr_b16 a[4:5], v7 offset:9216
    ds_read_b64_tr_b16 a[6:7], v7 offset:9472
    v_mov_b32 v128, v21
    v_xor_b32 v129, 64, v21
    v_add_u32 v130, 40960, v128
    v_add_u32 v131, 40960, v129
    v_mfma_f32_32x32x16_bf16 v[32:47], a[12:15], v[140:143], v[32:47]
    ds_read_b64_tr_b16 a[8:9], v7 offset:10240
    ds_read_b64_tr_b16 a[10:11], v7 offset:10496
    s_waitcnt lgkmcnt(6)
    v_add_u32 v132, 81920, v128
    v_add_u32 v133, 81920, v129
    v_add_u32 v134, 122880, v128
    s_waitcnt vmcnt(7)
    v_cmp_ne_u32 vcc, s38, v30
    v_mfma_f32_32x32x16_bf16 v[32:47], a[16:19], v[144:147], v[32:47]
    s_cbranch_vccnz L_spin24
L_ok24:
    buffer_load_dwordx4 a[32:35], v2, s[20:23], s28 offen offset:0 sc1
    ds_read_b64_tr_b16 a[12:13], v7 offset:11264
    ds_read_b64_tr_b16 a[14:15], v7 offset:11520
    v_add_u32 v135, 122880, v129
    v_mfma_f32_32x32x16_bf16 v[32:47], a[20:23], v[148:151], v[32:47]
    ds_read_b64_tr_b16 a[16:17], v7 offset:12288
    ds_read_b64_tr_b16 a[18:19], v7 offset:12544
    v_exp_f32_e64 v64, v48 clamp
    v_max_f32 v48, s55, v48
    v_exp_f32_e64 v65, v49 clamp
    v_mfma_f32_32x32x16_bf16 v[32:47], a[24:27], v[152:155], v[32:47]
    buffer_load_dwordx4 a[36:39], v2, s[20:23], s28 offen offset:1024 sc1
    ds_read_b64_tr_b16 a[20:21], v7 offset:13312
    ds_read_b64_tr_b16 a[22:23], v7 offset:13568
    v_max_f32 v49, s55, v49
    v_fmac_f32 v64, s54, v48
    v_mfma_f32_32x32x16_bf16 v[32:47], a[28:31], v[156:159], v[32:47]
    ds_read_b64_tr_b16 a[24:25], v7 offset:14336
    ds_read_b64_tr_b16 a[26:27], v7 offset:14592
    s_waitcnt lgkmcnt(6)
    v_exp_f32_e64 v66, v50 clamp
    v_max_f32 v50, s55, v50
    v_fmac_f32 v65, s54, v49
    v_mfma_f32_32x32x16_bf16 v[32:47], a[0:3], v[160:163], v[32:47]
    buffer_load_dwordx4 a[40:43], v2, s[20:23], s29 offen offset:0 sc1
    ds_read_b64_tr_b16 a[28:29], v7 offset:15360
    ds_read_b64_tr_b16 a[30:31], v7 offset:15616
    v_exp_f32_e64 v67, v51 clamp
    v_max_f32 v51, s55, v51
    v_mfma_f32_32x32x16_bf16 v[32:47], a[4:7], v[164:167], v[32:47]
    ds_read_b64_tr_b16 a[0:1], v8 offset:8192
    ds_read_b64_tr_b16 a[2:3], v8 offset:8448
    v_fmac_f32 v66, s54, v50
    v_cvt_pk_bf16_f32 v72, v64, v65
    v_exp_f32_e64 v68, v52 clamp
    v_mfma_f32_32x32x16_bf16 v[32:47], a[8:11], v[168:171], v[32:47]
    buffer_load_dwordx4 a[44:47], v2, s[20:23], s29 offen offset:1024 sc1
    ds_read_b64_tr_b16 a[4:5], v8 offset:9216
    ds_read_b64_tr_b16 a[6:7], v8 offset:9472
    v_max_f32 v52, s55, v52
    v_fmac_f32 v67, s54, v51
    v_mfma_f32_32x32x16_bf16 v[32:47], a[12:15], v[172:175], v[32:47]
    ds_read_b64_tr_b16 a[8:9], v8 offset:10240
    ds_read_b64_tr_b16 a[10:11], v8 offset:10496
    s_waitcnt lgkmcnt(6)
    v_exp_f32_e64 v69, v53 clamp
    v_max_f32 v53, s55, v53
    v_fmac_f32 v68, s54, v52
    v_mfma_f32_32x32x16_bf16 v[32:47], a[16:19], v[176:179], v[32:47]
    ds_read_b64_tr_b16 a[12:13], v8 offset:11264
    ds_read_b64_tr_b16 a[14:15], v8 offset:11520
    v_cvt_pk_bf16_f32 v73, v66, v67
    v_exp_f32_e64 v64, v54 clamp
    v_max_f32 v54, s55, v54
    v_mfma_f32_32x32x16_bf16 v[32:47], a[20:23], v[180:183], v[32:47]
    ds_read_b64_tr_b16 a[16:17], v8 offset:12288
    ds_read_b64_tr_b16 a[18:19], v8 offset:12544
    v_fmac_f32 v69, s54, v53
    v_exp_f32_e64 v65, v55 clamp
    v_max_f32 v55, s55, v55
    v_mfma_f32_32x32x16_bf16 v[32:47], a[24:27], v[184:187], v[32:47]
    buffer_load_dwordx4 a[48:51], v2, s[20:23], s30 offen offset:0 sc1
    ds_read_b64_tr_b16 a[20:21], v8 offset:13312
    ds_read_b64_tr_b16 a[22:23], v8 offset:13568
    v_fmac_f32 v64, s54, v54
    v_cvt_pk_bf16_f32 v74, v68, v69
    v_mfma_f32_32x32x16_bf16 v[32:47], a[28:31], v[188:191], v[32:47]
    ds_read_b64_tr_b16 a[24:25], v8 offset:14336
    ds_read_b64_tr_b16 a[26:27], v8 offset:14592
    s_waitcnt lgkmcnt(6)
    v_exp_f32_e64 v66, v56 clamp
    v_max_f32 v56, s55, v56
    v_fmac_f32 v65, s54, v55
    v_mfma_f32_32x32x16_bf16 v[32:47], a[0:3], v[192:195], v[32:47]
    buffer_load_dwordx4 a[52:55], v2, s[20:23], s30 offen offset:1024 sc1
    ds_read_b64_tr_b16 a[28:29], v8 offset:15360
    ds_read_b64_tr_b16 a[30:31], v8 offset:15616
    v_exp_f32_e64 v67, v57 clamp
    v_max_f32 v57, s55, v57
    v_mfma_f32_32x32x16_bf16 v[32:47], a[4:7], v[196:199], v[32:47]
    ds_read_b64_tr_b16 a[0:1], v9 offset:8192
    ds_read_b64_tr_b16 a[2:3], v9 offset:8448
    v_fmac_f32 v66, s54, v56
    v_cvt_pk_bf16_f32 v75, v64, v65
    v_exp_f32_e64 v68, v58 clamp
    v_mfma_f32_32x32x16_bf16 v[32:47], a[8:11], v[200:203], v[32:47]
    buffer_load_dwordx4 a[56:59], v2, s[20:23], s31 offen offset:0 sc1
    ds_read_b64_tr_b16 a[4:5], v9 offset:9216
    ds_read_b64_tr_b16 a[6:7], v9 offset:9472
    v_max_f32 v58, s55, v58
    v_fmac_f32 v67, s54, v57
    v_mfma_f32_32x32x16_bf16 v[32:47], a[12:15], v[204:207], v[32:47]
    ds_read_b64_tr_b16 a[8:9], v9 offset:10240
    ds_read_b64_tr_b16 a[10:11], v9 offset:10496
    s_waitcnt lgkmcnt(6)
    v_exp_f32_e64 v69, v59 clamp
    v_max_f32 v59, s55, v59
    v_mfma_f32_32x32x16_bf16 v[32:47], a[16:19], v[208:211], v[32:47]
    buffer_load_dwordx4 a[60:63], v2, s[20:23], s31 offen offset:1024 sc1
    ds_read_b64_tr_b16 a[12:13], v9 offset:11264
    ds_read_b64_tr_b16 a[14:15], v9 offset:11520
    v_fmac_f32 v68, s54, v58
    v_cvt_pk_bf16_f32 v76, v66, v67
    v_mfma_f32_32x32x16_bf16 v[32:47], a[20:23], v[212:215], v[32:47]
    ds_read_b64_tr_b16 a[16:17], v9 offset:12288
    ds_read_b64_tr_b16 a[18:19], v9 offset:12544
    v_exp_f32_e64 v64, v60 clamp
    v_max_f32 v60, s55, v60
    v_fmac_f32 v69, s54, v59
    v_mfma_f32_32x32x16_bf16 v[32:47], a[24:27], v[216:219], v[32:47]
    buffer_load_dwordx4 v[144:147], v2, s[20:23], s84 offen offset:0 sc1
    ds_read_b64_tr_b16 a[20:21], v9 offset:13312
    ds_read_b64_tr_b16 a[22:23], v9 offset:13568
    v_exp_f32_e64 v65, v61 clamp
    v_mfma_f32_32x32x16_bf16 v[32:47], a[28:31], v[220:223], v[32:47]
    ds_read_b64_tr_b16 a[24:25], v9 offset:14336
    ds_read_b64_tr_b16 a[26:27], v9 offset:14592
    s_waitcnt lgkmcnt(6)
    v_max_f32 v61, s55, v61
    v_fmac_f32 v64, s54, v60
    v_cvt_pk_bf16_f32 v77, v68, v69
    v_mfma_f32_32x32x16_bf16 v[32:47], a[0:3], v[224:227], v[32:47]
    buffer_load_dwordx4 v[148:151], v2, s[20:23], s84 offen offset:1024 sc1
    ds_read_b64_tr_b16 a[28:29], v9 offset:15360
    ds_read_b64_tr_b16 a[30:31], v9 offset:15616
    v_exp_f32_e64 v66, v62 clamp
    v_mfma_f32_32x32x16_bf16 v[32:47], a[4:7], v[228:231], v[32:47]
    buffer_load_dwordx4 v[152:155], v2, s[20:23], s84 offen offset:2048 sc1
    ds_read_b64_tr_b16 a[0:1], v129 offset:32768
    ds_read_b64_tr_b16 a[2:3], v129 offset:33792
    v_max_f32 v62, s55, v62
    v_fmac_f32 v65, s54, v61
    v_mfma_f32_32x32x16_bf16 v[32:47], a[8:11], v[232:235], v[32:47]
    ds_read_b64_tr_b16 a[4:5], v128 offset:32768
    ds_read_b64_tr_b16 a[6:7], v128 offset:33792
    v_exp_f32_e64 v67, v63 clamp
    v_max_f32 v63, s55, v63
    v_fmac_f32 v66, s54, v62
    v_mfma_f32_32x32x16_bf16 v[32:47], a[12:15], v[236:239], v[32:47]
    buffer_load_dwordx4 v[156:159], v2, s[20:23], s84 offen offset:3072 sc1
    ds_read_b64_tr_b16 a[8:9], v129 offset:34816
    ds_read_b64_tr_b16 a[10:11], v129 offset:35840
    s_waitcnt lgkmcnt(6)
    s_waitcnt vmcnt(12)
    s_barrier
    v_mfma_f32_32x32x16_bf16 v[32:47], a[16:19], v[240:243], v[32:47]
    ds_read_b64_tr_b16 a[12:13], v128 offset:34816
    ds_read_b64_tr_b16 a[14:15], v128 offset:35840
    v_cvt_pk_bf16_f32 v78, v64, v65
    v_fmac_f32 v67, s54, v63
    v_cvt_pk_bf16_f32 v79, v66, v67
    v_mfma_f32_32x32x16_bf16 v[32:47], a[20:23], v[244:247], v[32:47]
    ds_write_b64 v122, a[184:185] offset:0
    ds_write_b64 v122, a[186:187] offset:8
    ds_read_b64_tr_b16 a[16:17], v131 offset:32768
    ds_read_b64_tr_b16 a[18:19], v131 offset:33792
    v_mfma_f32_32x32x16_bf16 v[32:47], a[24:27], v[248:251], v[32:47]
    buffer_load_dwordx4 v[160:163], v2, s[20:23], s85 offen offset:0 sc1
    ds_write_b64 v122, a[188:189] offset:1024
    ds_write_b64 v122, a[190:191] offset:1032
    ds_read_b64_tr_b16 a[20:21], v130 offset:32768
    s_waitcnt lgkmcnt(11)
    ds_read_b64_tr_b16 a[22:23], v130 offset:33792
    v_mfma_f32_32x32x16_bf16 v[32:47], a[28:31], v[252:255], v[32:47]
    buffer_load_dwordx4 v[164:167], v2, s[20:23], s85 offen offset:1024 sc1
    ds_write_b64 v122, a[192:193] offset:2048
    ds_write_b64 v122, a[194:195] offset:2056
    ds_read_b64_tr_b16 a[24:25], v131 offset:34816
    s_waitcnt lgkmcnt(11)
    ds_read_b64_tr_b16 a[26:27], v131 offset:35840
    s_waitcnt vmcnt(12)
    v_mfma_f32_32x32x16_bf16 v[224:239], a[0:3], a[32:35], 0
    buffer_load_dwordx4 v[168:171], v2, s[20:23], s85 offen offset:2048 sc1
    ds_write_b64 v122, a[196:197] offset:3072
    ds_read_b64_tr_b16 a[28:29], v130 offset:34816
    ds_read_b64_tr_b16 a[30:31], v130 offset:35840
    v_mfma_f32_32x32x16_bf16 v[240:255], a[4:7], a[32:35], 0
    buffer_load_dwordx4 v[172:175], v2, s[20:23], s85 offen offset:3072 sc1
    s_mov_b32 s51, 131072
    buffer_load_dword v31, v26, s[20:23], s51 offen sc1
    s_waitcnt lgkmcnt(11)
    ds_write_b64 v122, a[198:199] offset:3080
    ds_write_b64 v122, a[200:201] offset:4096
    ds_read_b64_tr_b16 a[0:1], v133 offset:32768
    ds_read_b64_tr_b16 a[2:3], v133 offset:33792
    v_mfma_f32_32x32x16_bf16 v[224:239], a[8:11], a[36:39], v[224:239]
    buffer_load_dwordx4 v[176:179], v2, s[20:23], s86 offen offset:0 sc1
    s_waitcnt lgkmcnt(11)
    ds_write_b64 v122, a[202:203] offset:4104
    ds_write_b64 v122, a[204:205] offset:5120
    ds_read_b64_tr_b16 a[4:5], v132 offset:32768
    ds_read_b64_tr_b16 a[6:7], v132 offset:33792
    v_mfma_f32_32x32x16_bf16 v[240:255], a[12:15], a[36:39], v[240:255]
    buffer_load_dwordx4 v[180:183], v2, s[20:23], s86 offen offset:1024 sc1
    s_waitcnt lgkmcnt(11)
    ds_write_b64 v122, a[206:207] offset:5128
    ds_read_b64_tr_b16 a[8:9], v133 offset:34816
    ds_read_b64_tr_b16 a[10:11], v133 offset:35840
    s_waitcnt lgkmcnt(11)
    v_exp_f32_e64 v64, v32 clamp
    v_max_f32 v32, s55, v32
    v_exp_f32_e64 v65, v33 clamp
    v_max_f32 v33, s55, v33
    v_fmac_f32 v64, s54, v32
    v_exp_f32_e64 v66, v34 clamp
    v_max_f32 v34, s55, v34
    v_fmac_f32 v65, s54, v33
    v_exp_f32_e64 v67, v35 clamp
    v_max_f32 v35, s55, v35
    v_fmac_f32 v66, s54, v34
    v_cvt_pk_bf16_f32 v80, v64, v65
    s_waitcnt vmcnt(15)
    v_mfma_f32_32x32x16_bf16 v[224:239], a[16:19], a[40:43], v[224:239]
    buffer_load_dwordx4 v[184:187], v2, s[20:23], s86 offen offset:2048 sc1
    ds_write_b64 v122, a[208:209] offset:6144
    ds_write_b64 v122, a[210:211] offset:6152
    ds_read_b64_tr_b16 a[12:13], v132 offset:34816
    ds_read_b64_tr_b16 a[14:15], v132 offset:35840
    v_exp_f32_e64 v68, v36 clamp
    v_max_f32 v36, s55, v36
    v_fmac_f32 v67, s54, v35
    v_exp_f32_e64 v69, v37 clamp
    v_max_f32 v37, s55, v37
    v_fmac_f32 v68, s54, v36
    v_cvt_pk_bf16_f32 v81, v66, v67
    v_exp_f32_e64 v64, v38 clamp
    v_mfma_f32_32x32x16_bf16 v[240:255], a[20:23], a[40:43], v[240:255]
    buffer_load_dwordx4 v[188:191], v2, s[20:23], s86 offen offset:3072 sc1
    s_waitcnt lgkmcnt(11)
    ds_write_b64 v122, a[212:213] offset:7168
    ds_write_b64 v122, a[214:215] offset:7176
    ds_read_b64_tr_b16 a[16:17], v135 offset:32768
    ds_read_b64_tr_b16 a[18:19], v135 offset:33792
    v_max_f32 v38, s55, v38
    v_fmac_f32 v69, s54, v37
    v_exp_f32_e64 v65, v39 clamp
    v_max_f32 v39, s55, v39
    v_fmac_f32 v64, s54, v38
    v_cvt_pk_bf16_f32 v82, v68, v69
    v_exp_f32_e64 v66, v40 clamp
    v_max_f32 v40, s55, v40
    v_fmac_f32 v65, s54, v39
    v_mfma_f32_32x32x16_bf16 v[224:239], a[24:27], a[44:47], v[224:239]
    buffer_load_dwordx4 v[192:195], v2, s[20:23], s87 offen offset:0 sc1
    s_mov_b32 s51, 196608
    buffer_load_dword v23, v3, s[20:23], s51 offen sc1
    s_waitcnt lgkmcnt(11)
    ds_write_b64 v122, a[216:217] offset:8192
    ds_read_b64_tr_b16 a[20:21], v134 offset:32768
    ds_read_b64_tr_b16 a[22:23], v134 offset:33792
    v_exp_f32_e64 v67, v41 clamp
    v_max_f32 v41, s55, v41
    v_fmac_f32 v66, s54, v40
    v_cvt_pk_bf16_f32 v83, v64, v65
    v_exp_f32_e64 v68, v42 clamp
    v_max_f32 v42, s55, v42
    v_fmac_f32 v67, s54, v41
    v_exp_f32_e64 v69, v43 clamp
    v_max_f32 v43, s55, v43
    v_fmac_f32 v68, s54, v42
    v_mfma_f32_32x32x16_bf16 v[240:255], a[28:31], a[44:47], v[240:255]
    buffer_load_dwordx4 v[196:199], v2, s[20:23], s87 offen offset:1024 sc1
    ds_write_b64 v122, a[218:219] offset:8200
    s_waitcnt lgkmcnt(11)
    ds_write_b64 v122, a[220:221] offset:9216
    ds_read_b64_tr_b16 a[24:25], v135 offset:34816
    ds_read_b64_tr_b16 a[26:27], v135 offset:35840
    s_waitcnt lgkmcnt(11)
    v_cvt_pk_bf16_f32 v84, v66, v67
    v_exp_f32_e64 v64, v44 clamp
    v_max_f32 v44, s55, v44
    v_fmac_f32 v69, s54, v43
    v_exp_f32_e64 v65, v45 clamp
    v_max_f32 v45, s55, v45
    v_fmac_f32 v64, s54, v44
    v_cvt_pk_bf16_f32 v85, v68, v69
    s_waitcnt vmcnt(18)
    v_mfma_f32_32x32x16_bf16 v[224:239], a[0:3], a[48:51], v[224:239]
    buffer_load_dwordx4 v[200:203], v2, s[20:23], s87 offen offset:2048 sc1
    ds_write_b64 v122, a[222:223] offset:9224
    ds_write_b64 v122, a[224:225] offset:10240
    ds_read_b64_tr_b16 a[28:29], v134 offset:34816
    ds_read_b64_tr_b16 a[30:31], v134 offset:35840
    v_exp_f32_e64 v66, v46 clamp
    v_max_f32 v46, s55, v46
    v_fmac_f32 v65, s54, v45
    v_exp_f32_e64 v67, v47 clamp
    v_max_f32 v47, s55, v47
    v_fmac_f32 v66, s54, v46
    v_cvt_pk_bf16_f32 v86, v64, v65
    v_fmac_f32 v67, s54, v47
    v_cvt_pk_bf16_f32 v87, v66, v67
    v_mfma_f32_32x32x16_bf16 v[240:255], a[4:7], a[48:51], v[240:255]
    buffer_load_dwordx4 v[204:207], v2, s[20:23], s87 offen offset:3072 sc1
    s_waitcnt lgkmcnt(11)
    ds_write_b64 v122, a[226:227] offset:10248
    ds_read_b64_tr_b16 a[0:1], v129 offset:36864
    ds_read_b64_tr_b16 a[2:3], v129 offset:37888
    s_waitcnt vmcnt(14)
    v_bitop3_b32 v117, v147, v151, v22 bitop3:0x7e
    v_bitop3_b32 v118, v155, v159, v22 bitop3:0x7e
    v_or_b32 v117, v117, v118
    v_cmp_ne_u32 vcc, 0, v117
    s_cbranch_vccnz L_spin25
L_ok25:
    v_mfma_f32_16x16x16_bf16 v[112:115], v[92:93], v[144:145], 0
    v_mov_b32 v116, v146
    v_mfma_f32_16x16x16_bf16 v[112:115], v[92:93], v[148:149], v[112:115]
    s_waitcnt vmcnt(9)
    v_cmp_ne_u32 vcc, s38, v31
    v_mfma_f32_32x32x16_bf16 v[224:239], a[8:11], a[52:55], v[224:239]
    s_cbranch_vccnz L_spin26
L_ok26:
    buffer_load_dwordx4 a[64:67], v2, s[20:23], s28 offen offset:2048 sc1
    ds_write_b64 v122, a[228:229] offset:11264
    s_waitcnt lgkmcnt(11)
    ds_write_b64 v122, a[230:231] offset:11272
    ds_read_b64_tr_b16 a[4:5], v128 offset:36864
    ds_read_b64_tr_b16 a[6:7], v128 offset:37888
    v_add_f32 v116, v116, v150
    v_mfma_f32_16x16x16_bf16 v[112:115], v[92:93], v[152:153], v[112:115]
    v_add_f32 v116, v116, v154
    v_mfma_f32_16x16x16_bf16 v[112:115], v[92:93], v[156:157], v[112:115]
    v_mfma_f32_32x32x16_bf16 v[240:255], a[12:15], a[52:55], v[240:255]
    buffer_load_dwordx4 a[68:71], v2, s[20:23], s28 offen offset:3072 sc1
    ds_write_b64 v122, a[232:233] offset:12288
    s_waitcnt lgkmcnt(11)
    ds_write_b64 v122, a[234:235] offset:12296
    ds_read_b64_tr_b16 a[8:9], v129 offset:38912
    ds_read_b64_tr_b16 a[10:11], v129 offset:39936
    s_waitcnt lgkmcnt(11)
    v_add_f32 v116, v116, v158
    v_bitop3_b32 v117, v163, v167, v22 bitop3:0x7e
    v_bitop3_b32 v118, v171, v175, v22 bitop3:0x7e
    v_or_b32 v117, v117, v118
    v_cmp_ne_u32 vcc, 0, v117
    s_cbranch_vccnz L_spin27
L_ok27:
    v_mfma_f32_16x16x16_bf16 v[112:115], v[92:93], v[160:161], v[112:115]
    v_mfma_f32_32x32x16_bf16 v[224:239], a[16:19], a[56:59], v[224:239]
    buffer_load_dwordx4 a[72:75], v2, s[20:23], s29 offen offset:2048 sc1
    ds_write_b64 v122, a[236:237] offset:13312
    ds_read_b64_tr_b16 a[12:13], v128 offset:38912
    ds_read_b64_tr_b16 a[14:15], v128 offset:39936
    v_add_f32 v116, v116, v162
    v_mfma_f32_16x16x16_bf16 v[112:115], v[92:93], v[164:165], v[112:115]
    v_add_f32 v116, v116, v166
    v_mfma_f32_16x16x16_bf16 v[112:115], v[92:93], v[168:169], v[112:115]
    v_add_f32 v116, v116, v170
    v_mfma_f32_16x16x16_bf16 v[112:115], v[92:93], v[172:173], v[112:115]
    v_add_f32 v116, v116, v174
    v_mfma_f32_32x32x16_bf16 v[240:255], a[20:23], a[56:59], v[240:255]
    buffer_load_dwordx4 a[76:79], v2, s[20:23], s29 offen offset:3072 sc1
    ds_write_b64 v122, a[238:239] offset:13320
    s_waitcnt lgkmcnt(11)
    ds_write_b64 v122, a[240:241] offset:14336
    ds_read_b64_tr_b16 a[16:17], v131 offset:36864
    ds_read_b64_tr_b16 a[18:19], v131 offset:37888
    s_waitcnt vmcnt(9)
    v_bitop3_b32 v117, v179, v183, v22 bitop3:0x7e
    v_bitop3_b32 v118, v187, v191, v22 bitop3:0x7e
    v_or_b32 v117, v117, v118
    v_cmp_ne_u32 vcc, 0, v117
    s_cbranch_vccnz L_spin28
L_ok28:
    v_mfma_f32_16x16x16_bf16 v[112:115], v[92:93], v[176:177], v[112:115]
    v_add_f32 v116, v116, v178
    v_mfma_f32_32x32x16_bf16 v[224:239], a[24:27], a[60:63], v[224:239]
    buffer_load_dwordx4 a[80:83], v2, s[20:23], s30 offen offset:2048 sc1
    ds_write_b64 v122, a[242:243] offset:14344
    s_waitcnt lgkmcnt(11)
    ds_write_b64 v122, a[244:245] offset:15360
    ds_read_b64_tr_b16 a[20:21], v130 offset:36864
    ds_read_b64_tr_b16 a[22:23], v130 offset:37888
    v_mfma_f32_16x16x16_bf16 v[112:115], v[92:93], v[180:181], v[112:115]
    v_add_f32 v116, v116, v182
    v_mfma_f32_16x16x16_bf16 v[112:115], v[92:93], v[184:185], v[112:115]
    v_add_f32 v116, v116, v186
    s_waitcnt vmcnt(8)
    v_cmp_ne_u32 vcc, s38, v23
    v_mfma_f32_32x32x16_bf16 v[240:255], a[28:31], a[60:63], v[240:255]
    buffer_load_dwordx4 a[84:87], v2, s[20:23], s30 offen offset:3072 sc1
    buffer_load_dwordx4 a[88:91], v2, s[20:23], s31 offen offset:2048 sc1
    buffer_load_dwordx4 a[92:95], v2, s[20:23], s31 offen offset:3072 sc1
    s_cbranch_vccnz L_spin29
L_ok29:
    buffer_load_dwordx4 a[96:99], v14, s[20:23], s28 offen offset:0 sc1
    buffer_load_dwordx4 a[100:103], v14, s[20:23], s28 offen offset:1024 sc1
    buffer_load_dwordx4 a[104:107], v14, s[20:23], s29 offen offset:0 sc1
    ds_write_b64 v122, a[246:247] offset:15368
    s_waitcnt lgkmcnt(11)
    ds_read_b64_tr_b16 a[24:25], v131 offset:38912
    ds_read_b64_tr_b16 a[26:27], v131 offset:39936
    s_waitcnt lgkmcnt(11)
    v_mfma_f32_16x16x16_bf16 v[112:115], v[92:93], v[188:189], v[112:115]
    v_add_f32 v116, v116, v190
    s_waitcnt vmcnt(11)
    v_bitop3_b32 v117, v195, v199, v22 bitop3:0x7e
    v_bitop3_b32 v118, v203, v207, v22 bitop3:0x7e
    v_or_b32 v117, v117, v118
    v_cmp_ne_u32 vcc, 0, v117
    s_cbranch_vccnz L_spin30
L_ok30:
    v_mfma_f32_16x16x16_bf16 v[112:115], v[92:93], v[192:193], v[112:115]
    v_add_f32 v116, v116, v194
    v_mfma_f32_16x16x16_bf16 v[112:115], v[92:93], v[196:197], v[112:115]
    v_add_f32 v116, v116, v198
    v_mfma_f32_16x16x16_bf16 v[112:115], v[92:93], v[200:201], v[112:115]
    v_add_f32 v116, v116, v202
    v_mfma_f32_16x16x16_bf16 v[112:115], v[92:93], v[204:205], v[112:115]
    v_add_f32 v116, v116, v206
    v_cvt_pk_bf16_f32 v116, v116, v116
    ds_write_b16 v125, v116 offset:18432
    s_nop 4
    v_cvt_pk_bf16_f32 v112, v112, v113
    v_cvt_pk_bf16_f32 v113, v114, v115
    ds_write_b64 v124, v[112:113] offset:16384
    s_waitcnt lgkmcnt(0)
    s_barrier
    ds_read_b128 v[96:99], v126 offset:16384
    ds_read_b128 v[100:103], v127 offset:16384
    ds_read_b128 v[104:107], v126 offset:17408
    ds_read_b128 v[108:111], v127 offset:17408
    s_waitcnt lgkmcnt(3)
    v_mfma_f32_32x32x16_bf16 v[144:159], v[96:99], v[72:75], 0
    s_waitcnt lgkmcnt(2)
    v_mfma_f32_32x32x16_bf16 v[160:175], v[100:103], v[76:79], 0
    s_waitcnt lgkmcnt(1)
    v_mfma_f32_32x32x16_bf16 v[176:191], v[104:107], v[80:83], 0
    s_waitcnt lgkmcnt(0)
    v_mfma_f32_32x32x16_bf16 v[192:207], v[108:111], v[84:87], 0
    s_waitcnt vmcnt(9)
    v_mfma_f32_32x32x16_bf16 v[224:239], a[0:3], a[64:67], v[224:239]
    buffer_load_dwordx4 a[108:111], v14, s[20:23], s29 offen offset:1024 sc1
    ds_read_b64_tr_b16 a[28:29], v130 offset:38912
    ds_read_b64_tr_b16 a[30:31], v130 offset:39936
    v_mfma_f32_32x32x16_bf16 v[240:255], a[4:7], a[64:67], v[240:255]
    buffer_load_dwordx4 a[112:115], v14, s[20:23], s30 offen offset:0 sc1
    ds_read_b64_tr_b16 a[0:1], v133 offset:36864
    ds_read_b64_tr_b16 a[2:3], v133 offset:37888
    v_add_f32 v152, v152, v153
    v_add_f32 v154, v154, v155
    v_add_f32 v152, v152, v154
    v_add_f32 v152, 0x358637bd, v152
    v_rcp_f32 v152, v152
    s_nop 0
    v_mul_f32 v144, v152, v144
    v_mfma_f32_32x32x16_bf16 v[224:239], a[8:11], a[68:71], v[224:239]
    buffer_load_dwordx4 a[116:119], v14, s[20:23], s30 offen offset:1024 sc1
    ds_read_b64_tr_b16 a[4:5], v132 offset:36864
    ds_read_b64_tr_b16 a[6:7], v132 offset:37888
    v_mul_f32 v145, v152, v145
    v_mul_f32 v146, v152, v146
    v_mul_f32 v147, v152, v147
    v_mul_f32 v148, v152, v148
    v_mul_f32 v149, v152, v149
    v_mul_f32 v150, v152, v150
    v_mul_f32 v151, v152, v151
    v_cvt_pk_bf16_f32 v96, v144, v145
    v_mfma_f32_32x32x16_bf16 v[240:255], a[12:15], a[68:71], v[240:255]
    ds_read_b64_tr_b16 a[8:9], v133 offset:38912
    ds_read_b64_tr_b16 a[10:11], v133 offset:39936
    s_waitcnt lgkmcnt(6)
    v_cvt_pk_bf16_f32 v97, v146, v147
    v_cvt_pk_bf16_f32 v98, v148, v149
    v_cvt_pk_bf16_f32 v99, v150, v151
    v_add_f32 v160, v160, v161
    v_add_f32 v162, v162, v163
    v_add_f32 v160, v160, v162
    v_add_f32 v160, 0x358637bd, v160
    v_rcp_f32 v160, v160
    s_waitcnt vmcnt(10)
    v_mfma_f32_32x32x16_bf16 v[224:239], a[16:19], a[72:75], v[224:239]
    s_mov_b32 s51, 262144
    buffer_load_dword v30, v3, s[20:23], s51 offen sc1
    buffer_store_dwordx4 v[96:99], v16, s[20:23], s28 offen offset:2048 sc1
    ds_read_b64_tr_b16 a[12:13], v132 offset:38912
    ds_read_b64_tr_b16 a[14:15], v132 offset:39936
    v_mfma_f32_32x32x16_bf16 v[240:255], a[20:23], a[72:75], v[240:255]
    ds_read_b64_tr_b16 a[16:17], v135 offset:36864
    ds_read_b64_tr_b16 a[18:19], v135 offset:37888
    s_nop 0
    v_mul_f32 v168, v160, v168
    v_mul_f32 v169, v160, v169
    v_mul_f32 v170, v160, v170
    v_mul_f32 v171, v160, v171
    v_mul_f32 v172, v160, v172
    v_mul_f32 v173, v160, v173
    v_mul_f32 v174, v160, v174
    v_mul_f32 v175, v160, v175
    v_cvt_pk_bf16_f32 v100, v168, v169
    v_mfma_f32_32x32x16_bf16 v[224:239], a[24:27], a[76:79], v[224:239]
    ds_read_b64_tr_b16 a[20:21], v134 offset:36864
    ds_read_b64_tr_b16 a[22:23], v134 offset:37888
    v_cvt_pk_bf16_f32 v101, v170, v171
    v_cvt_pk_bf16_f32 v102, v172, v173
    v_cvt_pk_bf16_f32 v103, v174, v175
    v_add_f32 v184, v184, v185
    v_add_f32 v186, v186, v187
    v_add_f32 v184, v184, v186
    v_add_f32 v184, 0x358637bd, v184
    v_rcp_f32 v184, v184
    s_nop 0
    v_mfma_f32_32x32x16_bf16 v[240:255], a[28:31], a[76:79], v[240:255]
    buffer_store_dwordx4 v[100:103], v16, s[20:23], s28 offen offset:3072 sc1
    ds_read_b64_tr_b16 a[24:25], v135 offset:38912
    ds_read_b64_tr_b16 a[26:27], v135 offset:39936
    s_waitcnt lgkmcnt(6)
    v_mul_f32 v176, v184, v176
    s_waitcnt vmcnt(11)
    v_mfma_f32_32x32x16_bf16 v[224:239], a[0:3], a[80:83], v[224:239]
    ds_read_b64_tr_b16 a[28:29], v134 offset:38912
    ds_read_b64_tr_b16 a[30:31], v134 offset:39936
    v_mul_f32 v177, v184, v177
    v_mul_f32 v178, v184, v178
    v_mul_f32 v179, v184, v179
    v_mul_f32 v180, v184, v180
    v_mul_f32 v181, v184, v181
    v_mul_f32 v182, v184, v182
    v_mul_f32 v183, v184, v183
    v_cvt_pk_bf16_f32 v104, v176, v177
    v_cvt_pk_bf16_f32 v105, v178, v179
    v_cvt_pk_bf16_f32 v106, v180, v181
    v_mfma_f32_32x32x16_bf16 v[240:255], a[4:7], a[80:83], v[240:255]
    ds_read_b64_tr_b16 a[0:1], v129 offset:20480
    ds_read_b64_tr_b16 a[2:3], v129 offset:21504
    v_cvt_pk_bf16_f32 v107, v182, v183
    v_add_f32 v192, v192, v193
    v_add_f32 v194, v194, v195
    v_add_f32 v192, v192, v194
    v_add_f32 v192, 0x358637bd, v192
    v_rcp_f32 v192, v192
    s_nop 0
    v_mul_f32 v200, v192, v200
    v_mul_f32 v201, v192, v201
    v_mul_f32 v202, v192, v202
    v_mul_f32 v203, v192, v203
    v_mul_f32 v204, v192, v204
    v_mul_f32 v205, v192, v205
    v_mul_f32 v206, v192, v206
    v_mul_f32 v207, v192, v207
    v_cvt_pk_bf16_f32 v108, v200, v201
    v_cvt_pk_bf16_f32 v109, v202, v203
    v_cvt_pk_bf16_f32 v110, v204, v205
    v_cvt_pk_bf16_f32 v111, v206, v207
    v_mfma_f32_32x32x16_bf16 v[224:239], a[8:11], a[84:87], v[224:239]
    buffer_store_dwordx4 v[104:107], v17, s[20:23], s28 offen offset:0 sc1
    buffer_store_dwordx4 v[108:111], v17, s[20:23], s28 offen offset:1024 sc1
    ds_read_b64_tr_b16 a[4:5], v128 offset:20480
    ds_read_b64_tr_b16 a[6:7], v128 offset:21504
    v_mfma_f32_32x32x16_bf16 v[240:255], a[12:15], a[84:87], v[240:255]
    ds_read_b64_tr_b16 a[8:9], v129 offset:22528
    ds_read_b64_tr_b16 a[10:11], v129 offset:23552
    s_waitcnt lgkmcnt(6)
    s_waitcnt vmcnt(11)
    v_mfma_f32_32x32x16_bf16 v[224:239], a[16:19], a[88:91], v[224:239]
    ds_read_b64_tr_b16 a[12:13], v128 offset:22528
    ds_read_b64_tr_b16 a[14:15], v128 offset:23552
    v_mfma_f32_32x32x16_bf16 v[240:255], a[20:23], a[88:91], v[240:255]
    ds_read_b64_tr_b16 a[16:17], v131 offset:20480
    ds_read_b64_tr_b16 a[18:19], v131 offset:21504
    v_mfma_f32_32x32x16_bf16 v[224:239], a[24:27], a[92:95], v[224:239]
    ds_read_b64_tr_b16 a[20:21], v130 offset:20480
    ds_read_b64_tr_b16 a[22:23], v130 offset:21504
    v_mfma_f32_32x32x16_bf16 v[240:255], a[28:31], a[92:95], v[240:255]
    ds_read_b64_tr_b16 a[24:25], v131 offset:22528
    ds_read_b64_tr_b16 a[26:27], v131 offset:23552
    s_waitcnt lgkmcnt(6)
    s_waitcnt vmcnt(9)
    v_mfma_f32_32x32x16_bf16 v[224:239], a[0:3], a[96:99], v[224:239]
    ds_read_b64_tr_b16 a[28:29], v130 offset:22528
    ds_read_b64_tr_b16 a[30:31], v130 offset:23552
    v_mfma_f32_32x32x16_bf16 v[240:255], a[4:7], a[96:99], v[240:255]
    buffer_load_dwordx4 a[120:123], v14, s[20:23], s31 offen offset:0 sc1
    ds_read_b64_tr_b16 a[0:1], v133 offset:20480
    ds_read_b64_tr_b16 a[2:3], v133 offset:21504
    v_mfma_f32_32x32x16_bf16 v[224:239], a[8:11], a[100:103], v[224:239]
    buffer_load_dwordx4 a[124:127], v14, s[20:23], s31 offen offset:1024 sc1
    ds_read_b64_tr_b16 a[4:5], v132 offset:20480
    ds_read_b64_tr_b16 a[6:7], v132 offset:21504
    v_mfma_f32_32x32x16_bf16 v[240:255], a[12:15], a[100:103], v[240:255]
    ds_read_b64_tr_b16 a[8:9], v133 offset:22528
    ds_read_b64_tr_b16 a[10:11], v133 offset:23552
    s_waitcnt lgkmcnt(6)
    s_waitcnt vmcnt(6)
    v_cmp_ne_u32 vcc, s38, v30
    v_mfma_f32_32x32x16_bf16 v[224:239], a[16:19], a[104:107], v[224:239]
    s_cbranch_vccnz L_spin31
L_ok31:
    buffer_load_dwordx4 a[128:131], v14, s[20:23], s28 offen offset:2048 sc1
    ds_read_b64_tr_b16 a[12:13], v132 offset:22528
    ds_read_b64_tr_b16 a[14:15], v132 offset:23552
    v_mfma_f32_32x32x16_bf16 v[240:255], a[20:23], a[104:107], v[240:255]
    ds_read_b64_tr_b16 a[16:17], v135 offset:20480
    ds_read_b64_tr_b16 a[18:19], v135 offset:21504
    v_mfma_f32_32x32x16_bf16 v[224:239], a[24:27], a[108:111], v[224:239]
    buffer_load_dwordx4 a[132:135], v14, s[20:23], s28 offen offset:3072 sc1
    ds_read_b64_tr_b16 a[20:21], v134 offset:20480
    ds_read_b64_tr_b16 a[22:23], v134 offset:21504
    v_mfma_f32_32x32x16_bf16 v[240:255], a[28:31], a[108:111], v[240:255]
    ds_read_b64_tr_b16 a[24:25], v135 offset:22528
    ds_read_b64_tr_b16 a[26:27], v135 offset:23552
    s_waitcnt lgkmcnt(6)
    v_mfma_f32_32x32x16_bf16 v[224:239], a[0:3], a[112:115], v[224:239]
    buffer_load_dwordx4 a[136:139], v14, s[20:23], s29 offen offset:2048 sc1
    ds_read_b64_tr_b16 a[28:29], v134 offset:22528
    ds_read_b64_tr_b16 a[30:31], v134 offset:23552
    v_mfma_f32_32x32x16_bf16 v[240:255], a[4:7], a[112:115], v[240:255]
    ds_read_b64_tr_b16 a[0:1], v129 offset:8192
    ds_read_b64_tr_b16 a[2:3], v129 offset:9216
    v_mfma_f32_32x32x16_bf16 v[224:239], a[8:11], a[116:119], v[224:239]
    buffer_load_dwordx4 a[140:143], v14, s[20:23], s29 offen offset:3072 sc1
    ds_read_b64_tr_b16 a[4:5], v128 offset:8192
    ds_read_b64_tr_b16 a[6:7], v128 offset:9216
    v_mfma_f32_32x32x16_bf16 v[240:255], a[12:15], a[116:119], v[240:255]
    ds_read_b64_tr_b16 a[8:9], v129 offset:10240
    ds_read_b64_tr_b16 a[10:11], v129 offset:11264
    s_waitcnt lgkmcnt(6)
    s_waitcnt vmcnt(4)
    v_mfma_f32_32x32x16_bf16 v[224:239], a[16:19], a[120:123], v[224:239]
    buffer_load_dwordx4 a[144:147], v14, s[20:23], s30 offen offset:2048 sc1
    ds_read_b64_tr_b16 a[12:13], v128 offset:10240
    ds_read_b64_tr_b16 a[14:15], v128 offset:11264
    v_mfma_f32_32x32x16_bf16 v[240:255], a[20:23], a[120:123], v[240:255]
    ds_read_b64_tr_b16 a[16:17], v129 offset:12288
    ds_read_b64_tr_b16 a[18:19], v129 offset:13312
    v_mfma_f32_32x32x16_bf16 v[224:239], a[24:27], a[124:127], v[224:239]
    buffer_load_dwordx4 a[148:151], v14, s[20:23], s30 offen offset:3072 sc1
    ds_read_b64_tr_b16 a[20:21], v128 offset:12288
    ds_read_b64_tr_b16 a[22:23], v128 offset:13312
    v_mfma_f32_32x32x16_bf16 v[240:255], a[28:31], a[124:127], v[240:255]
    ds_read_b64_tr_b16 a[24:25], v129 offset:14336
    ds_read_b64_tr_b16 a[26:27], v129 offset:15360
    s_waitcnt lgkmcnt(6)
    v_mfma_f32_32x32x16_bf16 v[224:239], a[0:3], v[96:99], v[224:239]
    ds_read_b64_tr_b16 a[28:29], v128 offset:14336
    ds_read_b64_tr_b16 a[30:31], v128 offset:15360
    v_mfma_f32_32x32x16_bf16 v[240:255], a[4:7], v[96:99], v[240:255]
    ds_read_b64_tr_b16 a[0:1], v129 offset:24576
    ds_read_b64_tr_b16 a[2:3], v129 offset:25600
    v_mfma_f32_32x32x16_bf16 v[224:239], a[8:11], v[100:103], v[224:239]
    buffer_load_dwordx4 a[152:155], v14, s[20:23], s31 offen offset:2048 sc1
    ds_read_b64_tr_b16 a[4:5], v128 offset:24576
    ds_read_b64_tr_b16 a[6:7], v128 offset:25600
    v_mfma_f32_32x32x16_bf16 v[240:255], a[12:15], v[100:103], v[240:255]
    ds_read_b64_tr_b16 a[8:9], v129 offset:26624
    ds_read_b64_tr_b16 a[10:11], v129 offset:27648
    s_waitcnt lgkmcnt(6)
    v_mfma_f32_32x32x16_bf16 v[224:239], a[16:19], v[104:107], v[224:239]
    buffer_load_dwordx4 a[156:159], v14, s[20:23], s31 offen offset:3072 sc1
    ds_read_b64_tr_b16 a[12:13], v128 offset:26624
    ds_read_b64_tr_b16 a[14:15], v128 offset:27648
    v_mfma_f32_32x32x16_bf16 v[240:255], a[20:23], v[104:107], v[240:255]
    buffer_load_dwordx4 a[160:163], v15, s[20:23], s28 offen offset:0 sc1
    ds_read_b64_tr_b16 a[16:17], v131 offset:24576
    ds_read_b64_tr_b16 a[18:19], v131 offset:25600
    v_mfma_f32_32x32x16_bf16 v[224:239], a[24:27], v[108:111], v[224:239]
    ds_read_b64_tr_b16 a[20:21], v130 offset:24576
    ds_read_b64_tr_b16 a[22:23], v130 offset:25600
    v_mfma_f32_32x32x16_bf16 v[240:255], a[28:31], v[108:111], v[240:255]
    buffer_load_dwordx4 a[164:167], v15, s[20:23], s28 offen offset:1024 sc1
    ds_read_b64_tr_b16 a[24:25], v131 offset:26624
    ds_read_b64_tr_b16 a[26:27], v131 offset:27648
    s_waitcnt lgkmcnt(6)
    s_barrier
    s_waitcnt vmcnt(8)
    v_mfma_f32_32x32x16_bf16 v[224:239], a[0:3], a[128:131], v[224:239]
    ds_read_b64_tr_b16 a[28:29], v130 offset:26624
    ds_read_b64_tr_b16 a[30:31], v130 offset:27648
    v_mfma_f32_32x32x16_bf16 v[240:255], a[4:7], a[128:131], v[240:255]
    buffer_load_dwordx4 a[168:171], v15, s[20:23], s29 offen offset:0 sc1
    ds_read_b64_tr_b16 a[0:1], v133 offset:24576
    ds_read_b64_tr_b16 a[2:3], v133 offset:25600
    v_mfma_f32_32x32x16_bf16 v[224:239], a[8:11], a[132:135], v[224:239]
    ds_read_b64_tr_b16 a[4:5], v132 offset:24576
    ds_read_b64_tr_b16 a[6:7], v132 offset:25600
    v_mfma_f32_32x32x16_bf16 v[240:255], a[12:15], a[132:135], v[240:255]
    buffer_load_dwordx4 a[172:175], v15, s[20:23], s29 offen offset:1024 sc1
    ds_read_b64_tr_b16 a[8:9], v133 offset:26624
    ds_read_b64_tr_b16 a[10:11], v133 offset:27648
    s_waitcnt lgkmcnt(6)
    s_waitcnt vmcnt(8)
    v_mfma_f32_32x32x16_bf16 v[224:239], a[16:19], a[136:139], v[224:239]
    ds_read_b64_tr_b16 a[12:13], v132 offset:26624
    ds_read_b64_tr_b16 a[14:15], v132 offset:27648
    v_mfma_f32_32x32x16_bf16 v[240:255], a[20:23], a[136:139], v[240:255]
    buffer_load_dwordx4 a[176:179], v15, s[20:23], s30 offen offset:0 sc1
    ds_read_b64_tr_b16 a[16:17], v135 offset:24576
    ds_read_b64_tr_b16 a[18:19], v135 offset:25600
    v_mfma_f32_32x32x16_bf16 v[224:239], a[24:27], a[140:143], v[224:239]
    ds_read_b64_tr_b16 a[20:21], v134 offset:24576
    ds_read_b64_tr_b16 a[22:23], v134 offset:25600
    v_mfma_f32_32x32x16_bf16 v[240:255], a[28:31], a[140:143], v[240:255]
    buffer_load_dwordx4 a[180:183], v15, s[20:23], s30 offen offset:1024 sc1
    ds_read_b64_tr_b16 a[24:25], v135 offset:26624
    ds_read_b64_tr_b16 a[26:27], v135 offset:27648
    s_waitcnt lgkmcnt(6)
    s_waitcnt vmcnt(8)
    v_mfma_f32_32x32x16_bf16 v[224:239], a[0:3], a[144:147], v[224:239]
    ds_read_b64_tr_b16 a[28:29], v134 offset:26624
    ds_read_b64_tr_b16 a[30:31], v134 offset:27648
    v_mfma_f32_32x32x16_bf16 v[240:255], a[4:7], a[144:147], v[240:255]
    buffer_load_dwordx4 a[184:187], v15, s[20:23], s31 offen offset:0 sc1
    ds_read_b64_tr_b16 a[0:1], v129 offset:28672
    ds_read_b64_tr_b16 a[2:3], v129 offset:29696
    v_mfma_f32_32x32x16_bf16 v[224:239], a[8:11], a[148:151], v[224:239]
    buffer_load_dwordx4 a[188:191], v15, s[20:23], s31 offen offset:1024 sc1
    ds_read_b64_tr_b16 a[4:5], v128 offset:28672
    ds_read_b64_tr_b16 a[6:7], v128 offset:29696
    v_mfma_f32_32x32x16_bf16 v[240:255], a[12:15], a[148:151], v[240:255]
    ds_read_b64_tr_b16 a[8:9], v129 offset:30720
    ds_read_b64_tr_b16 a[10:11], v129 offset:31744
    s_waitcnt lgkmcnt(6)
    s_waitcnt vmcnt(8)
    v_mfma_f32_32x32x16_bf16 v[224:239], a[16:19], a[152:155], v[224:239]
    buffer_load_dwordx4 a[192:195], v15, s[20:23], s28 offen offset:2048 sc1
    ds_read_b64_tr_b16 a[12:13], v128 offset:30720
    ds_read_b64_tr_b16 a[14:15], v128 offset:31744
    v_mfma_f32_32x32x16_bf16 v[240:255], a[20:23], a[152:155], v[240:255]
    ds_read_b64_tr_b16 a[16:17], v131 offset:28672
    ds_read_b64_tr_b16 a[18:19], v131 offset:29696
    v_mfma_f32_32x32x16_bf16 v[224:239], a[24:27], a[156:159], v[224:239]
    buffer_load_dwordx4 a[196:199], v15, s[20:23], s28 offen offset:3072 sc1
    ds_read_b64_tr_b16 a[20:21], v130 offset:28672
    ds_read_b64_tr_b16 a[22:23], v130 offset:29696
    s_waitcnt vmcnt(8)
    v_accvgpr_read_b32 v48, a160
    v_accvgpr_read_b32 v49, a164
    v_max_u32 v48, v48, v49
    v_cmp_eq_u32 vcc, -1, v48
    v_mfma_f32_32x32x16_bf16 v[240:255], a[28:31], a[156:159], v[240:255]
    ds_read_b64_tr_b16 a[24:25], v131 offset:30720
    ds_read_b64_tr_b16 a[26:27], v131 offset:31744
    s_waitcnt lgkmcnt(6)
    s_cbranch_vccnz L_spin32
L_ok32:
    v_mfma_f32_32x32x16_bf16 v[224:239], a[0:3], a[160:163], v[224:239]
    buffer_load_dwordx4 a[200:203], v15, s[20:23], s29 offen offset:2048 sc1
    ds_read_b64_tr_b16 a[28:29], v130 offset:30720
    ds_read_b64_tr_b16 a[30:31], v130 offset:31744
    v_mfma_f32_32x32x16_bf16 v[240:255], a[4:7], a[160:163], v[240:255]
    ds_read_b64_tr_b16 a[0:1], v133 offset:28672
    ds_read_b64_tr_b16 a[2:3], v133 offset:29696
    v_mfma_f32_32x32x16_bf16 v[224:239], a[8:11], a[164:167], v[224:239]
    buffer_load_dwordx4 a[204:207], v15, s[20:23], s29 offen offset:3072 sc1
    ds_read_b64_tr_b16 a[4:5], v132 offset:28672
    ds_read_b64_tr_b16 a[6:7], v132 offset:29696
    s_waitcnt vmcnt(8)
    v_accvgpr_read_b32 v48, a168
    v_accvgpr_read_b32 v49, a172
    v_max_u32 v48, v48, v49
    v_cmp_eq_u32 vcc, -1, v48
    v_mfma_f32_32x32x16_bf16 v[240:255], a[12:15], a[164:167], v[240:255]
    ds_read_b64_tr_b16 a[8:9], v133 offset:30720
    ds_read_b64_tr_b16 a[10:11], v133 offset:31744
    s_waitcnt lgkmcnt(6)
    s_cbranch_vccnz L_spin33
L_ok33:
    v_mfma_f32_32x32x16_bf16 v[224:239], a[16:19], a[168:171], v[224:239]
    buffer_load_dwordx4 a[208:211], v15, s[20:23], s30 offen offset:2048 sc1
    ds_read_b64_tr_b16 a[12:13], v132 offset:30720
    ds_read_b64_tr_b16 a[14:15], v132 offset:31744
    v_mfma_f32_32x32x16_bf16 v[240:255], a[20:23], a[168:171], v[240:255]
    ds_read_b64_tr_b16 a[16:17], v135 offset:28672
    ds_read_b64_tr_b16 a[18:19], v135 offset:29696
    v_mfma_f32_32x32x16_bf16 v[224:239], a[24:27], a[172:175], v[224:239]
    buffer_load_dwordx4 a[212:215], v15, s[20:23], s30 offen offset:3072 sc1
    ds_read_b64_tr_b16 a[20:21], v134 offset:28672
    ds_read_b64_tr_b16 a[22:23], v134 offset:29696
    s_waitcnt vmcnt(8)
    v_accvgpr_read_b32 v48, a176
    v_accvgpr_read_b32 v49, a180
    v_max_u32 v48, v48, v49
    v_cmp_eq_u32 vcc, -1, v48
    v_mfma_f32_32x32x16_bf16 v[240:255], a[28:31], a[172:175], v[240:255]
    ds_read_b64_tr_b16 a[24:25], v135 offset:30720
    ds_read_b64_tr_b16 a[26:27], v135 offset:31744
    s_waitcnt lgkmcnt(6)
    s_cbranch_vccnz L_spin34
L_ok34:
    v_mfma_f32_32x32x16_bf16 v[224:239], a[0:3], a[176:179], v[224:239]
    buffer_load_dwordx4 a[216:219], v15, s[20:23], s31 offen offset:2048 sc1
    ds_read_b64_tr_b16 a[28:29], v134 offset:30720
    ds_read_b64_tr_b16 a[30:31], v134 offset:31744
    v_mfma_f32_32x32x16_bf16 v[240:255], a[4:7], a[176:179], v[240:255]
    buffer_load_dwordx4 a[220:223], v15, s[20:23], s31 offen offset:3072 sc1
    ds_read_b64_tr_b16 a[0:1], v129 offset:0
    ds_read_b64_tr_b16 a[2:3], v129 offset:1024
    v_mfma_f32_32x32x16_bf16 v[224:239], a[8:11], a[180:183], v[224:239]
    ds_read_b64_tr_b16 a[4:5], v128 offset:0
    ds_read_b64_tr_b16 a[6:7], v128 offset:1024
    s_waitcnt vmcnt(8)
    v_accvgpr_read_b32 v48, a184
    v_accvgpr_read_b32 v49, a188
    v_max_u32 v48, v48, v49
    v_cmp_eq_u32 vcc, -1, v48
    v_mfma_f32_32x32x16_bf16 v[240:255], a[12:15], a[180:183], v[240:255]
    buffer_load_dwordx4 a[224:227], v16, s[20:23], s28 offen offset:0 sc1
    ds_read_b64_tr_b16 a[8:9], v129 offset:2048
    ds_read_b64_tr_b16 a[10:11], v129 offset:3072
    s_waitcnt lgkmcnt(6)
    s_cbranch_vccnz L_spin35
L_ok35:
    v_mfma_f32_32x32x16_bf16 v[224:239], a[16:19], a[184:187], v[224:239]
    ds_read_b64_tr_b16 a[12:13], v128 offset:2048
    ds_read_b64_tr_b16 a[14:15], v128 offset:3072
    v_mfma_f32_32x32x16_bf16 v[240:255], a[20:23], a[184:187], v[240:255]
    buffer_load_dwordx4 a[228:231], v16, s[20:23], s28 offen offset:1024 sc1
    ds_read_b64_tr_b16 a[16:17], v131 offset:0
    ds_read_b64_tr_b16 a[18:19], v131 offset:1024
    v_mfma_f32_32x32x16_bf16 v[224:239], a[24:27], a[188:191], v[224:239]
    ds_read_b64_tr_b16 a[20:21], v130 offset:0
    ds_read_b64_tr_b16 a[22:23], v130 offset:1024
    s_waitcnt vmcnt(8)
    v_accvgpr_read_b32 v48, a192
    v_accvgpr_read_b32 v49, a196
    v_max_u32 v48, v48, v49
    v_cmp_eq_u32 vcc, -1, v48
    v_mfma_f32_32x32x16_bf16 v[240:255], a[28:31], a[188:191], v[240:255]
    buffer_load_dwordx4 a[232:235], v16, s[20:23], s29 offen offset:0 sc1
    ds_read_b64_tr_b16 a[24:25], v131 offset:2048
    ds_read_b64_tr_b16 a[26:27], v131 offset:3072
    s_waitcnt lgkmcnt(6)
    s_cbranch_vccnz L_spin36
L_ok36:
    v_mfma_f32_32x32x16_bf16 v[224:239], a[0:3], a[192:195], v[224:239]
    ds_read_b64_tr_b16 a[28:29], v130 offset:2048
    ds_read_b64_tr_b16 a[30:31], v130 offset:3072
    v_mfma_f32_32x32x16_bf16 v[240:255], a[4:7], a[192:195], v[240:255]
    buffer_load_dwordx4 a[236:239], v16, s[20:23], s29 offen offset:1024 sc1
    ds_read_b64_tr_b16 a[0:1], v133 offset:0
    ds_read_b64_tr_b16 a[2:3], v133 offset:1024
    v_mfma_f32_32x32x16_bf16 v[224:239], a[8:11], a[196:199], v[224:239]
    ds_read_b64_tr_b16 a[4:5], v132 offset:0
    ds_read_b64_tr_b16 a[6:7], v132 offset:1024
    s_waitcnt vmcnt(8)
    v_accvgpr_read_b32 v48, a200
    v_accvgpr_read_b32 v49, a204
    v_max_u32 v48, v48, v49
    v_cmp_eq_u32 vcc, -1, v48
    v_mfma_f32_32x32x16_bf16 v[240:255], a[12:15], a[196:199], v[240:255]
    buffer_load_dwordx4 a[240:243], v16, s[20:23], s30 offen offset:0 sc1
    ds_read_b64_tr_b16 a[8:9], v133 offset:2048
    ds_read_b64_tr_b16 a[10:11], v133 offset:3072
    s_waitcnt lgkmcnt(6)
    s_cbranch_vccnz L_spin37
L_ok37:
    v_mfma_f32_32x32x16_bf16 v[224:239], a[16:19], a[200:203], v[224:239]
    ds_read_b64_tr_b16 a[12:13], v132 offset:2048
    ds_read_b64_tr_b16 a[14:15], v132 offset:3072
    v_mfma_f32_32x32x16_bf16 v[240:255], a[20:23], a[200:203], v[240:255]
    buffer_load_dwordx4 a[244:247], v16, s[20:23], s30 offen offset:1024 sc1
    ds_read_b64_tr_b16 a[16:17], v135 offset:0
    ds_read_b64_tr_b16 a[18:19], v135 offset:1024
    v_mfma_f32_32x32x16_bf16 v[224:239], a[24:27], a[204:207], v[224:239]
    buffer_load_dwordx4 a[32:35], v16, s[20:23], s31 offen offset:0 sc1
    ds_read_b64_tr_b16 a[20:21], v134 offset:0
    ds_read_b64_tr_b16 a[22:23], v134 offset:1024
    s_waitcnt vmcnt(9)
    v_accvgpr_read_b32 v48, a208
    v_accvgpr_read_b32 v49, a212
    v_max_u32 v48, v48, v49
    v_cmp_eq_u32 vcc, -1, v48
    v_mfma_f32_32x32x16_bf16 v[240:255], a[28:31], a[204:207], v[240:255]
    ds_read_b64_tr_b16 a[24:25], v135 offset:2048
    ds_read_b64_tr_b16 a[26:27], v135 offset:3072
    s_waitcnt lgkmcnt(6)
    s_cbranch_vccnz L_spin38
L_ok38:
    v_mfma_f32_32x32x16_bf16 v[224:239], a[0:3], a[208:211], v[224:239]
    buffer_load_dwordx4 a[36:39], v16, s[20:23], s31 offen offset:1024 sc1
    ds_read_b64_tr_b16 a[28:29], v134 offset:2048
    ds_read_b64_tr_b16 a[30:31], v134 offset:3072
    v_mfma_f32_32x32x16_bf16 v[240:255], a[4:7], a[208:211], v[240:255]
    ds_read_b64_tr_b16 a[0:1], v129 offset:4096
    ds_read_b64_tr_b16 a[2:3], v129 offset:5120
    v_mfma_f32_32x32x16_bf16 v[224:239], a[8:11], a[212:215], v[224:239]
    buffer_load_dwordx4 a[40:43], v16, s[20:23], s29 offen offset:2048 sc1
    ds_read_b64_tr_b16 a[4:5], v128 offset:4096
    ds_read_b64_tr_b16 a[6:7], v128 offset:5120
    s_waitcnt vmcnt(9)
    v_accvgpr_read_b32 v48, a216
    v_accvgpr_read_b32 v49, a220
    v_max_u32 v48, v48, v49
    v_cmp_eq_u32 vcc, -1, v48
    v_mfma_f32_32x32x16_bf16 v[240:255], a[12:15], a[212:215], v[240:255]
    ds_read_b64_tr_b16 a[8:9], v129 offset:6144
    ds_read_b64_tr_b16 a[10:11], v129 offset:7168
    s_waitcnt lgkmcnt(6)
    s_cbranch_vccnz L_spin39
L_ok39:
    v_mfma_f32_32x32x16_bf16 v[224:239], a[16:19], a[216:219], v[224:239]
    buffer_load_dwordx4 a[44:47], v16, s[20:23], s29 offen offset:3072 sc1
    ds_read_b64_tr_b16 a[12:13], v128 offset:6144
    ds_read_b64_tr_b16 a[14:15], v128 offset:7168
    v_mfma_f32_32x32x16_bf16 v[240:255], a[20:23], a[216:219], v[240:255]
    ds_read_b64_tr_b16 a[16:17], v131 offset:4096
    ds_read_b64_tr_b16 a[18:19], v131 offset:5120
    v_mfma_f32_32x32x16_bf16 v[224:239], a[24:27], a[220:223], v[224:239]
    buffer_load_dwordx4 a[48:51], v16, s[20:23], s30 offen offset:2048 sc1
    ds_read_b64_tr_b16 a[20:21], v130 offset:4096
    ds_read_b64_tr_b16 a[22:23], v130 offset:5120
    s_waitcnt vmcnt(9)
    v_accvgpr_read_b32 v48, a224
    v_accvgpr_read_b32 v49, a228
    v_max_u32 v48, v48, v49
    v_cmp_eq_u32 vcc, -1, v48
    v_mfma_f32_32x32x16_bf16 v[240:255], a[28:31], a[220:223], v[240:255]
    ds_read_b64_tr_b16 a[24:25], v131 offset:6144
    ds_read_b64_tr_b16 a[26:27], v131 offset:7168
    s_waitcnt lgkmcnt(6)
    s_cbranch_vccnz L_spin40
L_ok40:
    v_accvgpr_read_b32 v136, a248
    v_mfma_f32_32x32x16_bf16 v[224:239], a[0:3], a[224:227], v[224:239]
    buffer_load_dwordx4 a[52:55], v16, s[20:23], s30 offen offset:3072 sc1
    ds_read_b64_tr_b16 a[28:29], v130 offset:6144
    ds_read_b64_tr_b16 a[30:31], v130 offset:7168
    v_accvgpr_read_b32 v137, a249
    v_accvgpr_read_b32 v138, a250
    v_mfma_f32_32x32x16_bf16 v[240:255], a[4:7], a[224:227], v[240:255]
    ds_read_b64_tr_b16 a[0:1], v133 offset:4096
    ds_read_b64_tr_b16 a[2:3], v133 offset:5120
    v_accvgpr_read_b32 v139, a251
    v_accvgpr_read_b32 v140, a252
    v_accvgpr_read_b32 v141, a253
    v_accvgpr_read_b32 v142, a254
    v_mfma_f32_32x32x16_bf16 v[224:239], a[8:11], a[228:231], v[224:239]
    buffer_load_dwordx4 a[56:59], v16, s[20:23], s31 offen offset:2048 sc1
    ds_read_b64_tr_b16 a[4:5], v132 offset:4096
    ds_read_b64_tr_b16 a[6:7], v132 offset:5120
    s_waitcnt vmcnt(9)
    v_accvgpr_read_b32 v48, a232
    v_accvgpr_read_b32 v49, a236
    v_max_u32 v48, v48, v49
    v_cmp_eq_u32 vcc, -1, v48
    v_mfma_f32_32x32x16_bf16 v[240:255], a[12:15], a[228:231], v[240:255]
    buffer_load_dwordx4 a[60:63], v16, s[20:23], s31 offen offset:3072 sc1
    ds_read_b64_tr_b16 a[8:9], v133 offset:6144
    ds_read_b64_tr_b16 a[10:11], v133 offset:7168
    s_waitcnt lgkmcnt(6)
    s_cbranch_vccnz L_spin41
L_ok41:
    v_mfma_f32_32x32x16_bf16 v[224:239], a[16:19], a[232:235], v[224:239]
    ds_read_b64_tr_b16 a[12:13], v132 offset:6144
    ds_read_b64_tr_b16 a[14:15], v132 offset:7168
    v_accvgpr_read_b32 v143, a255
    v_permlane32_swap_b32 v136, v138
    v_permlane32_swap_b32 v137, v139
    v_permlane32_swap_b32 v140, v142
    v_mfma_f32_32x32x16_bf16 v[240:255], a[20:23], a[232:235], v[240:255]
    buffer_load_dwordx4 a[64:67], v17, s[20:23], s29 offen offset:0 sc1
    ds_read_b64_tr_b16 a[16:17], v135 offset:4096
    ds_read_b64_tr_b16 a[18:19], v135 offset:5120
    v_permlane32_swap_b32 v141, v143
    v_lshlrev_b32 v208, 16, v136
    v_mfma_f32_32x32x16_bf16 v[224:239], a[24:27], a[236:239], v[224:239]
    ds_read_b64_tr_b16 a[20:21], v134 offset:4096
    ds_read_b64_tr_b16 a[22:23], v134 offset:5120
    s_waitcnt vmcnt(9)
    v_accvgpr_read_b32 v48, a240
    v_accvgpr_read_b32 v49, a244
    v_max_u32 v48, v48, v49
    v_cmp_eq_u32 vcc, -1, v48
    v_mfma_f32_32x32x16_bf16 v[240:255], a[28:31], a[236:239], v[240:255]
    buffer_load_dwordx4 a[68:71], v17, s[20:23], s29 offen offset:1024 sc1
    ds_read_b64_tr_b16 a[24:25], v135 offset:6144
    ds_read_b64_tr_b16 a[26:27], v135 offset:7168
    s_waitcnt lgkmcnt(6)
    s_cbranch_vccnz L_spin42
L_ok42:
    v_mfma_f32_32x32x16_bf16 v[224:239], a[0:3], a[240:243], v[224:239]
    ds_read_b64_tr_b16 a[28:29], v134 offset:6144
    ds_read_b64_tr_b16 a[30:31], v134 offset:7168
    v_and_b32 v209, s53, v136
    v_lshlrev_b32 v210, 16, v137
    v_and_b32 v211, s53, v137
    v_lshlrev_b32 v212, 16, v138
    v_mfma_f32_32x32x16_bf16 v[240:255], a[4:7], a[240:243], v[240:255]
    buffer_load_dwordx4 a[72:75], v17, s[20:23], s30 offen offset:0 sc1
    ds_read_b64_tr_b16 a[0:1], v131 offset:8192
    ds_read_b64_tr_b16 a[2:3], v131 offset:9216
    v_and_b32 v213, s53, v138
    v_lshlrev_b32 v214, 16, v139
    v_mfma_f32_32x32x16_bf16 v[224:239], a[8:11], a[244:247], v[224:239]
    ds_read_b64_tr_b16 a[4:5], v130 offset:8192
    ds_read_b64_tr_b16 a[6:7], v130 offset:9216
    s_waitcnt vmcnt(9)
    v_accvgpr_read_b32 v48, a32
    v_accvgpr_read_b32 v49, a36
    v_max_u32 v48, v48, v49
    v_cmp_eq_u32 vcc, -1, v48
    v_mfma_f32_32x32x16_bf16 v[240:255], a[12:15], a[244:247], v[240:255]
    buffer_load_dwordx4 a[76:79], v17, s[20:23], s30 offen offset:1024 sc1
    ds_read_b64_tr_b16 a[8:9], v131 offset:10240
    ds_read_b64_tr_b16 a[10:11], v131 offset:11264
    s_waitcnt lgkmcnt(6)
    s_cbranch_vccnz L_spin43
L_ok43:
    v_mfma_f32_32x32x16_bf16 v[224:239], a[16:19], a[32:35], v[224:239]
    ds_read_b64_tr_b16 a[12:13], v130 offset:10240
    ds_read_b64_tr_b16 a[14:15], v130 offset:11264
    v_and_b32 v215, s53, v139
    v_lshlrev_b32 v216, 16, v140
    v_and_b32 v217, s53, v140
    v_lshlrev_b32 v218, 16, v141
    v_mfma_f32_32x32x16_bf16 v[240:255], a[20:23], a[32:35], v[240:255]
    buffer_load_dwordx4 a[80:83], v17, s[20:23], s31 offen offset:0 sc1
    ds_read_b64_tr_b16 a[16:17], v133 offset:8192
    ds_read_b64_tr_b16 a[18:19], v133 offset:9216
    v_and_b32 v219, s53, v141
    v_lshlrev_b32 v220, 16, v142
    v_mfma_f32_32x32x16_bf16 v[224:239], a[24:27], a[36:39], v[224:239]
    buffer_load_dwordx4 a[84:87], v17, s[20:23], s31 offen offset:1024 sc1
    ds_read_b64_tr_b16 a[20:21], v132 offset:8192
    ds_read_b64_tr_b16 a[22:23], v132 offset:9216
    s_waitcnt vmcnt(10)
    v_accvgpr_read_b32 v48, a40
    v_accvgpr_read_b32 v49, a44
    v_max_u32 v48, v48, v49
    v_cmp_eq_u32 vcc, -1, v48
    v_mfma_f32_32x32x16_bf16 v[240:255], a[28:31], a[36:39], v[240:255]
    ds_read_b64_tr_b16 a[24:25], v133 offset:10240
    ds_read_b64_tr_b16 a[26:27], v133 offset:11264
    s_waitcnt lgkmcnt(6)
    s_cbranch_vccnz L_spin44
L_ok44:
    v_and_b32 v221, s53, v142
    v_mfma_f32_32x32x16_bf16 v[224:239], a[0:3], a[40:43], v[224:239]
    ds_read_b64_tr_b16 a[28:29], v132 offset:10240
    ds_read_b64_tr_b16 a[30:31], v132 offset:11264
    v_lshlrev_b32 v222, 16, v143
    v_and_b32 v223, s53, v143
    v_mov_b32 v147, v22
    v_mov_b32 v151, v22
    v_mfma_f32_32x32x16_bf16 v[240:255], a[4:7], a[40:43], v[240:255]
    ds_read_b64_tr_b16 a[0:1], v135 offset:8192
    ds_read_b64_tr_b16 a[2:3], v135 offset:9216
    v_mov_b32 v154, v22
    v_mov_b32 v155, v22
    s_lshl3_add_u32 s56, s32, s36
    s_lshl1_add_u32 s56, s56, s35
    v_mfma_f32_32x32x16_bf16 v[224:239], a[8:11], a[44:47], v[224:239]
    ds_read_b64_tr_b16 a[4:5], v134 offset:8192
    ds_read_b64_tr_b16 a[6:7], v134 offset:9216
    s_waitcnt vmcnt(8)
    v_accvgpr_read_b32 v48, a48
    v_accvgpr_read_b32 v49, a52
    v_max_u32 v48, v48, v49
    v_cmp_eq_u32 vcc, -1, v48
    v_mfma_f32_32x32x16_bf16 v[240:255], a[12:15], a[44:47], v[240:255]
    ds_read_b64_tr_b16 a[8:9], v135 offset:10240
    ds_read_b64_tr_b16 a[10:11], v135 offset:11264
    s_waitcnt lgkmcnt(6)
    s_cbranch_vccnz L_spin45
L_ok45:
    s_lshl2_add_u32 s56, s56, s3
    v_mfma_f32_32x32x16_bf16 v[224:239], a[16:19], a[48:51], v[224:239]
    ds_read_b64_tr_b16 a[12:13], v134 offset:10240
    ds_read_b64_tr_b16 a[14:15], v134 offset:11264
    s_lshl_b32 s56, s56, 12
    s_add_u32 s56, s56, 12582912
    s_xor_b32 s57, s56, 16384
    s_mov_b32 s54, 0x3f317218
    v_mfma_f32_32x32x16_bf16 v[240:255], a[20:23], a[48:51], v[240:255]
    ds_read_b64_tr_b16 a[16:17], v131 offset:12288
    ds_read_b64_tr_b16 a[18:19], v131 offset:13312
    v_and_b32 v27, 31, v1
    v_mul_u32_u24 v27, 80, v27
    v_lshrrev_b32 v28, 5, v1
    v_lshl_add_u32 v27, v28, 3, v27
    v_mfma_f32_32x32x16_bf16 v[224:239], a[24:27], a[52:55], v[224:239]
    ds_read_b64_tr_b16 a[20:21], v130 offset:12288
    ds_read_b64_tr_b16 a[22:23], v130 offset:13312
    s_waitcnt vmcnt(6)
    v_accvgpr_read_b32 v48, a56
    v_accvgpr_read_b32 v49, a60
    v_max_u32 v48, v48, v49
    v_cmp_eq_u32 vcc, -1, v48
    v_mfma_f32_32x32x16_bf16 v[240:255], a[28:31], a[52:55], v[240:255]
    ds_read_b64_tr_b16 a[24:25], v131 offset:14336
    ds_read_b64_tr_b16 a[26:27], v131 offset:15360
    s_waitcnt lgkmcnt(6)
    s_cbranch_vccnz L_spin46
L_ok46:
    v_add_u32 v4, s37, v27
    v_mfma_f32_32x32x16_bf16 v[224:239], a[0:3], a[56:59], v[224:239]
    ds_read_b64_tr_b16 a[28:29], v130 offset:14336
    ds_read_b64_tr_b16 a[30:31], v130 offset:15360
    v_lshrrev_b32 v27, 2, v1
    v_mul_u32_u24 v27, 80, v27
    v_and_b32 v28, 3, v1
    v_lshl_add_u32 v27, v28, 4, v27
    v_mfma_f32_32x32x16_bf16 v[240:255], a[4:7], a[56:59], v[240:255]
    ds_read_b64_tr_b16 a[0:1], v133 offset:12288
    ds_read_b64_tr_b16 a[2:3], v133 offset:13312
    v_add_u32 v5, s37, v27
    s_movk_i32 s58, 16384
    v_mfma_f32_32x32x16_bf16 v[224:239], a[8:11], a[60:63], v[224:239]
    ds_read_b64_tr_b16 a[4:5], v132 offset:12288
    ds_read_b64_tr_b16 a[6:7], v132 offset:13312
    s_waitcnt vmcnt(4)
    v_accvgpr_read_b32 v48, a64
    v_accvgpr_read_b32 v49, a68
    v_max_u32 v48, v48, v49
    v_cmp_eq_u32 vcc, -1, v48
    v_mfma_f32_32x32x16_bf16 v[240:255], a[12:15], a[60:63], v[240:255]
    ds_read_b64_tr_b16 a[8:9], v133 offset:14336
    ds_read_b64_tr_b16 a[10:11], v133 offset:15360
    s_waitcnt lgkmcnt(6)
    s_cbranch_vccnz L_spin47
L_ok47:
    v_mfma_f32_32x32x16_bf16 v[224:239], a[16:19], a[64:67], v[224:239]
    ds_read_b64_tr_b16 a[12:13], v132 offset:14336
    ds_read_b64_tr_b16 a[14:15], v132 offset:15360
    v_mfma_f32_32x32x16_bf16 v[240:255], a[20:23], a[64:67], v[240:255]
    ds_read_b64_tr_b16 a[16:17], v135 offset:12288
    ds_read_b64_tr_b16 a[18:19], v135 offset:13312
    v_mfma_f32_32x32x16_bf16 v[224:239], a[24:27], a[68:71], v[224:239]
    ds_read_b64_tr_b16 a[20:21], v135 offset:14336
    ds_read_b64_tr_b16 a[22:23], v135 offset:15360
    s_waitcnt vmcnt(2)
    v_accvgpr_read_b32 v48, a72
    v_accvgpr_read_b32 v49, a76
    v_max_u32 v48, v48, v49
    v_cmp_eq_u32 vcc, -1, v48
    v_mfma_f32_32x32x16_bf16 v[240:255], a[28:31], a[68:71], v[240:255]
    ds_read_b64_tr_b16 a[24:25], v134 offset:12288
    ds_read_b64_tr_b16 a[26:27], v134 offset:13312
    s_waitcnt lgkmcnt(6)
    s_cbranch_vccnz L_spin48
L_ok48:
    v_mfma_f32_32x32x16_bf16 v[224:239], a[0:3], a[72:75], v[224:239]
    ds_read_b64_tr_b16 a[28:29], v134 offset:14336
    ds_read_b64_tr_b16 a[30:31], v134 offset:15360
    v_mfma_f32_32x32x16_bf16 v[240:255], a[4:7], a[72:75], v[240:255]
    v_mfma_f32_32x32x16_bf16 v[224:239], a[8:11], a[76:79], v[224:239]
    s_waitcnt vmcnt(0)
    v_accvgpr_read_b32 v48, a80
    v_accvgpr_read_b32 v49, a84
    v_max_u32 v48, v48, v49
    v_cmp_eq_u32 vcc, -1, v48
    v_mfma_f32_32x32x16_bf16 v[240:255], a[12:15], a[76:79], v[240:255]
    s_waitcnt lgkmcnt(0)
    s_cbranch_vccnz L_spin49
L_ok49:
    v_mfma_f32_32x32x16_bf16 v[224:239], a[16:19], a[80:83], v[224:239]
    v_mfma_f32_32x32x16_bf16 v[224:239], a[20:23], a[84:87], v[224:239]
    v_mfma_f32_32x32x16_bf16 v[240:255], a[24:27], a[80:83], v[240:255]
    v_mfma_f32_32x32x16_bf16 v[240:255], a[28:31], a[84:87], v[240:255]
    s_nop 9
    v_cvt_pk_bf16_f32 v144, v224, v225
    v_cvt_pk_bf16_f32 v145, v226, v227
    v_cvt_pk_bf16_f32 v146, v228, v229
    buffer_store_dwordx4 v[144:147], v2, s[20:23], s56 offen offset:0 sc1
    v_cvt_pk_bf16_f32 v148, v230, v231
    v_cvt_pk_bf16_f32 v149, v232, v233
    v_cvt_pk_bf16_f32 v150, v234, v235
    buffer_store_dwordx4 v[148:151], v2, s[20:23], s56 offen offset:1024 sc1
    v_cvt_pk_bf16_f32 v152, v236, v237
    v_cvt_pk_bf16_f32 v153, v238, v239
    buffer_store_dwordx4 v[152:155], v2, s[20:23], s56 offen offset:2048 sc1
    v_fmac_f32 v208, s54, v240
    v_fmac_f32 v209, s54, v241
    v_fmac_f32 v210, s54, v242
    v_fmac_f32 v211, s54, v243
    v_fmac_f32 v212, s54, v244
    v_fmac_f32 v213, s54, v245
    v_fmac_f32 v214, s54, v246
    v_fmac_f32 v215, s54, v247
    v_fmac_f32 v216, s54, v248
    v_fmac_f32 v217, s54, v249
    v_fmac_f32 v218, s54, v250
    v_fmac_f32 v219, s54, v251
    v_fmac_f32 v220, s54, v252
    v_fmac_f32 v221, s54, v253
    v_fmac_f32 v222, s54, v254
    v_fmac_f32 v223, s54, v255
    s_waitcnt vmcnt(0)
    buffer_load_dwordx4 v[160:163], v2, s[20:23], s57 offen offset:0 sc1
    buffer_load_dwordx4 v[164:167], v2, s[20:23], s57 offen offset:1024 sc1
    buffer_load_dwordx4 v[168:171], v2, s[20:23], s57 offen offset:2048 sc1
    s_waitcnt vmcnt(0)
    v_bitop3_b32 v26, v163, v167, v22 bitop3:0x7e
    v_xor_b32 v27, v171, v22
    v_or_b32 v26, v26, v27
    v_cmp_ne_u32 vcc, 0, v26
    s_cbranch_vccnz L_spin50
L_ok50:
    v_lshlrev_b32 v176, 16, v160
    v_and_b32 v177, s53, v160
    v_lshlrev_b32 v178, 16, v161
    v_and_b32 v179, s53, v161
    v_lshlrev_b32 v180, 16, v162
    v_and_b32 v181, s53, v162
    v_lshlrev_b32 v182, 16, v164
    v_and_b32 v183, s53, v164
    v_fmac_f32 v208, s54, v176
    v_fmac_f32 v209, s54, v177
    v_fmac_f32 v210, s54, v178
    v_fmac_f32 v211, s54, v179
    v_fmac_f32 v212, s54, v180
    v_fmac_f32 v213, s54, v181
    v_fmac_f32 v214, s54, v182
    v_fmac_f32 v215, s54, v183
    v_cvt_pk_bf16_f32 v136, v208, v209
    v_cvt_pk_bf16_f32 v137, v210, v211
    v_cvt_pk_bf16_f32 v138, v212, v213
    v_cvt_pk_bf16_f32 v139, v214, v215
    ds_write_b64 v4, v[136:137] offset:16384
    ds_write_b64 v4, v[138:139] offset:16400
    v_lshlrev_b32 v184, 16, v165
    v_and_b32 v185, s53, v165
    v_lshlrev_b32 v186, 16, v166
    v_and_b32 v187, s53, v166
    v_lshlrev_b32 v188, 16, v168
    v_and_b32 v189, s53, v168
    v_lshlrev_b32 v190, 16, v169
    v_and_b32 v191, s53, v169
    v_fmac_f32 v216, s54, v184
    v_fmac_f32 v217, s54, v185
    v_fmac_f32 v218, s54, v186
    v_fmac_f32 v219, s54, v187
    v_fmac_f32 v220, s54, v188
    v_fmac_f32 v221, s54, v189
    v_fmac_f32 v222, s54, v190
    v_fmac_f32 v223, s54, v191
    v_cvt_pk_bf16_f32 v140, v216, v217
    v_cvt_pk_bf16_f32 v141, v218, v219
    v_cvt_pk_bf16_f32 v142, v220, v221
    v_cvt_pk_bf16_f32 v143, v222, v223
    ds_write_b64 v4, v[140:141] offset:16416
    ds_write_b64 v4, v[142:143] offset:16432
    ds_read_b128 v[176:179], v5 offset:16384
    ds_read_b128 v[180:183], v5 offset:17664
    s_waitcnt lgkmcnt(1)
    buffer_store_dwordx4 v[176:179], v19, s[24:27], 0 offen sc1
    s_waitcnt lgkmcnt(0)
    buffer_store_dwordx4 v[180:183], v19, s[24:27], s58 offen sc1
    s_endpgm
L_spin23:
    s_mov_b32 s62, 0
L_spinl23:
    global_load_dword v30, v18, s[0:1] sc1
    s_add_u32 s62, s62, 1
    s_cmp_gt_u32 s62, 400000
    s_waitcnt vmcnt(0)
    s_cbranch_scc1 L_ok23
    v_cmp_eq_u32 vcc, 0, v30
    s_cbranch_vccnz L_spinl23
    s_branch L_ok23
L_spin24:
    s_mov_b32 s62, 0
    s_mov_b32 s51, 65536
L_spinl24:
    buffer_load_dword v30, v3, s[20:23], s51 offen sc1
    s_add_u32 s62, s62, 1
    s_cmp_gt_u32 s62, 400000
    s_waitcnt vmcnt(0)
    s_cbranch_scc1 L_ok24
    v_cmp_ne_u32 vcc, s38, v30
    s_cbranch_vccnz L_spinl24
    s_branch L_ok24
L_spin25:
    s_mov_b32 s62, 0
L_spinl25:
    buffer_load_dwordx4 v[144:147], v2, s[20:23], s84 offen offset:0 sc1
    buffer_load_dwordx4 v[148:151], v2, s[20:23], s84 offen offset:1024 sc1
    buffer_load_dwordx4 v[152:155], v2, s[20:23], s84 offen offset:2048 sc1
    buffer_load_dwordx4 v[156:159], v2, s[20:23], s84 offen offset:3072 sc1
    s_add_u32 s62, s62, 1
    s_cmp_gt_u32 s62, 400000
    s_waitcnt vmcnt(0)
    s_cbranch_scc1 L_ok25
    v_bitop3_b32 v117, v147, v151, v22 bitop3:0x7e
    v_bitop3_b32 v118, v155, v159, v22 bitop3:0x7e
    v_or_b32 v117, v117, v118
    v_cmp_ne_u32 vcc, 0, v117
    s_cbranch_vccnz L_spinl25
    s_branch L_ok25
L_spin26:
    s_mov_b32 s62, 0
    s_mov_b32 s51, 131072
L_spinl26:
    buffer_load_dword v31, v26, s[20:23], s51 offen sc1
    s_add_u32 s62, s62, 1
    s_cmp_gt_u32 s62, 400000
    s_waitcnt vmcnt(0)
    s_cbranch_scc1 L_ok26
    v_cmp_ne_u32 vcc, s38, v31
    s_cbranch_vccnz L_spinl26
    s_branch L_ok26
L_spin27:
    s_mov_b32 s62, 0
L_spinl27:
    buffer_load_dwordx4 v[160:163], v2, s[20:23], s85 offen offset:0 sc1
    buffer_load_dwordx4 v[164:167], v2, s[20:23], s85 offen offset:1024 sc1
    buffer_load_dwordx4 v[168:171], v2, s[20:23], s85 offen offset:2048 sc1
    buffer_load_dwordx4 v[172:175], v2, s[20:23], s85 offen offset:3072 sc1
    s_add_u32 s62, s62, 1
    s_cmp_gt_u32 s62, 400000
    s_waitcnt vmcnt(0)
    s_cbranch_scc1 L_ok27
    v_bitop3_b32 v117, v163, v167, v22 bitop3:0x7e
    v_bitop3_b32 v118, v171, v175, v22 bitop3:0x7e
    v_or_b32 v117, v117, v118
    v_cmp_ne_u32 vcc, 0, v117
    s_cbranch_vccnz L_spinl27
    s_branch L_ok27
L_spin28:
    s_mov_b32 s62, 0
L_spinl28:
    buffer_load_dwordx4 v[176:179], v2, s[20:23], s86 offen offset:0 sc1
    buffer_load_dwordx4 v[180:183], v2, s[20:23], s86 offen offset:1024 sc1
    buffer_load_dwordx4 v[184:187], v2, s[20:23], s86 offen offset:2048 sc1
    buffer_load_dwordx4 v[188:191], v2, s[20:23], s86 offen offset:3072 sc1
    s_add_u32 s62, s62, 1
    s_cmp_gt_u32 s62, 400000
    s_waitcnt vmcnt(0)
    s_cbranch_scc1 L_ok28
    v_bitop3_b32 v117, v179, v183, v22 bitop3:0x7e
    v_bitop3_b32 v118, v187, v191, v22 bitop3:0x7e
    v_or_b32 v117, v117, v118
    v_cmp_ne_u32 vcc, 0, v117
    s_cbranch_vccnz L_spinl28
    s_branch L_ok28
L_spin29:
    s_mov_b32 s62, 0
    s_mov_b32 s51, 196608
L_spinl29:
    buffer_load_dword v23, v3, s[20:23], s51 offen sc1
    s_add_u32 s62, s62, 1
    s_cmp_gt_u32 s62, 400000
    s_waitcnt vmcnt(0)
    s_cbranch_scc1 L_ok29
    v_cmp_ne_u32 vcc, s38, v23
    s_cbranch_vccnz L_spinl29
    s_branch L_ok29
L_spin30:
    s_mov_b32 s62, 0
L_spinl30:
    buffer_load_dwordx4 v[192:195], v2, s[20:23], s87 offen offset:0 sc1
    buffer_load_dwordx4 v[196:199], v2, s[20:23], s87 offen offset:1024 sc1
    buffer_load_dwordx4 v[200:203], v2, s[20:23], s87 offen offset:2048 sc1
    buffer_load_dwordx4 v[204:207], v2, s[20:23], s87 offen offset:3072 sc1
    s_add_u32 s62, s62, 1
    s_cmp_gt_u32 s62, 400000
    s_waitcnt vmcnt(0)
    s_cbranch_scc1 L_ok30
    v_bitop3_b32 v117, v195, v199, v22 bitop3:0x7e
    v_bitop3_b32 v118, v203, v207, v22 bitop3:0x7e
    v_or_b32 v117, v117, v118
    v_cmp_ne_u32 vcc, 0, v117
    s_cbranch_vccnz L_spinl30
    s_branch L_ok30
L_spin31:
    s_mov_b32 s62, 0
    s_mov_b32 s51, 262144
L_spinl31:
    buffer_load_dword v30, v3, s[20:23], s51 offen sc1
    s_add_u32 s62, s62, 1
    s_cmp_gt_u32 s62, 400000
    s_waitcnt vmcnt(0)
    s_cbranch_scc1 L_ok31
    v_cmp_ne_u32 vcc, s38, v30
    s_cbranch_vccnz L_spinl31
    s_branch L_ok31
L_spin32:
    s_mov_b32 s62, 0
L_spinl32:
    buffer_load_dwordx4 a[160:163], v15, s[20:23], s28 offen offset:0 sc1
    buffer_load_dwordx4 a[164:167], v15, s[20:23], s28 offen offset:1024 sc1
    buffer_load_dwordx4 a[168:171], v15, s[20:23], s29 offen offset:0 sc1
    buffer_load_dwordx4 a[172:175], v15, s[20:23], s29 offen offset:1024 sc1
    buffer_load_dwordx4 a[176:179], v15, s[20:23], s30 offen offset:0 sc1
    buffer_load_dwordx4 a[180:183], v15, s[20:23], s30 offen offset:1024 sc1
    buffer_load_dwordx4 a[184:187], v15, s[20:23], s31 offen offset:0 sc1
    buffer_load_dwordx4 a[188:191], v15, s[20:23], s31 offen offset:1024 sc1
    s_add_u32 s62, s62, 1
    s_cmp_gt_u32 s62, 400000
    s_waitcnt vmcnt(0)
    s_cbranch_scc1 L_ok32
    v_accvgpr_read_b32 v48, a160
    v_accvgpr_read_b32 v49, a164
    v_max_u32 v48, v48, v49
    v_cmp_eq_u32 vcc, -1, v48
    s_cbranch_vccnz L_spinl32
    s_branch L_ok32
L_spin33:
    s_mov_b32 s62, 0
L_spinl33:
    buffer_load_dwordx4 a[168:171], v15, s[20:23], s29 offen offset:0 sc1
    buffer_load_dwordx4 a[172:175], v15, s[20:23], s29 offen offset:1024 sc1
    buffer_load_dwordx4 a[176:179], v15, s[20:23], s30 offen offset:0 sc1
    buffer_load_dwordx4 a[180:183], v15, s[20:23], s30 offen offset:1024 sc1
    buffer_load_dwordx4 a[184:187], v15, s[20:23], s31 offen offset:0 sc1
    buffer_load_dwordx4 a[188:191], v15, s[20:23], s31 offen offset:1024 sc1
    buffer_load_dwordx4 a[192:195], v15, s[20:23], s28 offen offset:2048 sc1
    buffer_load_dwordx4 a[196:199], v15, s[20:23], s28 offen offset:3072 sc1
    s_add_u32 s62, s62, 1
    s_cmp_gt_u32 s62, 400000
    s_waitcnt vmcnt(0)
    s_cbranch_scc1 L_ok33
    v_accvgpr_read_b32 v48, a168
    v_accvgpr_read_b32 v49, a172
    v_max_u32 v48, v48, v49
    v_cmp_eq_u32 vcc, -1, v48
    s_cbranch_vccnz L_spinl33
    s_branch L_ok33
L_spin34:
    s_mov_b32 s62, 0
L_spinl34:
    buffer_load_dwordx4 a[176:179], v15, s[20:23], s30 offen offset:0 sc1
    buffer_load_dwordx4 a[180:183], v15, s[20:23], s30 offen offset:1024 sc1
    buffer_load_dwordx4 a[184:187], v15, s[20:23], s31 offen offset:0 sc1
    buffer_load_dwordx4 a[188:191], v15, s[20:23], s31 offen offset:1024 sc1
    buffer_load_dwordx4 a[192:195], v15, s[20:23], s28 offen offset:2048 sc1
    buffer_load_dwordx4 a[196:199], v15, s[20:23], s28 offen offset:3072 sc1
    buffer_load_dwordx4 a[200:203], v15, s[20:23], s29 offen offset:2048 sc1
    buffer_load_dwordx4 a[204:207], v15, s[20:23], s29 offen offset:3072 sc1
    s_add_u32 s62, s62, 1
    s_cmp_gt_u32 s62, 400000
    s_waitcnt vmcnt(0)
    s_cbranch_scc1 L_ok34
    v_accvgpr_read_b32 v48, a176
    v_accvgpr_read_b32 v49, a180
    v_max_u32 v48, v48, v49
    v_cmp_eq_u32 vcc, -1, v48
    s_cbranch_vccnz L_spinl34
    s_branch L_ok34
L_spin35:
    s_mov_b32 s62, 0
L_spinl35:
    buffer_load_dwordx4 a[184:187], v15, s[20:23], s31 offen offset:0 sc1
    buffer_load_dwordx4 a[188:191], v15, s[20:23], s31 offen offset:1024 sc1
    buffer_load_dwordx4 a[192:195], v15, s[20:23], s28 offen offset:2048 sc1
    buffer_load_dwordx4 a[196:199], v15, s[20:23], s28 offen offset:3072 sc1
    buffer_load_dwordx4 a[200:203], v15, s[20:23], s29 offen offset:2048 sc1
    buffer_load_dwordx4 a[204:207], v15, s[20:23], s29 offen offset:3072 sc1
    buffer_load_dwordx4 a[208:211], v15, s[20:23], s30 offen offset:2048 sc1
    buffer_load_dwordx4 a[212:215], v15, s[20:23], s30 offen offset:3072 sc1
    s_add_u32 s62, s62, 1
    s_cmp_gt_u32 s62, 400000
    s_waitcnt vmcnt(0)
    s_cbranch_scc1 L_ok35
    v_accvgpr_read_b32 v48, a184
    v_accvgpr_read_b32 v49, a188
    v_max_u32 v48, v48, v49
    v_cmp_eq_u32 vcc, -1, v48
    s_cbranch_vccnz L_spinl35
    s_branch L_ok35
L_spin36:
    s_mov_b32 s62, 0
L_spinl36:
    buffer_load_dwordx4 a[192:195], v15, s[20:23], s28 offen offset:2048 sc1
    buffer_load_dwordx4 a[196:199], v15, s[20:23], s28 offen offset:3072 sc1
    buffer_load_dwordx4 a[200:203], v15, s[20:23], s29 offen offset:2048 sc1
    buffer_load_dwordx4 a[204:207], v15, s[20:23], s29 offen offset:3072 sc1
    buffer_load_dwordx4 a[208:211], v15, s[20:23], s30 offen offset:2048 sc1
    buffer_load_dwordx4 a[212:215], v15, s[20:23], s30 offen offset:3072 sc1
    buffer_load_dwordx4 a[216:219], v15, s[20:23], s31 offen offset:2048 sc1
    buffer_load_dwordx4 a[220:223], v15, s[20:23], s31 offen offset:3072 sc1
    s_add_u32 s62, s62, 1
    s_cmp_gt_u32 s62, 400000
    s_waitcnt vmcnt(0)
    s_cbranch_scc1 L_ok36
    v_accvgpr_read_b32 v48, a192
    v_accvgpr_read_b32 v49, a196
    v_max_u32 v48, v48, v49
    v_cmp_eq_u32 vcc, -1, v48
    s_cbranch_vccnz L_spinl36
    s_branch L_ok36
L_spin37:
    s_mov_b32 s62, 0
L_spinl37:
    buffer_load_dwordx4 a[200:203], v15, s[20:23], s29 offen offset:2048 sc1
    buffer_load_dwordx4 a[204:207], v15, s[20:23], s29 offen offset:3072 sc1
    buffer_load_dwordx4 a[208:211], v15, s[20:23], s30 offen offset:2048 sc1
    buffer_load_dwordx4 a[212:215], v15, s[20:23], s30 offen offset:3072 sc1
    buffer_load_dwordx4 a[216:219], v15, s[20:23], s31 offen offset:2048 sc1
    buffer_load_dwordx4 a[220:223], v15, s[20:23], s31 offen offset:3072 sc1
    buffer_load_dwordx4 a[224:227], v16, s[20:23], s28 offen offset:0 sc1
    buffer_load_dwordx4 a[228:231], v16, s[20:23], s28 offen offset:1024 sc1
    s_add_u32 s62, s62, 1
    s_cmp_gt_u32 s62, 400000
    s_waitcnt vmcnt(0)
    s_cbranch_scc1 L_ok37
    v_accvgpr_read_b32 v48, a200
    v_accvgpr_read_b32 v49, a204
    v_max_u32 v48, v48, v49
    v_cmp_eq_u32 vcc, -1, v48
    s_cbranch_vccnz L_spinl37
    s_branch L_ok37
L_spin38:
    s_mov_b32 s62, 0
L_spinl38:
    buffer_load_dwordx4 a[208:211], v15, s[20:23], s30 offen offset:2048 sc1
    buffer_load_dwordx4 a[212:215], v15, s[20:23], s30 offen offset:3072 sc1
    buffer_load_dwordx4 a[216:219], v15, s[20:23], s31 offen offset:2048 sc1
    buffer_load_dwordx4 a[220:223], v15, s[20:23], s31 offen offset:3072 sc1
    buffer_load_dwordx4 a[224:227], v16, s[20:23], s28 offen offset:0 sc1
    buffer_load_dwordx4 a[228:231], v16, s[20:23], s28 offen offset:1024 sc1
    buffer_load_dwordx4 a[232:235], v16, s[20:23], s29 offen offset:0 sc1
    buffer_load_dwordx4 a[236:239], v16, s[20:23], s29 offen offset:1024 sc1
    s_add_u32 s62, s62, 1
    s_cmp_gt_u32 s62, 400000
    s_waitcnt vmcnt(0)
    s_cbranch_scc1 L_ok38
    v_accvgpr_read_b32 v48, a208
    v_accvgpr_read_b32 v49, a212
    v_max_u32 v48, v48, v49
    v_cmp_eq_u32 vcc, -1, v48
    s_cbranch_vccnz L_spinl38
    s_branch L_ok38
L_spin39:
    s_mov_b32 s62, 0
L_spinl39:
    buffer_load_dwordx4 a[216:219], v15, s[20:23], s31 offen offset:2048 sc1
    buffer_load_dwordx4 a[220:223], v15, s[20:23], s31 offen offset:3072 sc1
    buffer_load_dwordx4 a[224:227], v16, s[20:23], s28 offen offset:0 sc1
    buffer_load_dwordx4 a[228:231], v16, s[20:23], s28 offen offset:1024 sc1
    buffer_load_dwordx4 a[232:235], v16, s[20:23], s29 offen offset:0 sc1
    buffer_load_dwordx4 a[236:239], v16, s[20:23], s29 offen offset:1024 sc1
    buffer_load_dwordx4 a[240:243], v16, s[20:23], s30 offen offset:0 sc1
    buffer_load_dwordx4 a[244:247], v16, s[20:23], s30 offen offset:1024 sc1
    s_add_u32 s62, s62, 1
    s_cmp_gt_u32 s62, 400000
    s_waitcnt vmcnt(0)
    s_cbranch_scc1 L_ok39
    v_accvgpr_read_b32 v48, a216
    v_accvgpr_read_b32 v49, a220
    v_max_u32 v48, v48, v49
    v_cmp_eq_u32 vcc, -1, v48
    s_cbranch_vccnz L_spinl39
    s_branch L_ok39
L_spin40:
    s_mov_b32 s62, 0
L_spinl40:
    buffer_load_dwordx4 a[224:227], v16, s[20:23], s28 offen offset:0 sc1
    buffer_load_dwordx4 a[228:231], v16, s[20:23], s28 offen offset:1024 sc1
    buffer_load_dwordx4 a[232:235], v16, s[20:23], s29 offen offset:0 sc1
    buffer_load_dwordx4 a[236:239], v16, s[20:23], s29 offen offset:1024 sc1
    buffer_load_dwordx4 a[240:243], v16, s[20:23], s30 offen offset:0 sc1
    buffer_load_dwordx4 a[244:247], v16, s[20:23], s30 offen offset:1024 sc1
    buffer_load_dwordx4 a[32:35], v16, s[20:23], s31 offen offset:0 sc1
    buffer_load_dwordx4 a[36:39], v16, s[20:23], s31 offen offset:1024 sc1
    s_add_u32 s62, s62, 1
    s_cmp_gt_u32 s62, 400000
    s_waitcnt vmcnt(0)
    s_cbranch_scc1 L_ok40
    v_accvgpr_read_b32 v48, a224
    v_accvgpr_read_b32 v49, a228
    v_max_u32 v48, v48, v49
    v_cmp_eq_u32 vcc, -1, v48
    s_cbranch_vccnz L_spinl40
    s_branch L_ok40
L_spin41:
    s_mov_b32 s62, 0
L_spinl41:
    buffer_load_dwordx4 a[232:235], v16, s[20:23], s29 offen offset:0 sc1
    buffer_load_dwordx4 a[236:239], v16, s[20:23], s29 offen offset:1024 sc1
    buffer_load_dwordx4 a[240:243], v16, s[20:23], s30 offen offset:0 sc1
    buffer_load_dwordx4 a[244:247], v16, s[20:23], s30 offen offset:1024 sc1
    buffer_load_dwordx4 a[32:35], v16, s[20:23], s31 offen offset:0 sc1
    buffer_load_dwordx4 a[36:39], v16, s[20:23], s31 offen offset:1024 sc1
    buffer_load_dwordx4 a[40:43], v16, s[20:23], s29 offen offset:2048 sc1
    buffer_load_dwordx4 a[44:47], v16, s[20:23], s29 offen offset:3072 sc1
    s_add_u32 s62, s62, 1
    s_cmp_gt_u32 s62, 400000
    s_waitcnt vmcnt(0)
    s_cbranch_scc1 L_ok41
    v_accvgpr_read_b32 v48, a232
    v_accvgpr_read_b32 v49, a236
    v_max_u32 v48, v48, v49
    v_cmp_eq_u32 vcc, -1, v48
    s_cbranch_vccnz L_spinl41
    s_branch L_ok41
L_spin42:
    s_mov_b32 s62, 0
L_spinl42:
    buffer_load_dwordx4 a[240:243], v16, s[20:23], s30 offen offset:0 sc1
    buffer_load_dwordx4 a[244:247], v16, s[20:23], s30 offen offset:1024 sc1
    buffer_load_dwordx4 a[32:35], v16, s[20:23], s31 offen offset:0 sc1
    buffer_load_dwordx4 a[36:39], v16, s[20:23], s31 offen offset:1024 sc1
    buffer_load_dwordx4 a[40:43], v16, s[20:23], s29 offen offset:2048 sc1
    buffer_load_dwordx4 a[44:47], v16, s[20:23], s29 offen offset:3072 sc1
    buffer_load_dwordx4 a[48:51], v16, s[20:23], s30 offen offset:2048 sc1
    buffer_load_dwordx4 a[52:55], v16, s[20:23], s30 offen offset:3072 sc1
    s_add_u32 s62, s62, 1
    s_cmp_gt_u32 s62, 400000
    s_waitcnt vmcnt(0)
    s_cbranch_scc1 L_ok42
    v_accvgpr_read_b32 v48, a240
    v_accvgpr_read_b32 v49, a244
    v_max_u32 v48, v48, v49
    v_cmp_eq_u32 vcc, -1, v48
    s_cbranch_vccnz L_spinl42
    s_branch L_ok42
L_spin43:
    s_mov_b32 s62, 0
L_spinl43:
    buffer_load_dwordx4 a[32:35], v16, s[20:23], s31 offen offset:0 sc1
    buffer_load_dwordx4 a[36:39], v16, s[20:23], s31 offen offset:1024 sc1
    buffer_load_dwordx4 a[40:43], v16, s[20:23], s29 offen offset:2048 sc1
    buffer_load_dwordx4 a[44:47], v16, s[20:23], s29 offen offset:3072 sc1
    buffer_load_dwordx4 a[48:51], v16, s[20:23], s30 offen offset:2048 sc1
    buffer_load_dwordx4 a[52:55], v16, s[20:23], s30 offen offset:3072 sc1
    buffer_load_dwordx4 a[56:59], v16, s[20:23], s31 offen offset:2048 sc1
    buffer_load_dwordx4 a[60:63], v16, s[20:23], s31 offen offset:3072 sc1
    s_add_u32 s62, s62, 1
    s_cmp_gt_u32 s62, 400000
    s_waitcnt vmcnt(0)
    s_cbranch_scc1 L_ok43
    v_accvgpr_read_b32 v48, a32
    v_accvgpr_read_b32 v49, a36
    v_max_u32 v48, v48, v49
    v_cmp_eq_u32 vcc, -1, v48
    s_cbranch_vccnz L_spinl43
    s_branch L_ok43
L_spin44:
    s_mov_b32 s62, 0
L_spinl44:
    buffer_load_dwordx4 a[40:43], v16, s[20:23], s29 offen offset:2048 sc1
    buffer_load_dwordx4 a[44:47], v16, s[20:23], s29 offen offset:3072 sc1
    buffer_load_dwordx4 a[48:51], v16, s[20:23], s30 offen offset:2048 sc1
    buffer_load_dwordx4 a[52:55], v16, s[20:23], s30 offen offset:3072 sc1
    buffer_load_dwordx4 a[56:59], v16, s[20:23], s31 offen offset:2048 sc1
    buffer_load_dwordx4 a[60:63], v16, s[20:23], s31 offen offset:3072 sc1
    buffer_load_dwordx4 a[64:67], v17, s[20:23], s29 offen offset:0 sc1
    buffer_load_dwordx4 a[68:71], v17, s[20:23], s29 offen offset:1024 sc1
    s_add_u32 s62, s62, 1
    s_cmp_gt_u32 s62, 400000
    s_waitcnt vmcnt(0)
    s_cbranch_scc1 L_ok44
    v_accvgpr_read_b32 v48, a40
    v_accvgpr_read_b32 v49, a44
    v_max_u32 v48, v48, v49
    v_cmp_eq_u32 vcc, -1, v48
    s_cbranch_vccnz L_spinl44
    s_branch L_ok44
L_spin45:
    s_mov_b32 s62, 0
L_spinl45:
    buffer_load_dwordx4 a[48:51], v16, s[20:23], s30 offen offset:2048 sc1
    buffer_load_dwordx4 a[52:55], v16, s[20:23], s30 offen offset:3072 sc1
    buffer_load_dwordx4 a[56:59], v16, s[20:23], s31 offen offset:2048 sc1
    buffer_load_dwordx4 a[60:63], v16, s[20:23], s31 offen offset:3072 sc1
    buffer_load_dwordx4 a[64:67], v17, s[20:23], s29 offen offset:0 sc1
    buffer_load_dwordx4 a[68:71], v17, s[20:23], s29 offen offset:1024 sc1
    buffer_load_dwordx4 a[72:75], v17, s[20:23], s30 offen offset:0 sc1
    buffer_load_dwordx4 a[76:79], v17, s[20:23], s30 offen offset:1024 sc1
    s_add_u32 s62, s62, 1
    s_cmp_gt_u32 s62, 400000
    s_waitcnt vmcnt(0)
    s_cbranch_scc1 L_ok45
    v_accvgpr_read_b32 v48, a48
    v_accvgpr_read_b32 v49, a52
    v_max_u32 v48, v48, v49
    v_cmp_eq_u32 vcc, -1, v48
    s_cbranch_vccnz L_spinl45
    s_branch L_ok45
L_spin46:
    s_mov_b32 s62, 0
L_spinl46:
    buffer_load_dwordx4 a[56:59], v16, s[20:23], s31 offen offset:2048 sc1
    buffer_load_dwordx4 a[60:63], v16, s[20:23], s31 offen offset:3072 sc1
    buffer_load_dwordx4 a[64:67], v17, s[20:23], s29 offen offset:0 sc1
    buffer_load_dwordx4 a[68:71], v17, s[20:23], s29 offen offset:1024 sc1
    buffer_load_dwordx4 a[72:75], v17, s[20:23], s30 offen offset:0 sc1
    buffer_load_dwordx4 a[76:79], v17, s[20:23], s30 offen offset:1024 sc1
    buffer_load_dwordx4 a[80:83], v17, s[20:23], s31 offen offset:0 sc1
    buffer_load_dwordx4 a[84:87], v17, s[20:23], s31 offen offset:1024 sc1
    s_add_u32 s62, s62, 1
    s_cmp_gt_u32 s62, 400000
    s_waitcnt vmcnt(0)
    s_cbranch_scc1 L_ok46
    v_accvgpr_read_b32 v48, a56
    v_accvgpr_read_b32 v49, a60
    v_max_u32 v48, v48, v49
    v_cmp_eq_u32 vcc, -1, v48
    s_cbranch_vccnz L_spinl46
    s_branch L_ok46
L_spin47:
    s_mov_b32 s62, 0
L_spinl47:
    buffer_load_dwordx4 a[64:67], v17, s[20:23], s29 offen offset:0 sc1
    buffer_load_dwordx4 a[68:71], v17, s[20:23], s29 offen offset:1024 sc1
    buffer_load_dwordx4 a[72:75], v17, s[20:23], s30 offen offset:0 sc1
    buffer_load_dwordx4 a[76:79], v17, s[20:23], s30 offen offset:1024 sc1
    buffer_load_dwordx4 a[80:83], v17, s[20:23], s31 offen offset:0 sc1
    buffer_load_dwordx4 a[84:87], v17, s[20:23], s31 offen offset:1024 sc1
    s_add_u32 s62, s62, 1
    s_cmp_gt_u32 s62, 400000
    s_waitcnt vmcnt(0)
    s_cbranch_scc1 L_ok47
    v_accvgpr_read_b32 v48, a64
    v_accvgpr_read_b32 v49, a68
    v_max_u32 v48, v48, v49
    v_cmp_eq_u32 vcc, -1, v48
    s_cbranch_vccnz L_spinl47
    s_branch L_ok47
L_spin48:
    s_mov_b32 s62, 0
L_spinl48:
    buffer_load_dwordx4 a[72:75], v17, s[20:23], s30 offen offset:0 sc1
    buffer_load_dwordx4 a[76:79], v17, s[20:23], s30 offen offset:1024 sc1
    buffer_load_dwordx4 a[80:83], v17, s[20:23], s31 offen offset:0 sc1
    buffer_load_dwordx4 a[84:87], v17, s[20:23], s31 offen offset:1024 sc1
    s_add_u32 s62, s62, 1
    s_cmp_gt_u32 s62, 400000
    s_waitcnt vmcnt(0)
    s_cbranch_scc1 L_ok48
    v_accvgpr_read_b32 v48, a72
    v_accvgpr_read_b32 v49, a76
    v_max_u32 v48, v48, v49
    v_cmp_eq_u32 vcc, -1, v48
    s_cbranch_vccnz L_spinl48
    s_branch L_ok48
L_spin49:
    s_mov_b32 s62, 0
L_spinl49:
    buffer_load_dwordx4 a[80:83], v17, s[20:23], s31 offen offset:0 sc1
    buffer_load_dwordx4 a[84:87], v17, s[20:23], s31 offen offset:1024 sc1
    s_add_u32 s62, s62, 1
    s_cmp_gt_u32 s62, 400000
    s_waitcnt vmcnt(0)
    s_cbranch_scc1 L_ok49
    v_accvgpr_read_b32 v48, a80
    v_accvgpr_read_b32 v49, a84
    v_max_u32 v48, v48, v49
    v_cmp_eq_u32 vcc, -1, v48
    s_cbranch_vccnz L_spinl49
    s_branch L_ok49
L_spin50:
    s_mov_b32 s62, 0
L_spinl50:
    buffer_load_dwordx4 v[160:163], v2, s[20:23], s57 offen offset:0 sc1
    buffer_load_dwordx4 v[164:167], v2, s[20:23], s57 offen offset:1024 sc1
    buffer_load_dwordx4 v[168:171], v2, s[20:23], s57 offen offset:2048 sc1
    s_add_u32 s62, s62, 1
    s_cmp_gt_u32 s62, 400000
    s_waitcnt vmcnt(0)
    s_cbranch_scc1 L_ok50
    v_bitop3_b32 v26, v163, v167, v22 bitop3:0x7e
    v_xor_b32 v27, v171, v22
    v_or_b32 v26, v26, v27
    v_cmp_ne_u32 vcc, 0, v26
    s_cbranch_vccnz L_spinl50
    s_branch L_ok50
L_codeend:
    s_endpgm
.section .rodata,"a"
.p2align 6
.amdhsa_kernel parallel_sum__linear_attn_block__dense_activation_silu__prompt_kernel
  .amdhsa_next_free_vgpr 512
  .amdhsa_next_free_sgpr 102
  .amdhsa_accum_offset 256
  .amdhsa_group_segment_fixed_size 0
  .amdhsa_kernarg_size 72
  .amdhsa_user_sgpr_count 2
  .amdhsa_user_sgpr_kernarg_segment_ptr 1
  .amdhsa_system_sgpr_workgroup_id_x 1
.end_amdhsa_kernel
```
